```python
import torch

def _softmax(x, axis=-1):
    return torch.softmax(x, dim=axis)
def _gelu(x):
    return torch.nn.functional.gelu(x, approximate="tanh")
def _silu(x):
    return torch.nn.functional.silu(x)
def _sigmoid(x):
    return torch.sigmoid(x)
def _layernorm(x, axis=-1, eps=1e-5):
    m = x.mean(dim=axis, keepdim=True)
    v = x.var(dim=axis, keepdim=True, unbiased=False)
    return (x - m) / torch.sqrt(v + eps)
def _scatter_add(tgt, idx, src, axis=0):
    return tgt.clone().index_add_(axis, idx, src)
def _segment_sum(src, seg, n):
    out = torch.zeros((n,) + src.shape[1:], dtype=src.dtype)
    return out.index_add_(0, seg, src)
def _pad(x, pw):
    flat = tuple(v for pair in reversed(pw) for v in pair)
    return torch.nn.functional.pad(x, flat)

kernel_name = 'gated_mix__ssm_conv_s5__dense_activation_squared_relu__prompt'

def setup_inputs():

    _w = (lambda a: (lambda t: t.to(torch.bfloat16) if t.is_floating_point() else t)(torch.as_tensor(a)))
    def _A_setup():
        B, S, D = 1, 2048, 640
        P = D
        Lambda_re = -0.5 * (lambda _x: torch.exp(torch.as_tensor(_x)))((lambda *s: torch.randn(*s, dtype=torch.bfloat16) * 0.4)(P))
        Lambda_im = (lambda *s: torch.randn(*s, dtype=torch.bfloat16) * 0.8)(P) * 1.0
        B_re = (lambda *s: torch.randn(*s, dtype=torch.bfloat16) * 0.4)(P, D) * (D ** -0.5)
        B_im = (lambda *s: torch.randn(*s, dtype=torch.bfloat16) * 0.8)(P, D) * (D ** -0.5)
        C_re = (lambda *s: torch.randn(*s, dtype=torch.bfloat16) * 0.4)(D, P) * (P ** -0.5)
        C_im = (lambda *s: torch.randn(*s, dtype=torch.bfloat16) * 0.4)(D, P) * (P ** -0.5)
        log_dt = (lambda *s: torch.randn(*s, dtype=torch.bfloat16) * 0.4)(P) * 0.3 - 2.0
        Dskip = (lambda *s: torch.randn(*s, dtype=torch.bfloat16) * 0.1)(D)
        return {
            "x": _w((lambda *s: torch.randn(*s, dtype=torch.bfloat16) * 0.05)(B, S, D)),
            "Lambda_re": _w(Lambda_re),
            "Lambda_im": _w(Lambda_im),
            "B_re": _w(B_re),
            "B_im": _w(B_im),
            "C_re": _w(C_re),
            "C_im": _w(C_im),
            "log_dt": _w(log_dt),
            "Dskip": _w(Dskip),
        }
    _A_in = _A_setup()

    def _B_setup():
        B, S, D, F = 1, 2048, 640, 1728
        return {
            "x": _w((lambda *s: torch.randn(*s, dtype=torch.bfloat16) * 0.05)(B, S, D)),
            "w1": _w((lambda *s: torch.randn(*s, dtype=torch.bfloat16) * 0.05)(D, F)),
            "b1": _w((lambda *s: torch.randn(*s, dtype=torch.bfloat16) * 0.05)(F)),
            "w2": _w((lambda *s: torch.randn(*s, dtype=torch.bfloat16) * 0.05)(F, D)),
            "b2": _w((lambda *s: torch.randn(*s, dtype=torch.bfloat16) * 0.05)(D)),
        }
    _B_in = _B_setup()

    return {
        "A_x": _A_in["x"],
        "A_Lambda_re": _A_in["Lambda_re"],
        "A_Lambda_im": _A_in["Lambda_im"],
        "A_B_re": _A_in["B_re"],
        "A_B_im": _A_in["B_im"],
        "A_C_re": _A_in["C_re"],
        "A_C_im": _A_in["C_im"],
        "A_log_dt": _A_in["log_dt"],
        "A_Dskip": _A_in["Dskip"],
        "B_x": _B_in["x"],
        "B_w1": _B_in["w1"],
        "B_b1": _B_in["b1"],
        "B_w2": _B_in["w2"],
        "B_b2": _B_in["b2"],
        "gate_w": _w((lambda *s: torch.randn(*s, dtype=torch.bfloat16) * 0.05)(640) * 16.0),
    }

def reference(A_x, A_Lambda_re, A_Lambda_im, A_B_re, A_B_im, A_C_re, A_C_im, A_log_dt, A_Dskip, B_x, B_w1, B_b1, B_w2, B_b2, gate_w):
    def _A_ref(x, Lambda_re, Lambda_im, B_re, B_im, C_re, C_im, log_dt, Dskip):
        Bsz, L, H = x.shape
        Lam = Lambda_re + 1j * Lambda_im
        Bmat = B_re + 1j * B_im
        Cmat = C_re + 1j * C_im
        dt = torch.exp(log_dt)
        Lam_bar = torch.exp(dt * Lam)
        B_bar = ((Lam_bar - 1.0) / Lam)[:, None] * Bmat
        Bu = torch.einsum("bld,pd->blp", x + 0j, B_bar)
        h = torch.zeros_like(Bu[:, 0, :])
        hs = []
        for t in range(L):
            h = Lam_bar[None, :] * h + Bu[:, t, :]
            hs.append(h)
        hseq = torch.stack(hs, 1)
        y = 2.0 * torch.einsum("blp,dp->bld", hseq, Cmat).real + x * Dskip[None, None, :]
        return y

    def _B_ref(x, w1, b1, w2, b2):
        h = torch.einsum("bsd,df->bsf", x, w1) + b1
        zero = torch.zeros_like(h)
        r = torch.where(h > zero, h, zero)
        h = r * r
        out = torch.einsum("bsf,fd->bsd", h, w2) + b2
        return out

    x = A_x
    g = _sigmoid((x * gate_w).sum(-1, keepdims=True))
    a = _A_ref(x, A_Lambda_re, A_Lambda_im, A_B_re, A_B_im, A_C_re, A_C_im, A_log_dt, A_Dskip)
    b = _B_ref(x, B_w1, B_b1, B_w2, B_b2)
    return g * a + (1 - g) * b
```

```asm
; @launch grid=(256,1,1) block=(512,1,1) lds=159808
.amdgcn_target "amdgcn-amd-amdhsa--gfx950"
.text
.globl gated_mix__ssm_conv_s5__dense_activation_squared_relu__prompt_kernel
.p2align 8
.type gated_mix__ssm_conv_s5__dense_activation_squared_relu__prompt_kernel,@function
gated_mix__ssm_conv_s5__dense_activation_squared_relu__prompt_kernel:
s_cmp_ge_u32 s2, 256
s_cbranch_scc1 DONE
s_load_dwordx2 s[40:41], s[0:1], 0
s_load_dwordx2 s[42:43], s[0:1], 80
s_load_dwordx2 s[44:45], s[0:1], 136
s_load_dwordx2 s[46:47], s[0:1], 88
s_load_dwordx2 s[70:71], s[0:1], 128
s_load_dwordx2 s[60:61], s[0:1], 24
s_load_dwordx2 s[62:63], s[0:1], 32
s_load_dwordx2 s[64:65], s[0:1], 8
s_load_dwordx2 s[66:67], s[0:1], 16
s_load_dwordx2 s[68:69], s[0:1], 56
s_load_dwordx2 s[84:85], s[0:1], 112
s_load_dwordx2 s[72:73], s[0:1], 96
s_load_dwordx2 s[74:75], s[0:1], 40
s_load_dwordx2 s[78:79], s[0:1], 48
s_load_dwordx2 s[48:49], s[0:1], 120
s_load_dwordx2 s[50:51], s[0:1], 64
s_load_dwordx2 s[52:53], s[0:1], 104
s_and_b32 s25, s2, 7
s_lshr_b32 s26, s2, 3
s_lshr_b32 s27, s25, 1
s_lshl_b32 s21, s27, 2
s_lshr_b32 s27, s26, 3
s_add_u32 s21, s21, s27
s_and_b32 s27, s25, 1
s_lshl_b32 s27, s27, 3
s_and_b32 s22, s26, 7
s_add_u32 s22, s22, s27
v_lshrrev_b32 v1, 6, v0
s_nop 0
v_readfirstlane_b32 s20, v1
v_and_b32 v0, 63, v0
s_waitcnt lgkmcnt(0)
s_add_u32 s86, s44, 16252928
s_addc_u32 s87, s45, 0
s_mov_b32 s4, s40
s_and_b32 s5, s41, 0xffff
s_mov_b32 s6, 2621440
s_mov_b32 s7, 0x20000
s_mov_b32 s12, s44
s_and_b32 s13, s45, 0xffff
s_mov_b32 s14, 67108864
s_mov_b32 s15, 0x20000
s_mov_b32 s80, s84
s_and_b32 s81, s85, 0xffff
s_mov_b32 s82, 1280
s_mov_b32 s83, 0x20000
s_cmp_lt_u32 s22, 8
s_cbranch_scc1 R_SSM
s_mov_b32 s8, s42
s_and_b32 s9, s43, 0xffff
s_mov_b32 s10, 2211840
s_mov_b32 s11, 0x20000
s_sub_u32 s23, s22, 8
s_mul_i32 s24, s23, 224
s_cmp_eq_u32 s23, 7
s_cselect_b32 s24, 1504, s24
s_lshl_b32 s27, s24, 1
s_and_b32 s26, s27, 0xffffff80
s_sub_u32 s28, s27, s26
s_cmp_ge_u32 s20, 4
s_cbranch_scc1 R_FFN_L
s_mov_b32 s16, s46
s_and_b32 s17, s47, 0xffff
s_mov_b32 s18, 3456
s_mov_b32 s19, 0x20000
s_and_b32 s31, s20, 1
v_lshrrev_b32 v1, 4, v0
s_mul_i32 s33, s31, 112
s_add_u32 s33, s33, s24
s_lshl_b32 s33, s33, 1
v_lshlrev_b32 v14, 3, v1
buffer_load_dwordx2 v[60:61], v14, s[16:19], s33 offen offset:0
buffer_load_dwordx2 v[62:63], v14, s[16:19], s33 offen offset:32
buffer_load_dwordx2 v[64:65], v14, s[16:19], s33 offen offset:64
buffer_load_dwordx2 v[66:67], v14, s[16:19], s33 offen offset:96
buffer_load_dwordx2 v[68:69], v14, s[16:19], s33 offen offset:128
buffer_load_dwordx2 v[70:71], v14, s[16:19], s33 offen offset:160
buffer_load_dwordx2 v[72:73], v14, s[16:19], s33 offen offset:192
s_branch R_FFN_C
R_FFN_L:
s_sub_u32 s30, s20, 4
s_setprio 2
v_lshrrev_b32 v1, 3, v0
v_and_b32 v4, 7, v0
v_lshrrev_b32 v5, 4, v0
v_mul_u32_u24 v7, 1280, v1
s_lshl_b32 s32, s21, 7
s_lshl_b32 s33, s30, 3
s_add_u32 s32, s32, s33
s_mul_i32 s40, s32, 1280
s_and_b32 s31, s30, 1
s_lshl_b32 s32, s31, 2
v_add_u32 v215, s32, v5
v_and_b32 v215, 7, v215
v_xor_b32 v6, v4, v215
v_lshlrev_b32 v6, 4, v6
v_add_u32 v2, v6, v7
v_and_b32 v6, 1, v5
s_lshl_b32 s32, s31, 1
v_or_b32 v6, s32, v6
v_lshlrev_b32 v6, 1, v6
v_xor_b32 v6, v4, v6
v_lshlrev_b32 v6, 4, v6
v_mul_u32_u24 v7, 3456, v1
v_add_u32 v3, v6, v7
s_lshl_b32 s33, s30, 3
s_mul_i32 s41, s33, 3456
s_add_u32 s41, s41, s26
s_lshl_b32 s42, s30, 10
s_mov_b32 s43, 0
s_and_b32 s32, s21, 3
s_mul_i32 s32, s32, 5
s_lshr_b32 s32, s32, 1
s_and_b32 s33, s22, 7
s_add_u32 s73, s32, s33
s_cmp_ge_u32 s73, 10
s_cselect_b32 s32, 10, 0
s_sub_u32 s73, s73, s32
s_mov_b32 s78, s73
s_lshl_b32 s32, s73, 7
s_add_u32 s40, s40, s32
s_mul_i32 s32, s73, 221184
s_add_u32 s41, s41, s32
s_add_u32 m0, s42, 0
s_add_u32 s44, s40, 0
buffer_load_dwordx4 v2, s[4:7], s44 offen lds
s_add_u32 m0, s42, 4096
s_add_u32 s44, s40, 40960
buffer_load_dwordx4 v2, s[4:7], s44 offen lds
s_add_u32 m0, s42, 8192
s_add_u32 s44, s40, 81920
buffer_load_dwordx4 v2, s[4:7], s44 offen lds
s_add_u32 m0, s42, 12288
s_add_u32 s44, s40, 122880
buffer_load_dwordx4 v2, s[4:7], s44 offen lds
s_add_u32 m0, s42, 16384
s_add_u32 s44, s41, 0
buffer_load_dwordx4 v3, s[8:11], s44 offen lds
s_add_u32 m0, s42, 20480
s_add_u32 s44, s41, 110592
buffer_load_dwordx4 v3, s[8:11], s44 offen lds
s_add_u32 m0, s42, 24576
s_add_u32 s44, s41, 128
buffer_load_dwordx4 v3, s[8:11], s44 offen lds
s_add_u32 m0, s42, 28672
s_add_u32 s44, s41, 110720
buffer_load_dwordx4 v3, s[8:11], s44 offen lds
s_add_u32 m0, s42, 32768
s_add_u32 s44, s41, 256
buffer_load_dwordx4 v3, s[8:11], s44 offen lds
s_add_u32 m0, s42, 36864
s_add_u32 s44, s41, 110848
buffer_load_dwordx4 v3, s[8:11], s44 offen lds
s_add_u32 m0, s42, 40960
s_add_u32 s44, s41, 384
buffer_load_dwordx4 v3, s[8:11], s44 offen lds
s_add_u32 m0, s42, 45056
s_add_u32 s44, s41, 110976
buffer_load_dwordx4 v3, s[8:11], s44 offen lds
s_cmp_eq_u32 s30, 3
s_cbranch_scc0 GD_1
v_lshlrev_b32 v205, 4, v0
s_movk_i32 s32, 1024
s_mov_b32 m0, 155648
s_nop 0
buffer_load_dwordx4 v205, s[80:83], 0 offen lds
s_mov_b32 m0, 156672
s_mov_b64 s[76:77], exec
s_mov_b64 exec, 0xffff
buffer_load_dwordx4 v205, s[80:83], s32 offen lds
s_mov_b64 exec, s[76:77]
s_mov_b32 m0, 156928
s_nop 0
buffer_load_dwordx4 v205, s[80:83], 0 offen lds
s_mov_b32 m0, 157952
s_mov_b64 s[76:77], exec
s_mov_b64 exec, 0xffff
buffer_load_dwordx4 v205, s[80:83], s32 offen lds
s_mov_b64 exec, s[76:77]
GD_1:
s_and_b32 s32, s22, 3
s_lshl_b32 s32, s32, 2
s_add_u32 s32, s32, s30
s_lshl_b32 s33, s32, 10
s_lshl_b32 s35, s32, 3
v_lshlrev_b32 v207, 4, v0
v_add_u32 v207, s33, v207
v_add_u32 v212, 49152, v207
v_add_u32 v213, 98304, v207
v_and_b32 v206, 7, v0
v_xor_b32 v206, v206, v215
v_lshlrev_b32 v206, 4, v206
v_add_u32 v206, 155648, v206
s_lshl_b32 s32, s73, 7
v_add_u32 v206, s32, v206
v_mov_b32 v204, 0
v_mov_b32 v218, 0
s_lshr_b32 s33, s22, 2
s_and_b32 s33, s33, 3
s_lshl_b32 s34, s21, 2
s_add_u32 s34, s34, s33
s_lshl_b32 s34, s34, 7
s_add_u32 s34, s34, s35
s_lshl_b32 s34, s34, 2
s_add_u32 s34, s34, 14680064
v_lshrrev_b32 v214, 3, v0
v_lshlrev_b32 v214, 2, v214
v_add_u32 v214, s34, v214
s_add_u32 s40, s40, 128
s_add_u32 s41, s41, 221184
s_add_u32 s78, s78, 1
s_cmp_eq_u32 s78, 10
s_cselect_b32 s79, 1280, 0
s_cselect_b32 s72, 2211840, 0
s_cselect_b32 s78, 0, s78
s_sub_u32 s40, s40, s79
s_sub_u32 s41, s41, s72
s_add_u32 s42, s42, 49152
s_add_u32 s43, s43, 1
s_cmp_eq_u32 s43, 3
s_cselect_b32 s45, 147456, 0
s_cselect_b32 s43, 0, s43
s_sub_u32 s42, s42, s45
s_add_u32 m0, s42, 0
s_add_u32 s44, s40, 0
buffer_load_dwordx4 v2, s[4:7], s44 offen lds
s_add_u32 m0, s42, 4096
s_add_u32 s44, s40, 40960
buffer_load_dwordx4 v2, s[4:7], s44 offen lds
s_add_u32 m0, s42, 8192
s_add_u32 s44, s40, 81920
buffer_load_dwordx4 v2, s[4:7], s44 offen lds
s_add_u32 m0, s42, 12288
s_add_u32 s44, s40, 122880
buffer_load_dwordx4 v2, s[4:7], s44 offen lds
s_add_u32 m0, s42, 16384
s_add_u32 s44, s41, 0
buffer_load_dwordx4 v3, s[8:11], s44 offen lds
s_add_u32 m0, s42, 20480
s_add_u32 s44, s41, 110592
buffer_load_dwordx4 v3, s[8:11], s44 offen lds
s_add_u32 m0, s42, 24576
s_add_u32 s44, s41, 128
buffer_load_dwordx4 v3, s[8:11], s44 offen lds
s_add_u32 m0, s42, 28672
s_add_u32 s44, s41, 110720
buffer_load_dwordx4 v3, s[8:11], s44 offen lds
s_add_u32 m0, s42, 32768
s_add_u32 s44, s41, 256
buffer_load_dwordx4 v3, s[8:11], s44 offen lds
s_add_u32 m0, s42, 36864
s_add_u32 s44, s41, 110848
buffer_load_dwordx4 v3, s[8:11], s44 offen lds
s_waitcnt vmcnt(10)
s_barrier
s_add_u32 m0, s42, 40960
s_add_u32 s44, s41, 384
buffer_load_dwordx4 v3, s[8:11], s44 offen lds
s_add_u32 m0, s42, 45056
s_add_u32 s44, s41, 110976
buffer_load_dwordx4 v3, s[8:11], s44 offen lds
s_add_u32 s40, s40, 128
s_add_u32 s41, s41, 221184
s_add_u32 s78, s78, 1
s_cmp_eq_u32 s78, 10
s_cselect_b32 s79, 1280, 0
s_cselect_b32 s72, 2211840, 0
s_cselect_b32 s78, 0, s78
s_sub_u32 s40, s40, s79
s_sub_u32 s41, s41, s72
s_add_u32 s42, s42, 49152
s_add_u32 s43, s43, 1
s_cmp_eq_u32 s43, 3
s_cselect_b32 s45, 147456, 0
s_cselect_b32 s43, 0, s43
s_sub_u32 s42, s42, s45
s_add_u32 m0, s42, 0
s_add_u32 s44, s40, 0
buffer_load_dwordx4 v2, s[4:7], s44 offen lds
s_add_u32 m0, s42, 4096
s_add_u32 s44, s40, 40960
buffer_load_dwordx4 v2, s[4:7], s44 offen lds
s_add_u32 m0, s42, 8192
s_add_u32 s44, s40, 81920
buffer_load_dwordx4 v2, s[4:7], s44 offen lds
s_add_u32 m0, s42, 12288
s_add_u32 s44, s40, 122880
buffer_load_dwordx4 v2, s[4:7], s44 offen lds
s_add_u32 m0, s42, 16384
s_add_u32 s44, s41, 0
buffer_load_dwordx4 v3, s[8:11], s44 offen lds
s_add_u32 m0, s42, 20480
s_add_u32 s44, s41, 110592
buffer_load_dwordx4 v3, s[8:11], s44 offen lds
s_add_u32 m0, s42, 24576
s_add_u32 s44, s41, 128
buffer_load_dwordx4 v3, s[8:11], s44 offen lds
s_add_u32 m0, s42, 28672
s_add_u32 s44, s41, 110720
buffer_load_dwordx4 v3, s[8:11], s44 offen lds
s_add_u32 m0, s42, 32768
s_add_u32 s44, s41, 256
buffer_load_dwordx4 v3, s[8:11], s44 offen lds
s_add_u32 m0, s42, 36864
s_add_u32 s44, s41, 110848
buffer_load_dwordx4 v3, s[8:11], s44 offen lds
ds_read_b128 v[200:203], v207
ds_read_b128 v[208:211], v206 offset:0
s_waitcnt lgkmcnt(0)
v_dot2_f32_bf16 v204, v200, v208, v204
v_dot2_f32_bf16 v218, v201, v209, v218
v_dot2_f32_bf16 v204, v202, v210, v204
v_dot2_f32_bf16 v218, v203, v211, v218
s_waitcnt vmcnt(10)
s_barrier
s_add_u32 m0, s42, 40960
s_add_u32 s44, s41, 384
buffer_load_dwordx4 v3, s[8:11], s44 offen lds
s_add_u32 m0, s42, 45056
s_add_u32 s44, s41, 110976
buffer_load_dwordx4 v3, s[8:11], s44 offen lds
s_add_u32 s40, s40, 128
s_add_u32 s41, s41, 221184
s_add_u32 s78, s78, 1
s_cmp_eq_u32 s78, 10
s_cselect_b32 s79, 1280, 0
s_cselect_b32 s72, 2211840, 0
s_cselect_b32 s78, 0, s78
s_sub_u32 s40, s40, s79
s_sub_u32 s41, s41, s72
s_add_u32 s42, s42, 49152
s_add_u32 s43, s43, 1
s_cmp_eq_u32 s43, 3
s_cselect_b32 s45, 147456, 0
s_cselect_b32 s43, 0, s43
s_sub_u32 s42, s42, s45
s_add_u32 m0, s42, 0
s_add_u32 s44, s40, 0
buffer_load_dwordx4 v2, s[4:7], s44 offen lds
s_add_u32 m0, s42, 4096
s_add_u32 s44, s40, 40960
buffer_load_dwordx4 v2, s[4:7], s44 offen lds
s_add_u32 m0, s42, 8192
s_add_u32 s44, s40, 81920
buffer_load_dwordx4 v2, s[4:7], s44 offen lds
s_add_u32 m0, s42, 12288
s_add_u32 s44, s40, 122880
buffer_load_dwordx4 v2, s[4:7], s44 offen lds
s_add_u32 m0, s42, 16384
s_add_u32 s44, s41, 0
buffer_load_dwordx4 v3, s[8:11], s44 offen lds
s_add_u32 m0, s42, 20480
s_add_u32 s44, s41, 110592
buffer_load_dwordx4 v3, s[8:11], s44 offen lds
s_add_u32 m0, s42, 24576
s_add_u32 s44, s41, 128
buffer_load_dwordx4 v3, s[8:11], s44 offen lds
s_add_u32 m0, s42, 28672
s_add_u32 s44, s41, 110720
buffer_load_dwordx4 v3, s[8:11], s44 offen lds
s_add_u32 m0, s42, 32768
s_add_u32 s44, s41, 256
buffer_load_dwordx4 v3, s[8:11], s44 offen lds
s_add_u32 m0, s42, 36864
s_add_u32 s44, s41, 110848
buffer_load_dwordx4 v3, s[8:11], s44 offen lds
ds_read_b128 v[200:203], v212
ds_read_b128 v[208:211], v206 offset:128
s_waitcnt lgkmcnt(0)
v_dot2_f32_bf16 v204, v200, v208, v204
v_dot2_f32_bf16 v218, v201, v209, v218
v_dot2_f32_bf16 v204, v202, v210, v204
v_dot2_f32_bf16 v218, v203, v211, v218
s_waitcnt vmcnt(10)
s_barrier
s_add_u32 m0, s42, 40960
s_add_u32 s44, s41, 384
buffer_load_dwordx4 v3, s[8:11], s44 offen lds
s_add_u32 m0, s42, 45056
s_add_u32 s44, s41, 110976
buffer_load_dwordx4 v3, s[8:11], s44 offen lds
s_add_u32 s40, s40, 128
s_add_u32 s41, s41, 221184
s_add_u32 s78, s78, 1
s_cmp_eq_u32 s78, 10
s_cselect_b32 s79, 1280, 0
s_cselect_b32 s72, 2211840, 0
s_cselect_b32 s78, 0, s78
s_sub_u32 s40, s40, s79
s_sub_u32 s41, s41, s72
s_add_u32 s42, s42, 49152
s_add_u32 s43, s43, 1
s_cmp_eq_u32 s43, 3
s_cselect_b32 s45, 147456, 0
s_cselect_b32 s43, 0, s43
s_sub_u32 s42, s42, s45
s_add_u32 m0, s42, 0
s_add_u32 s44, s40, 0
buffer_load_dwordx4 v2, s[4:7], s44 offen lds
s_add_u32 m0, s42, 4096
s_add_u32 s44, s40, 40960
buffer_load_dwordx4 v2, s[4:7], s44 offen lds
s_add_u32 m0, s42, 8192
s_add_u32 s44, s40, 81920
buffer_load_dwordx4 v2, s[4:7], s44 offen lds
s_add_u32 m0, s42, 12288
s_add_u32 s44, s40, 122880
buffer_load_dwordx4 v2, s[4:7], s44 offen lds
s_add_u32 m0, s42, 16384
s_add_u32 s44, s41, 0
buffer_load_dwordx4 v3, s[8:11], s44 offen lds
s_add_u32 m0, s42, 20480
s_add_u32 s44, s41, 110592
buffer_load_dwordx4 v3, s[8:11], s44 offen lds
s_add_u32 m0, s42, 24576
s_add_u32 s44, s41, 128
buffer_load_dwordx4 v3, s[8:11], s44 offen lds
s_add_u32 m0, s42, 28672
s_add_u32 s44, s41, 110720
buffer_load_dwordx4 v3, s[8:11], s44 offen lds
s_add_u32 m0, s42, 32768
s_add_u32 s44, s41, 256
buffer_load_dwordx4 v3, s[8:11], s44 offen lds
s_add_u32 m0, s42, 36864
s_add_u32 s44, s41, 110848
buffer_load_dwordx4 v3, s[8:11], s44 offen lds
ds_read_b128 v[200:203], v213
ds_read_b128 v[208:211], v206 offset:256
s_waitcnt lgkmcnt(0)
v_dot2_f32_bf16 v204, v200, v208, v204
v_dot2_f32_bf16 v218, v201, v209, v218
v_dot2_f32_bf16 v204, v202, v210, v204
v_dot2_f32_bf16 v218, v203, v211, v218
s_waitcnt vmcnt(10)
s_barrier
s_add_u32 m0, s42, 40960
s_add_u32 s44, s41, 384
buffer_load_dwordx4 v3, s[8:11], s44 offen lds
s_add_u32 m0, s42, 45056
s_add_u32 s44, s41, 110976
buffer_load_dwordx4 v3, s[8:11], s44 offen lds
s_add_u32 s40, s40, 128
s_add_u32 s41, s41, 221184
s_add_u32 s78, s78, 1
s_cmp_eq_u32 s78, 10
s_cselect_b32 s79, 1280, 0
s_cselect_b32 s72, 2211840, 0
s_cselect_b32 s78, 0, s78
s_sub_u32 s40, s40, s79
s_sub_u32 s41, s41, s72
s_add_u32 s42, s42, 49152
s_add_u32 s43, s43, 1
s_cmp_eq_u32 s43, 3
s_cselect_b32 s45, 147456, 0
s_cselect_b32 s43, 0, s43
s_sub_u32 s42, s42, s45
s_add_u32 m0, s42, 0
s_add_u32 s44, s40, 0
buffer_load_dwordx4 v2, s[4:7], s44 offen lds
s_add_u32 m0, s42, 4096
s_add_u32 s44, s40, 40960
buffer_load_dwordx4 v2, s[4:7], s44 offen lds
s_add_u32 m0, s42, 8192
s_add_u32 s44, s40, 81920
buffer_load_dwordx4 v2, s[4:7], s44 offen lds
s_add_u32 m0, s42, 12288
s_add_u32 s44, s40, 122880
buffer_load_dwordx4 v2, s[4:7], s44 offen lds
s_add_u32 m0, s42, 16384
s_add_u32 s44, s41, 0
buffer_load_dwordx4 v3, s[8:11], s44 offen lds
s_add_u32 m0, s42, 20480
s_add_u32 s44, s41, 110592
buffer_load_dwordx4 v3, s[8:11], s44 offen lds
s_add_u32 m0, s42, 24576
s_add_u32 s44, s41, 128
buffer_load_dwordx4 v3, s[8:11], s44 offen lds
s_add_u32 m0, s42, 28672
s_add_u32 s44, s41, 110720
buffer_load_dwordx4 v3, s[8:11], s44 offen lds
s_add_u32 m0, s42, 32768
s_add_u32 s44, s41, 256
buffer_load_dwordx4 v3, s[8:11], s44 offen lds
s_add_u32 m0, s42, 36864
s_add_u32 s44, s41, 110848
buffer_load_dwordx4 v3, s[8:11], s44 offen lds
ds_read_b128 v[200:203], v207
ds_read_b128 v[208:211], v206 offset:384
s_waitcnt lgkmcnt(0)
v_dot2_f32_bf16 v204, v200, v208, v204
v_dot2_f32_bf16 v218, v201, v209, v218
v_dot2_f32_bf16 v204, v202, v210, v204
v_dot2_f32_bf16 v218, v203, v211, v218
s_waitcnt vmcnt(10)
s_barrier
s_add_u32 m0, s42, 40960
s_add_u32 s44, s41, 384
buffer_load_dwordx4 v3, s[8:11], s44 offen lds
s_add_u32 m0, s42, 45056
s_add_u32 s44, s41, 110976
buffer_load_dwordx4 v3, s[8:11], s44 offen lds
s_add_u32 s40, s40, 128
s_add_u32 s41, s41, 221184
s_add_u32 s78, s78, 1
s_cmp_eq_u32 s78, 10
s_cselect_b32 s79, 1280, 0
s_cselect_b32 s72, 2211840, 0
s_cselect_b32 s78, 0, s78
s_sub_u32 s40, s40, s79
s_sub_u32 s41, s41, s72
s_add_u32 s42, s42, 49152
s_add_u32 s43, s43, 1
s_cmp_eq_u32 s43, 3
s_cselect_b32 s45, 147456, 0
s_cselect_b32 s43, 0, s43
s_sub_u32 s42, s42, s45
s_add_u32 m0, s42, 0
s_add_u32 s44, s40, 0
buffer_load_dwordx4 v2, s[4:7], s44 offen lds
s_add_u32 m0, s42, 4096
s_add_u32 s44, s40, 40960
buffer_load_dwordx4 v2, s[4:7], s44 offen lds
s_add_u32 m0, s42, 8192
s_add_u32 s44, s40, 81920
buffer_load_dwordx4 v2, s[4:7], s44 offen lds
s_add_u32 m0, s42, 12288
s_add_u32 s44, s40, 122880
buffer_load_dwordx4 v2, s[4:7], s44 offen lds
s_add_u32 m0, s42, 16384
s_add_u32 s44, s41, 0
buffer_load_dwordx4 v3, s[8:11], s44 offen lds
s_add_u32 m0, s42, 20480
s_add_u32 s44, s41, 110592
buffer_load_dwordx4 v3, s[8:11], s44 offen lds
s_add_u32 m0, s42, 24576
s_add_u32 s44, s41, 128
buffer_load_dwordx4 v3, s[8:11], s44 offen lds
s_add_u32 m0, s42, 28672
s_add_u32 s44, s41, 110720
buffer_load_dwordx4 v3, s[8:11], s44 offen lds
s_add_u32 m0, s42, 32768
s_add_u32 s44, s41, 256
buffer_load_dwordx4 v3, s[8:11], s44 offen lds
s_add_u32 m0, s42, 36864
s_add_u32 s44, s41, 110848
buffer_load_dwordx4 v3, s[8:11], s44 offen lds
ds_read_b128 v[200:203], v212
ds_read_b128 v[208:211], v206 offset:512
s_waitcnt lgkmcnt(0)
v_dot2_f32_bf16 v204, v200, v208, v204
v_dot2_f32_bf16 v218, v201, v209, v218
v_dot2_f32_bf16 v204, v202, v210, v204
v_dot2_f32_bf16 v218, v203, v211, v218
s_waitcnt vmcnt(10)
s_barrier
s_add_u32 m0, s42, 40960
s_add_u32 s44, s41, 384
buffer_load_dwordx4 v3, s[8:11], s44 offen lds
s_add_u32 m0, s42, 45056
s_add_u32 s44, s41, 110976
buffer_load_dwordx4 v3, s[8:11], s44 offen lds
s_add_u32 s40, s40, 128
s_add_u32 s41, s41, 221184
s_add_u32 s78, s78, 1
s_cmp_eq_u32 s78, 10
s_cselect_b32 s79, 1280, 0
s_cselect_b32 s72, 2211840, 0
s_cselect_b32 s78, 0, s78
s_sub_u32 s40, s40, s79
s_sub_u32 s41, s41, s72
s_add_u32 s42, s42, 49152
s_add_u32 s43, s43, 1
s_cmp_eq_u32 s43, 3
s_cselect_b32 s45, 147456, 0
s_cselect_b32 s43, 0, s43
s_sub_u32 s42, s42, s45
s_add_u32 m0, s42, 0
s_add_u32 s44, s40, 0
buffer_load_dwordx4 v2, s[4:7], s44 offen lds
s_add_u32 m0, s42, 4096
s_add_u32 s44, s40, 40960
buffer_load_dwordx4 v2, s[4:7], s44 offen lds
s_add_u32 m0, s42, 8192
s_add_u32 s44, s40, 81920
buffer_load_dwordx4 v2, s[4:7], s44 offen lds
s_add_u32 m0, s42, 12288
s_add_u32 s44, s40, 122880
buffer_load_dwordx4 v2, s[4:7], s44 offen lds
s_add_u32 m0, s42, 16384
s_add_u32 s44, s41, 0
buffer_load_dwordx4 v3, s[8:11], s44 offen lds
s_add_u32 m0, s42, 20480
s_add_u32 s44, s41, 110592
buffer_load_dwordx4 v3, s[8:11], s44 offen lds
s_add_u32 m0, s42, 24576
s_add_u32 s44, s41, 128
buffer_load_dwordx4 v3, s[8:11], s44 offen lds
s_add_u32 m0, s42, 28672
s_add_u32 s44, s41, 110720
buffer_load_dwordx4 v3, s[8:11], s44 offen lds
s_add_u32 m0, s42, 32768
s_add_u32 s44, s41, 256
buffer_load_dwordx4 v3, s[8:11], s44 offen lds
s_add_u32 m0, s42, 36864
s_add_u32 s44, s41, 110848
buffer_load_dwordx4 v3, s[8:11], s44 offen lds
ds_read_b128 v[200:203], v213
ds_read_b128 v[208:211], v206 offset:640
s_waitcnt lgkmcnt(0)
v_dot2_f32_bf16 v204, v200, v208, v204
v_dot2_f32_bf16 v218, v201, v209, v218
v_dot2_f32_bf16 v204, v202, v210, v204
v_dot2_f32_bf16 v218, v203, v211, v218
s_waitcnt vmcnt(10)
s_barrier
s_add_u32 m0, s42, 40960
s_add_u32 s44, s41, 384
buffer_load_dwordx4 v3, s[8:11], s44 offen lds
s_add_u32 m0, s42, 45056
s_add_u32 s44, s41, 110976
buffer_load_dwordx4 v3, s[8:11], s44 offen lds
s_add_u32 s40, s40, 128
s_add_u32 s41, s41, 221184
s_add_u32 s78, s78, 1
s_cmp_eq_u32 s78, 10
s_cselect_b32 s79, 1280, 0
s_cselect_b32 s72, 2211840, 0
s_cselect_b32 s78, 0, s78
s_sub_u32 s40, s40, s79
s_sub_u32 s41, s41, s72
s_add_u32 s42, s42, 49152
s_add_u32 s43, s43, 1
s_cmp_eq_u32 s43, 3
s_cselect_b32 s45, 147456, 0
s_cselect_b32 s43, 0, s43
s_sub_u32 s42, s42, s45
s_add_u32 m0, s42, 0
s_add_u32 s44, s40, 0
buffer_load_dwordx4 v2, s[4:7], s44 offen lds
s_add_u32 m0, s42, 4096
s_add_u32 s44, s40, 40960
buffer_load_dwordx4 v2, s[4:7], s44 offen lds
s_add_u32 m0, s42, 8192
s_add_u32 s44, s40, 81920
buffer_load_dwordx4 v2, s[4:7], s44 offen lds
s_add_u32 m0, s42, 12288
s_add_u32 s44, s40, 122880
buffer_load_dwordx4 v2, s[4:7], s44 offen lds
s_add_u32 m0, s42, 16384
s_add_u32 s44, s41, 0
buffer_load_dwordx4 v3, s[8:11], s44 offen lds
s_add_u32 m0, s42, 20480
s_add_u32 s44, s41, 110592
buffer_load_dwordx4 v3, s[8:11], s44 offen lds
s_add_u32 m0, s42, 24576
s_add_u32 s44, s41, 128
buffer_load_dwordx4 v3, s[8:11], s44 offen lds
s_add_u32 m0, s42, 28672
s_add_u32 s44, s41, 110720
buffer_load_dwordx4 v3, s[8:11], s44 offen lds
s_add_u32 m0, s42, 32768
s_add_u32 s44, s41, 256
buffer_load_dwordx4 v3, s[8:11], s44 offen lds
s_add_u32 m0, s42, 36864
s_add_u32 s44, s41, 110848
buffer_load_dwordx4 v3, s[8:11], s44 offen lds
ds_read_b128 v[200:203], v207
ds_read_b128 v[208:211], v206 offset:768
s_waitcnt lgkmcnt(0)
v_dot2_f32_bf16 v204, v200, v208, v204
v_dot2_f32_bf16 v218, v201, v209, v218
v_dot2_f32_bf16 v204, v202, v210, v204
v_dot2_f32_bf16 v218, v203, v211, v218
s_waitcnt vmcnt(10)
s_barrier
s_add_u32 m0, s42, 40960
s_add_u32 s44, s41, 384
buffer_load_dwordx4 v3, s[8:11], s44 offen lds
s_add_u32 m0, s42, 45056
s_add_u32 s44, s41, 110976
buffer_load_dwordx4 v3, s[8:11], s44 offen lds
s_add_u32 s40, s40, 128
s_add_u32 s41, s41, 221184
s_add_u32 s78, s78, 1
s_cmp_eq_u32 s78, 10
s_cselect_b32 s79, 1280, 0
s_cselect_b32 s72, 2211840, 0
s_cselect_b32 s78, 0, s78
s_sub_u32 s40, s40, s79
s_sub_u32 s41, s41, s72
s_add_u32 s42, s42, 49152
s_add_u32 s43, s43, 1
s_cmp_eq_u32 s43, 3
s_cselect_b32 s45, 147456, 0
s_cselect_b32 s43, 0, s43
s_sub_u32 s42, s42, s45
s_add_u32 m0, s42, 0
s_add_u32 s44, s40, 0
buffer_load_dwordx4 v2, s[4:7], s44 offen lds
s_add_u32 m0, s42, 4096
s_add_u32 s44, s40, 40960
buffer_load_dwordx4 v2, s[4:7], s44 offen lds
s_add_u32 m0, s42, 8192
s_add_u32 s44, s40, 81920
buffer_load_dwordx4 v2, s[4:7], s44 offen lds
s_add_u32 m0, s42, 12288
s_add_u32 s44, s40, 122880
buffer_load_dwordx4 v2, s[4:7], s44 offen lds
s_add_u32 m0, s42, 16384
s_add_u32 s44, s41, 0
buffer_load_dwordx4 v3, s[8:11], s44 offen lds
s_add_u32 m0, s42, 20480
s_add_u32 s44, s41, 110592
buffer_load_dwordx4 v3, s[8:11], s44 offen lds
s_add_u32 m0, s42, 24576
s_add_u32 s44, s41, 128
buffer_load_dwordx4 v3, s[8:11], s44 offen lds
s_add_u32 m0, s42, 28672
s_add_u32 s44, s41, 110720
buffer_load_dwordx4 v3, s[8:11], s44 offen lds
s_add_u32 m0, s42, 32768
s_add_u32 s44, s41, 256
buffer_load_dwordx4 v3, s[8:11], s44 offen lds
s_add_u32 m0, s42, 36864
s_add_u32 s44, s41, 110848
buffer_load_dwordx4 v3, s[8:11], s44 offen lds
ds_read_b128 v[200:203], v212
ds_read_b128 v[208:211], v206 offset:896
s_waitcnt lgkmcnt(0)
v_dot2_f32_bf16 v204, v200, v208, v204
v_dot2_f32_bf16 v218, v201, v209, v218
v_dot2_f32_bf16 v204, v202, v210, v204
v_dot2_f32_bf16 v218, v203, v211, v218
s_waitcnt vmcnt(10)
s_barrier
s_add_u32 m0, s42, 40960
s_add_u32 s44, s41, 384
buffer_load_dwordx4 v3, s[8:11], s44 offen lds
s_add_u32 m0, s42, 45056
s_add_u32 s44, s41, 110976
buffer_load_dwordx4 v3, s[8:11], s44 offen lds
s_add_u32 s40, s40, 128
s_add_u32 s41, s41, 221184
s_add_u32 s78, s78, 1
s_cmp_eq_u32 s78, 10
s_cselect_b32 s79, 1280, 0
s_cselect_b32 s72, 2211840, 0
s_cselect_b32 s78, 0, s78
s_sub_u32 s40, s40, s79
s_sub_u32 s41, s41, s72
s_add_u32 s42, s42, 49152
s_add_u32 s43, s43, 1
s_cmp_eq_u32 s43, 3
s_cselect_b32 s45, 147456, 0
s_cselect_b32 s43, 0, s43
s_sub_u32 s42, s42, s45
s_cmp_eq_u32 s20, 7
s_cbranch_scc0 PT_3_N
v_lshlrev_b32 v236, 7, v0
s_mul_i32 s32, s21, 54
s_lshr_b32 s33, s24, 5
s_add_u32 s32, s32, s33
s_lshl_b32 s32, s32, 13
buffer_load_dword v237, v236, s[12:15], s32 offen
s_add_u32 s32, s32, 8192
buffer_load_dword v237, v236, s[12:15], s32 offen
s_add_u32 s32, s32, 8192
buffer_load_dword v237, v236, s[12:15], s32 offen
s_add_u32 s32, s32, 8192
buffer_load_dword v237, v236, s[12:15], s32 offen
s_add_u32 s32, s32, 8192
buffer_load_dword v237, v236, s[12:15], s32 offen
s_add_u32 s32, s32, 8192
buffer_load_dword v237, v236, s[12:15], s32 offen
s_add_u32 s32, s32, 8192
buffer_load_dword v237, v236, s[12:15], s32 offen
s_add_u32 s32, s32, 8192
s_lshl_b32 s32, s21, 2
s_lshr_b32 s33, s22, 2
s_and_b32 s33, s33, 3
s_add_u32 s32, s32, s33
s_lshl_b32 s34, s32, 6
s_add_u32 s34, s34, 16351232
s_mov_b64 s[76:77], exec
s_mov_b64 exec, 1
buffer_load_dword v237, v236, s[12:15], s34 offen
s_lshl_b32 s34, s32, 9
s_and_b32 s33, s22, 3
s_lshl_b32 s33, s33, 7
s_add_u32 s34, s34, s33
s_add_u32 s34, s34, 14680064
buffer_load_dword v237, v236, s[12:15], s34 offen
s_mov_b64 exec, s[76:77]
ds_read_b128 v[200:203], v213
ds_read_b128 v[208:211], v206 offset:1024
s_waitcnt lgkmcnt(0)
v_dot2_f32_bf16 v204, v200, v208, v204
v_dot2_f32_bf16 v218, v201, v209, v218
v_dot2_f32_bf16 v204, v202, v210, v204
v_dot2_f32_bf16 v218, v203, v211, v218
s_waitcnt vmcnt(9)
s_branch PT_3_E
PT_3_N:
ds_read_b128 v[200:203], v213
ds_read_b128 v[208:211], v206 offset:1024
s_waitcnt lgkmcnt(0)
v_dot2_f32_bf16 v204, v200, v208, v204
v_dot2_f32_bf16 v218, v201, v209, v218
v_dot2_f32_bf16 v204, v202, v210, v204
v_dot2_f32_bf16 v218, v203, v211, v218
s_waitcnt vmcnt(0)
PT_3_E:
s_barrier
ds_read_b128 v[200:203], v207
ds_read_b128 v[208:211], v206 offset:1152
s_waitcnt lgkmcnt(0)
v_dot2_f32_bf16 v204, v200, v208, v204
v_dot2_f32_bf16 v218, v201, v209, v218
v_dot2_f32_bf16 v204, v202, v210, v204
v_dot2_f32_bf16 v218, v203, v211, v218
s_nop 3
v_add_f32 v204, v204, v218
s_nop 1
v_add_f32_dpp v204, v204, v204 quad_perm:[1,0,3,2] row_mask:0xf bank_mask:0xf
s_nop 1
v_add_f32_dpp v204, v204, v204 quad_perm:[2,3,0,1] row_mask:0xf bank_mask:0xf
s_nop 1
v_add_f32_dpp v204, v204, v204 row_half_mirror row_mask:0xf bank_mask:0xf
v_mul_f32 v204, 0xbfb8aa3b, v204
v_exp_f32 v204, v204
s_nop 0
v_add_f32 v204, 1.0, v204
v_rcp_f32 v204, v204
s_barrier
v_mov_b32 v230, 159744
ds_read_b64 v[232:233], v230
s_waitcnt lgkmcnt(0)
v_readfirstlane_b32 s90, v232
v_readfirstlane_b32 s91, v233
v_and_b32 v205, 7, v0
v_cmp_eq_u32 vcc, 0, v205
s_and_saveexec_b64 s[76:77], vcc
s_cmp_eq_u32 s91, 1
s_cbranch_scc1 GS_4_F
buffer_store_dword v204, v214, s[12:15], 0 offen sc1
s_branch GS_4_E
GS_4_F:
buffer_store_dword v204, v214, s[12:15], 0 offen
GS_4_E:
s_mov_b64 exec, s[76:77]
s_and_b32 s23, s22, 3
s_lshr_b32 s24, s22, 2
s_cmp_eq_u32 s24, 2
s_cselect_b32 s25, 14, 13
s_load_dwordx2 s[60:61], s[0:1], 96
v_lshrrev_b32 v1, 3, v0
v_and_b32 v4, 7, v0
v_lshrrev_b32 v5, 4, v0
v_lshlrev_b32 v2, 4, v0
v_mul_u32_u24 v7, 1280, v1
s_lshl_b32 s42, s30, 10
s_mov_b32 s43, 0
v_and_b32 v6, 3, v5
v_lshlrev_b32 v6, 1, v6
v_xor_b32 v6, v4, v6
v_lshlrev_b32 v6, 4, v6
v_add_u32 v3, v6, v7
s_cmp_eq_u32 s24, 2
s_cselect_b32 s32, 0, 14
s_mul_i32 s40, s21, 27
s_add_u32 s40, s40, s32
s_lshl_b32 s40, s40, 14
s_lshl_b32 s33, s30, 10
s_add_u32 s40, s40, s33
s_lshl_b32 s41, s32, 6
s_lshl_b32 s33, s30, 3
s_add_u32 s41, s41, s33
s_mul_i32 s41, s41, 1280
s_mul_i32 s33, s23, 320
s_and_b32 s33, s33, 0xffffff80
s_add_u32 s41, s41, s33
s_waitcnt lgkmcnt(0)
s_mov_b32 s8, s60
s_and_b32 s9, s61, 0xffff
s_mov_b32 s10, 2211840
s_mov_b32 s11, 0x20000
s_mov_b32 s68, s40
s_mov_b32 s69, s41
s_mul_i32 s33, s23, s25
s_lshr_b32 s78, s33, 2
s_lshl_b32 s32, s78, 14
s_add_u32 s40, s68, s32
s_mul_i32 s32, s78, 81920
s_add_u32 s41, s69, s32
s_add_u32 m0, s42, 16384
s_add_u32 s44, s41, 0
buffer_load_dwordx4 v3, s[8:11], s44 offen lds
s_add_u32 m0, s42, 20480
s_add_u32 s44, s41, 40960
buffer_load_dwordx4 v3, s[8:11], s44 offen lds
s_add_u32 m0, s42, 24576
s_add_u32 s44, s41, 128
buffer_load_dwordx4 v3, s[8:11], s44 offen lds
s_add_u32 m0, s42, 28672
s_add_u32 s44, s41, 41088
buffer_load_dwordx4 v3, s[8:11], s44 offen lds
s_add_u32 m0, s42, 32768
s_add_u32 s44, s41, 256
buffer_load_dwordx4 v3, s[8:11], s44 offen lds
s_add_u32 m0, s42, 36864
s_add_u32 s44, s41, 41216
buffer_load_dwordx4 v3, s[8:11], s44 offen lds
s_mov_b32 s50, s40
s_mov_b32 s51, s42
s_add_u32 s78, s78, 1
s_cmp_eq_u32 s78, s25
s_cselect_b32 s78, 0, s78
s_lshl_b32 s32, s78, 14
s_add_u32 s40, s68, s32
s_mul_i32 s32, s78, 81920
s_add_u32 s41, s69, s32
s_add_u32 s42, s42, 40960
s_add_u32 s43, s43, 1
s_cmp_eq_u32 s43, 3
s_cselect_b32 s45, 122880, 0
s_cselect_b32 s43, 0, s43
s_sub_u32 s42, s42, s45
s_add_u32 m0, s42, 16384
s_add_u32 s44, s41, 0
buffer_load_dwordx4 v3, s[8:11], s44 offen lds
s_add_u32 m0, s42, 20480
s_add_u32 s44, s41, 40960
buffer_load_dwordx4 v3, s[8:11], s44 offen lds
s_add_u32 m0, s42, 24576
s_add_u32 s44, s41, 128
buffer_load_dwordx4 v3, s[8:11], s44 offen lds
s_add_u32 m0, s42, 28672
s_add_u32 s44, s41, 41088
buffer_load_dwordx4 v3, s[8:11], s44 offen lds
s_add_u32 m0, s42, 32768
s_add_u32 s44, s41, 256
buffer_load_dwordx4 v3, s[8:11], s44 offen lds
s_add_u32 m0, s42, 36864
s_add_u32 s44, s41, 41216
buffer_load_dwordx4 v3, s[8:11], s44 offen lds
s_waitcnt vmcnt(0)
s_barrier
s_lshl_b32 s32, s21, 2
s_add_u32 s32, s32, s24
s_lshl_b32 s32, s32, 6
s_add_u32 s32, s32, 16351232
s_mov_b64 s[76:77], exec
s_mov_b64 exec, 1
v_mov_b32 v16, s90
s_lshl_b32 s33, s23, 2
v_mov_b32 v17, s33
s_cmp_eq_u32 s30, 0
s_cbranch_scc0 P2FPF_5_NF
s_cmp_eq_u32 s91, 1
s_cbranch_scc1 P2FPF_5_FF
buffer_store_dword v16, v17, s[12:15], s32 offen sc1
s_branch P2FPF_5_NF
P2FPF_5_FF:
buffer_store_dword v16, v17, s[12:15], s32 offen
P2FPF_5_NF:
v_mov_b32 v17, 0
s_mov_b32 s36, 0
P2FPF_5_P:
buffer_load_dwordx4 v[20:23], v17, s[12:15], s32 offen sc1
s_waitcnt vmcnt(0)
s_mov_b32 s35, 1
v_readfirstlane_b32 s37, v20
s_cmp_eq_u32 s37, s90
s_cselect_b32 s35, s35, 0
v_readfirstlane_b32 s37, v21
s_cmp_eq_u32 s37, s90
s_cselect_b32 s35, s35, 0
v_readfirstlane_b32 s37, v22
s_cmp_eq_u32 s37, s90
s_cselect_b32 s35, s35, 0
v_readfirstlane_b32 s37, v23
s_cmp_eq_u32 s37, s90
s_cselect_b32 s35, s35, 0
s_cmp_eq_u32 s35, 1
s_cbranch_scc1 P2FPF_5_D
s_add_u32 s36, s36, 1
s_cmp_lt_u32 s36, 0x4000
s_cbranch_scc0 P2FPF_5_D
s_branch P2FPF_5_P
P2FPF_5_D:
s_mov_b64 exec, s[76:77]
s_add_u32 m0, s51, 0
s_add_u32 s44, s50, 0
buffer_load_dwordx4 v2, s[12:15], s44 offen sc1 lds
s_add_u32 m0, s51, 4096
s_add_u32 s44, s50, 4096
buffer_load_dwordx4 v2, s[12:15], s44 offen sc1 lds
s_add_u32 m0, s51, 8192
s_add_u32 s44, s50, 8192
buffer_load_dwordx4 v2, s[12:15], s44 offen sc1 lds
s_add_u32 m0, s51, 12288
s_add_u32 s44, s50, 12288
buffer_load_dwordx4 v2, s[12:15], s44 offen sc1 lds
s_add_u32 m0, s42, 0
s_add_u32 s44, s40, 0
buffer_load_dwordx4 v2, s[12:15], s44 offen sc1 lds
s_add_u32 m0, s42, 4096
s_add_u32 s44, s40, 4096
buffer_load_dwordx4 v2, s[12:15], s44 offen sc1 lds
s_add_u32 m0, s42, 8192
s_add_u32 s44, s40, 8192
buffer_load_dwordx4 v2, s[12:15], s44 offen sc1 lds
s_add_u32 m0, s42, 12288
s_add_u32 s44, s40, 12288
buffer_load_dwordx4 v2, s[12:15], s44 offen sc1 lds
s_waitcnt vmcnt(4)
s_barrier
s_add_u32 s78, s78, 1
s_cmp_eq_u32 s78, s25
s_cselect_b32 s78, 0, s78
s_lshl_b32 s32, s78, 14
s_add_u32 s40, s68, s32
s_mul_i32 s32, s78, 81920
s_add_u32 s41, s69, s32
s_add_u32 s42, s42, 40960
s_add_u32 s43, s43, 1
s_cmp_eq_u32 s43, 3
s_cselect_b32 s45, 122880, 0
s_cselect_b32 s43, 0, s43
s_sub_u32 s42, s42, s45
s_add_u32 m0, s42, 16384
s_add_u32 s44, s41, 0
buffer_load_dwordx4 v3, s[8:11], s44 offen lds
s_add_u32 m0, s42, 20480
s_add_u32 s44, s41, 40960
buffer_load_dwordx4 v3, s[8:11], s44 offen lds
s_add_u32 m0, s42, 24576
s_add_u32 s44, s41, 128
buffer_load_dwordx4 v3, s[8:11], s44 offen lds
s_add_u32 m0, s42, 28672
s_add_u32 s44, s41, 41088
buffer_load_dwordx4 v3, s[8:11], s44 offen lds
s_add_u32 m0, s42, 32768
s_add_u32 s44, s41, 256
buffer_load_dwordx4 v3, s[8:11], s44 offen lds
s_add_u32 m0, s42, 36864
s_add_u32 s44, s41, 41216
buffer_load_dwordx4 v3, s[8:11], s44 offen lds
s_add_u32 m0, s42, 0
s_add_u32 s44, s40, 0
buffer_load_dwordx4 v2, s[12:15], s44 offen sc1 lds
s_add_u32 m0, s42, 4096
s_add_u32 s44, s40, 4096
buffer_load_dwordx4 v2, s[12:15], s44 offen sc1 lds
s_add_u32 m0, s42, 8192
s_add_u32 s44, s40, 8192
buffer_load_dwordx4 v2, s[12:15], s44 offen sc1 lds
s_add_u32 m0, s42, 12288
s_add_u32 s44, s40, 12288
buffer_load_dwordx4 v2, s[12:15], s44 offen sc1 lds
s_waitcnt vmcnt(10)
s_barrier
s_sub_u32 s49, s25, 3
P2F_LL:
s_add_u32 s78, s78, 1
s_cmp_eq_u32 s78, s25
s_cselect_b32 s78, 0, s78
s_lshl_b32 s32, s78, 14
s_add_u32 s40, s68, s32
s_mul_i32 s32, s78, 81920
s_add_u32 s41, s69, s32
s_add_u32 s42, s42, 40960
s_add_u32 s43, s43, 1
s_cmp_eq_u32 s43, 3
s_cselect_b32 s45, 122880, 0
s_cselect_b32 s43, 0, s43
s_sub_u32 s42, s42, s45
s_add_u32 m0, s42, 16384
s_add_u32 s44, s41, 0
buffer_load_dwordx4 v3, s[8:11], s44 offen lds
s_add_u32 m0, s42, 20480
s_add_u32 s44, s41, 40960
buffer_load_dwordx4 v3, s[8:11], s44 offen lds
s_add_u32 m0, s42, 24576
s_add_u32 s44, s41, 128
buffer_load_dwordx4 v3, s[8:11], s44 offen lds
s_add_u32 m0, s42, 28672
s_add_u32 s44, s41, 41088
buffer_load_dwordx4 v3, s[8:11], s44 offen lds
s_add_u32 m0, s42, 32768
s_add_u32 s44, s41, 256
buffer_load_dwordx4 v3, s[8:11], s44 offen lds
s_add_u32 m0, s42, 36864
s_add_u32 s44, s41, 41216
buffer_load_dwordx4 v3, s[8:11], s44 offen lds
s_add_u32 m0, s42, 0
s_add_u32 s44, s40, 0
buffer_load_dwordx4 v2, s[12:15], s44 offen sc1 lds
s_add_u32 m0, s42, 4096
s_add_u32 s44, s40, 4096
buffer_load_dwordx4 v2, s[12:15], s44 offen sc1 lds
s_add_u32 m0, s42, 8192
s_add_u32 s44, s40, 8192
buffer_load_dwordx4 v2, s[12:15], s44 offen sc1 lds
s_add_u32 m0, s42, 12288
s_add_u32 s44, s40, 12288
buffer_load_dwordx4 v2, s[12:15], s44 offen sc1 lds
s_waitcnt vmcnt(10)
s_barrier
s_sub_u32 s49, s49, 1
s_cmp_lg_u32 s49, 0
s_cbranch_scc1 P2F_LL
s_waitcnt vmcnt(0)
s_barrier
s_cmp_lg_u32 s2, 0
s_cbranch_scc1 EU_6_E
s_cmp_lg_u32 s20, 5
s_cbranch_scc1 EU_6_E
v_lshlrev_b32 v4, 7, v0
v_add_u32 v4, 16318464, v4
s_mov_b32 s36, 0
EU_6_T:
buffer_load_dwordx4 v[8:11], v4, s[12:15], 0 offen sc1
buffer_load_dwordx4 v[12:15], v4, s[12:15], 0 offen offset:16 sc1
s_waitcnt vmcnt(0)
v_cmp_eq_u32 vcc, s90, v8
v_cmp_eq_u32 s[32:33], s90, v10
v_cmp_eq_u32 s[34:35], s90, v12
v_cmp_eq_u32 s[76:77], s90, v14
s_nop 1
s_and_b64 vcc, vcc, s[32:33]
s_and_b64 s[34:35], s[34:35], s[76:77]
s_and_b64 vcc, vcc, s[34:35]
s_cmp_eq_u64 vcc, -1
s_cbranch_scc1 EU_6_OK
s_add_u32 s36, s36, 1
s_cmp_lt_u32 s36, 0x4000
s_cbranch_scc1 EU_6_T
EU_6_OK:
v_mov_b32 v4, 16252928
v_mov_b32 v5, s90
s_mov_b64 exec, 1
buffer_store_dword v5, v4, s[12:15], 0 offen sc1
s_mov_b64 exec, -1
EU_6_E:
s_branch FIN
R_SSM:
s_mov_b32 s8, s60
s_and_b32 s9, s61, 0xffff
s_mov_b32 s10, 819200
s_mov_b32 s11, 0x20000
s_cmp_ge_u32 s20, 4
s_cbranch_scc0 R_SSM_C
s_mov_b32 s56, s62
s_and_b32 s57, s63, 0xffff
s_mov_b32 s58, 819200
s_mov_b32 s59, 0x20000
s_mov_b32 s16, s64
s_and_b32 s17, s65, 0xffff
s_mov_b32 s18, 1280
s_mov_b32 s19, 0x20000
s_mov_b32 s48, s66
s_and_b32 s49, s67, 0xffff
s_mov_b32 s50, 1280
s_mov_b32 s51, 0x20000
s_mov_b32 s52, s68
s_and_b32 s53, s69, 0xffff
s_mov_b32 s54, 1280
s_mov_b32 s55, 0x20000
s_sub_u32 s30, s20, 4
s_setprio 2
v_lshrrev_b32 v1, 3, v0
v_and_b32 v4, 7, v0
v_lshrrev_b32 v5, 4, v0
v_mul_u32_u24 v7, 1280, v1
s_lshl_b32 s32, s21, 7
s_lshl_b32 s33, s30, 3
s_add_u32 s32, s32, s33
s_mul_i32 s40, s32, 1280
s_and_b32 s31, s30, 1
s_cmp_eq_u32 s31, 1
s_cselect_b32 s8, s56, s8
s_cselect_b32 s9, s57, s9
s_lshr_b32 s32, s30, 1
s_lshl_b32 s32, s32, 1
v_and_b32 v6, 1, v5
v_or_b32 v6, s32, v6
v_xor_b32 v6, v4, v6
v_lshlrev_b32 v6, 4, v6
v_add_u32 v2, v6, v7
v_xor_b32 v8, 64, v2
v_and_b32 v6, 6, v1
v_or_b32 v6, s31, v6
v_xor_b32 v6, v4, v6
v_lshlrev_b32 v6, 4, v6
v_add_u32 v3, v6, v7
s_mul_i32 s41, s22, 80
s_lshr_b32 s33, s30, 1
s_lshl_b32 s34, s33, 3
s_add_u32 s41, s41, s34
s_mul_i32 s41, s41, 1280
s_lshl_b32 s42, s30, 10
s_mul_i32 s46, s31, 10240
s_lshl_b32 s34, s33, 10
s_add_u32 s46, s46, s34
s_add_u32 s46, s46, 16384
s_mov_b32 s47, 0
s_mov_b32 s43, 0
s_and_b32 s32, s21, 3
s_mul_i32 s32, s32, 5
s_lshr_b32 s32, s32, 1
s_and_b32 s33, s22, 7
s_add_u32 s73, s32, s33
s_cmp_ge_u32 s73, 10
s_cselect_b32 s32, 10, 0
s_sub_u32 s73, s73, s32
s_mov_b32 s78, s73
s_lshl_b32 s32, s73, 7
s_add_u32 s40, s40, s32
s_mul_i32 s32, s73, 128
s_add_u32 s41, s41, s32
s_add_u32 s44, s42, s47
s_add_u32 m0, s44, 0
s_add_u32 s44, s40, 0
buffer_load_dwordx4 v2, s[4:7], s44 offen lds
s_add_u32 s44, s42, s47
s_add_u32 m0, s44, 4096
s_add_u32 s44, s40, 40960
buffer_load_dwordx4 v8, s[4:7], s44 offen lds
s_add_u32 s44, s42, s47
s_add_u32 m0, s44, 8192
s_add_u32 s44, s40, 81920
buffer_load_dwordx4 v2, s[4:7], s44 offen lds
s_add_u32 s44, s42, s47
s_add_u32 m0, s44, 12288
s_add_u32 s44, s40, 122880
buffer_load_dwordx4 v8, s[4:7], s44 offen lds
s_add_u32 s44, s46, s47
s_add_u32 m0, s44, 0
s_add_u32 s44, s41, 0
buffer_load_dwordx4 v3, s[8:11], s44 offen lds
s_add_u32 s44, s46, s47
s_add_u32 m0, s44, 2048
s_add_u32 s44, s41, 20480
buffer_load_dwordx4 v3, s[8:11], s44 offen lds
s_add_u32 s44, s46, s47
s_add_u32 m0, s44, 4096
s_add_u32 s44, s41, 40960
buffer_load_dwordx4 v3, s[8:11], s44 offen lds
s_add_u32 s44, s46, s47
s_add_u32 m0, s44, 6144
s_add_u32 s44, s41, 61440
buffer_load_dwordx4 v3, s[8:11], s44 offen lds
s_add_u32 s44, s46, s47
s_add_u32 m0, s44, 8192
s_add_u32 s44, s41, 81920
buffer_load_dwordx4 v3, s[8:11], s44 offen lds
s_cmp_eq_u32 s30, 3
s_cbranch_scc0 GD_7
v_lshlrev_b32 v205, 4, v0
s_movk_i32 s32, 1024
s_mov_b32 m0, 155648
s_nop 0
buffer_load_dwordx4 v205, s[80:83], 0 offen lds
s_mov_b32 m0, 156672
s_mov_b64 s[76:77], exec
s_mov_b64 exec, 0xffff
buffer_load_dwordx4 v205, s[80:83], s32 offen lds
s_mov_b64 exec, s[76:77]
s_mov_b32 m0, 156928
s_nop 0
buffer_load_dwordx4 v205, s[80:83], 0 offen lds
s_mov_b32 m0, 157952
s_mov_b64 s[76:77], exec
s_mov_b64 exec, 0xffff
buffer_load_dwordx4 v205, s[80:83], s32 offen lds
s_mov_b64 exec, s[76:77]
GD_7:
s_and_b32 s32, s22, 3
s_lshl_b32 s32, s32, 2
s_add_u32 s32, s32, s30
s_lshr_b32 s32, s32, 1
s_and_b32 s32, s32, 3
s_lshl_b32 s32, s32, 1
v_and_b32 v215, 1, v5
v_or_b32 v215, s32, v215
s_and_b32 s32, s22, 3
s_lshl_b32 s32, s32, 2
s_add_u32 s32, s32, s30
s_lshl_b32 s33, s32, 10
s_lshl_b32 s35, s32, 3
v_lshlrev_b32 v207, 4, v0
v_add_u32 v207, s33, v207
v_add_u32 v212, 36864, v207
v_add_u32 v213, 73728, v207
v_and_b32 v206, 7, v0
v_xor_b32 v206, v206, v215
v_lshlrev_b32 v206, 4, v206
v_add_u32 v206, 155648, v206
s_lshl_b32 s32, s73, 7
v_add_u32 v206, s32, v206
v_mov_b32 v204, 0
v_mov_b32 v218, 0
s_lshr_b32 s33, s22, 2
s_and_b32 s33, s33, 3
s_lshl_b32 s34, s21, 2
s_add_u32 s34, s34, s33
s_lshl_b32 s34, s34, 7
s_add_u32 s34, s34, s35
s_lshl_b32 s34, s34, 2
s_add_u32 s34, s34, 14680064
v_lshrrev_b32 v214, 3, v0
v_lshlrev_b32 v214, 2, v214
v_add_u32 v214, s34, v214
s_lshl_b32 s32, s30, 6
v_add_u32 v10, s32, v0
v_lshrrev_b32 v11, 1, v10
s_mul_i32 s32, s22, 80
v_add_u32 v11, s32, v11
v_lshlrev_b32 v11, 1, v11
buffer_load_ushort v20, v11, s[16:19], 0 offen
buffer_load_ushort v21, v11, s[48:51], 0 offen
buffer_load_ushort v22, v11, s[52:55], 0 offen
s_add_u32 s40, s40, 128
s_add_u32 s41, s41, 128
s_add_u32 s78, s78, 1
s_cmp_eq_u32 s78, 10
s_cselect_b32 s79, 1280, 0
s_cselect_b32 s72, 1280, 0
s_cselect_b32 s78, 0, s78
s_sub_u32 s40, s40, s79
s_sub_u32 s41, s41, s72
s_add_u32 s47, s47, 36864
s_add_u32 s43, s43, 1
s_cmp_eq_u32 s43, 3
s_cselect_b32 s45, 110592, 0
s_cselect_b32 s43, 0, s43
s_sub_u32 s47, s47, s45
s_add_u32 s44, s42, s47
s_add_u32 m0, s44, 0
s_add_u32 s44, s40, 0
buffer_load_dwordx4 v2, s[4:7], s44 offen lds
s_add_u32 s44, s42, s47
s_add_u32 m0, s44, 4096
s_add_u32 s44, s40, 40960
buffer_load_dwordx4 v8, s[4:7], s44 offen lds
s_add_u32 s44, s42, s47
s_add_u32 m0, s44, 8192
s_add_u32 s44, s40, 81920
buffer_load_dwordx4 v2, s[4:7], s44 offen lds
s_add_u32 s44, s42, s47
s_add_u32 m0, s44, 12288
s_add_u32 s44, s40, 122880
buffer_load_dwordx4 v8, s[4:7], s44 offen lds
s_add_u32 s44, s46, s47
s_add_u32 m0, s44, 0
s_add_u32 s44, s41, 0
buffer_load_dwordx4 v3, s[8:11], s44 offen lds
s_add_u32 s44, s46, s47
s_add_u32 m0, s44, 2048
s_add_u32 s44, s41, 20480
buffer_load_dwordx4 v3, s[8:11], s44 offen lds
s_add_u32 s44, s46, s47
s_add_u32 m0, s44, 4096
s_add_u32 s44, s41, 40960
buffer_load_dwordx4 v3, s[8:11], s44 offen lds
s_add_u32 s44, s46, s47
s_add_u32 m0, s44, 6144
s_add_u32 s44, s41, 61440
buffer_load_dwordx4 v3, s[8:11], s44 offen lds
s_add_u32 s44, s46, s47
s_add_u32 m0, s44, 8192
s_add_u32 s44, s41, 81920
buffer_load_dwordx4 v3, s[8:11], s44 offen lds
s_waitcnt vmcnt(9)
s_barrier
s_add_u32 s40, s40, 128
s_add_u32 s41, s41, 128
s_add_u32 s78, s78, 1
s_cmp_eq_u32 s78, 10
s_cselect_b32 s79, 1280, 0
s_cselect_b32 s72, 1280, 0
s_cselect_b32 s78, 0, s78
s_sub_u32 s40, s40, s79
s_sub_u32 s41, s41, s72
s_add_u32 s47, s47, 36864
s_add_u32 s43, s43, 1
s_cmp_eq_u32 s43, 3
s_cselect_b32 s45, 110592, 0
s_cselect_b32 s43, 0, s43
s_sub_u32 s47, s47, s45
s_add_u32 s44, s42, s47
s_add_u32 m0, s44, 0
s_add_u32 s44, s40, 0
buffer_load_dwordx4 v2, s[4:7], s44 offen lds
s_add_u32 s44, s42, s47
s_add_u32 m0, s44, 4096
s_add_u32 s44, s40, 40960
buffer_load_dwordx4 v8, s[4:7], s44 offen lds
s_add_u32 s44, s42, s47
s_add_u32 m0, s44, 8192
s_add_u32 s44, s40, 81920
buffer_load_dwordx4 v2, s[4:7], s44 offen lds
s_add_u32 s44, s42, s47
s_add_u32 m0, s44, 12288
s_add_u32 s44, s40, 122880
buffer_load_dwordx4 v8, s[4:7], s44 offen lds
s_add_u32 s44, s46, s47
s_add_u32 m0, s44, 0
s_add_u32 s44, s41, 0
buffer_load_dwordx4 v3, s[8:11], s44 offen lds
s_add_u32 s44, s46, s47
s_add_u32 m0, s44, 2048
s_add_u32 s44, s41, 20480
buffer_load_dwordx4 v3, s[8:11], s44 offen lds
s_add_u32 s44, s46, s47
s_add_u32 m0, s44, 4096
s_add_u32 s44, s41, 40960
buffer_load_dwordx4 v3, s[8:11], s44 offen lds
s_add_u32 s44, s46, s47
s_add_u32 m0, s44, 6144
s_add_u32 s44, s41, 61440
buffer_load_dwordx4 v3, s[8:11], s44 offen lds
s_add_u32 s44, s46, s47
s_add_u32 m0, s44, 8192
s_add_u32 s44, s41, 81920
buffer_load_dwordx4 v3, s[8:11], s44 offen lds
ds_read_b128 v[200:203], v207
ds_read_b128 v[208:211], v206 offset:0
s_waitcnt lgkmcnt(0)
v_dot2_f32_bf16 v204, v200, v208, v204
v_dot2_f32_bf16 v218, v201, v209, v218
v_dot2_f32_bf16 v204, v202, v210, v204
v_dot2_f32_bf16 v218, v203, v211, v218
v_lshlrev_b32 v20, 16, v20
v_lshlrev_b32 v21, 16, v21
v_lshlrev_b32 v22, 16, v22
v_mul_f32 v22, 0x3fb8aa3b, v22
v_exp_f32 v22, v22
s_nop 0
v_cvt_pk_bf16_f32 v22, v22, v22
v_lshlrev_b32 v22, 16, v22
v_mul_f32 v30, v22, v20
v_mul_f32 v31, v22, v21
v_mul_f32 v30, 0x3fb8aa3b, v30
v_exp_f32 v30, v30
v_mul_f32 v31, 0.15915494, v31
v_fract_f32 v31, v31
s_nop 0
v_cos_f32 v32, v31
v_sin_f32 v33, v31
s_nop 0
v_mul_f32 v23, v30, v32
v_mul_f32 v24, v30, v33
v_and_b32 v27, 1, v0
v_cvt_f32_u32 v27, v27
v_fma_f32 v27, v27, 2.0, -1.0
v_add_f32 v30, -1.0, v23
v_mul_f32 v31, v20, v20
v_fmac_f32 v31, v21, v21
v_rcp_f32 v31, v31
v_mul_f32 v32, v30, v20
v_fmac_f32 v32, v24, v21
v_mul_f32 v33, v24, v20
v_fma_f32 v33, -v30, v21, v33
v_add_f32 v31, v31, v31
v_mul_f32 v32, v32, v31
v_mul_f32 v33, v33, v31
v_mov_b32 v36, v23
v_mul_f32 v37, v27, v24
v_mul_f32 v38, v27, v32
v_sub_f32 v38, 0, v38
v_sub_f32 v39, 0, v33
v_lshlrev_b32 v12, 4, v10
v_add_u32 v12, 133120, v12
v_cmp_gt_u32 vcc, 160, v10
s_and_saveexec_b64 s[74:75], vcc
s_cbranch_execz SSM_KT_SKIP
ds_write_b128 v12, v[36:39]
SSM_KT_SKIP:
s_mov_b64 exec, s[74:75]
s_waitcnt vmcnt(9)
s_barrier
s_add_u32 s40, s40, 128
s_add_u32 s41, s41, 128
s_add_u32 s78, s78, 1
s_cmp_eq_u32 s78, 10
s_cselect_b32 s79, 1280, 0
s_cselect_b32 s72, 1280, 0
s_cselect_b32 s78, 0, s78
s_sub_u32 s40, s40, s79
s_sub_u32 s41, s41, s72
s_add_u32 s47, s47, 36864
s_add_u32 s43, s43, 1
s_cmp_eq_u32 s43, 3
s_cselect_b32 s45, 110592, 0
s_cselect_b32 s43, 0, s43
s_sub_u32 s47, s47, s45
s_add_u32 s44, s42, s47
s_add_u32 m0, s44, 0
s_add_u32 s44, s40, 0
buffer_load_dwordx4 v2, s[4:7], s44 offen lds
s_add_u32 s44, s42, s47
s_add_u32 m0, s44, 4096
s_add_u32 s44, s40, 40960
buffer_load_dwordx4 v8, s[4:7], s44 offen lds
s_add_u32 s44, s42, s47
s_add_u32 m0, s44, 8192
s_add_u32 s44, s40, 81920
buffer_load_dwordx4 v2, s[4:7], s44 offen lds
s_add_u32 s44, s42, s47
s_add_u32 m0, s44, 12288
s_add_u32 s44, s40, 122880
buffer_load_dwordx4 v8, s[4:7], s44 offen lds
s_add_u32 s44, s46, s47
s_add_u32 m0, s44, 0
s_add_u32 s44, s41, 0
buffer_load_dwordx4 v3, s[8:11], s44 offen lds
s_add_u32 s44, s46, s47
s_add_u32 m0, s44, 2048
s_add_u32 s44, s41, 20480
buffer_load_dwordx4 v3, s[8:11], s44 offen lds
s_add_u32 s44, s46, s47
s_add_u32 m0, s44, 4096
s_add_u32 s44, s41, 40960
buffer_load_dwordx4 v3, s[8:11], s44 offen lds
s_add_u32 s44, s46, s47
s_add_u32 m0, s44, 6144
s_add_u32 s44, s41, 61440
buffer_load_dwordx4 v3, s[8:11], s44 offen lds
s_add_u32 s44, s46, s47
s_add_u32 m0, s44, 8192
s_add_u32 s44, s41, 81920
buffer_load_dwordx4 v3, s[8:11], s44 offen lds
ds_read_b128 v[200:203], v212
ds_read_b128 v[208:211], v206 offset:128
s_waitcnt lgkmcnt(0)
v_dot2_f32_bf16 v204, v200, v208, v204
v_dot2_f32_bf16 v218, v201, v209, v218
v_dot2_f32_bf16 v204, v202, v210, v204
v_dot2_f32_bf16 v218, v203, v211, v218
v_mul_f32 v30, v23, v24
v_mul_f32 v23, v23, v23
v_fma_f32 v23, -v24, v24, v23
v_add_f32 v24, v30, v30
v_mul_f32 v30, v23, v24
v_mul_f32 v23, v23, v23
v_fma_f32 v23, -v24, v24, v23
v_add_f32 v24, v30, v30
v_mul_f32 v30, v23, v24
v_mul_f32 v23, v23, v23
v_fma_f32 v23, -v24, v24, v23
v_add_f32 v24, v30, v30
v_mul_f32 v30, v23, v24
v_mul_f32 v23, v23, v23
v_fma_f32 v23, -v24, v24, v23
v_add_f32 v24, v30, v30
v_mov_b32 v101, v23
v_mov_b32 v109, v24
v_mul_f32 v102, v101, v101
v_mul_f32 v110, v101, v109
s_waitcnt vmcnt(9)
s_barrier
s_add_u32 s40, s40, 128
s_add_u32 s41, s41, 128
s_add_u32 s78, s78, 1
s_cmp_eq_u32 s78, 10
s_cselect_b32 s79, 1280, 0
s_cselect_b32 s72, 1280, 0
s_cselect_b32 s78, 0, s78
s_sub_u32 s40, s40, s79
s_sub_u32 s41, s41, s72
s_add_u32 s47, s47, 36864
s_add_u32 s43, s43, 1
s_cmp_eq_u32 s43, 3
s_cselect_b32 s45, 110592, 0
s_cselect_b32 s43, 0, s43
s_sub_u32 s47, s47, s45
s_add_u32 s44, s42, s47
s_add_u32 m0, s44, 0
s_add_u32 s44, s40, 0
buffer_load_dwordx4 v2, s[4:7], s44 offen lds
s_add_u32 s44, s42, s47
s_add_u32 m0, s44, 4096
s_add_u32 s44, s40, 40960
buffer_load_dwordx4 v8, s[4:7], s44 offen lds
s_add_u32 s44, s42, s47
s_add_u32 m0, s44, 8192
s_add_u32 s44, s40, 81920
buffer_load_dwordx4 v2, s[4:7], s44 offen lds
s_add_u32 s44, s42, s47
s_add_u32 m0, s44, 12288
s_add_u32 s44, s40, 122880
buffer_load_dwordx4 v8, s[4:7], s44 offen lds
s_add_u32 s44, s46, s47
s_add_u32 m0, s44, 0
s_add_u32 s44, s41, 0
buffer_load_dwordx4 v3, s[8:11], s44 offen lds
s_add_u32 s44, s46, s47
s_add_u32 m0, s44, 2048
s_add_u32 s44, s41, 20480
buffer_load_dwordx4 v3, s[8:11], s44 offen lds
s_add_u32 s44, s46, s47
s_add_u32 m0, s44, 4096
s_add_u32 s44, s41, 40960
buffer_load_dwordx4 v3, s[8:11], s44 offen lds
s_add_u32 s44, s46, s47
s_add_u32 m0, s44, 6144
s_add_u32 s44, s41, 61440
buffer_load_dwordx4 v3, s[8:11], s44 offen lds
s_add_u32 s44, s46, s47
s_add_u32 m0, s44, 8192
s_add_u32 s44, s41, 81920
buffer_load_dwordx4 v3, s[8:11], s44 offen lds
ds_read_b128 v[200:203], v213
ds_read_b128 v[208:211], v206 offset:256
s_waitcnt lgkmcnt(0)
v_dot2_f32_bf16 v204, v200, v208, v204
v_dot2_f32_bf16 v218, v201, v209, v218
v_dot2_f32_bf16 v204, v202, v210, v204
v_dot2_f32_bf16 v218, v203, v211, v218
v_fma_f32 v102, -v109, v109, v102
v_fmac_f32 v110, v109, v101
v_mul_f32 v103, v102, v101
v_mul_f32 v111, v102, v109
v_fma_f32 v103, -v110, v109, v103
v_fmac_f32 v111, v110, v101
v_mul_f32 v104, v103, v101
v_mul_f32 v112, v103, v109
v_fma_f32 v104, -v111, v109, v104
v_fmac_f32 v112, v111, v101
v_mul_f32 v105, v104, v101
v_mul_f32 v113, v104, v109
v_fma_f32 v105, -v112, v109, v105
v_fmac_f32 v113, v112, v101
v_mul_f32 v106, v105, v101
v_mul_f32 v114, v105, v109
v_fma_f32 v106, -v113, v109, v106
v_fmac_f32 v114, v113, v101
v_mul_f32 v107, v106, v101
v_mul_f32 v115, v106, v109
s_waitcnt vmcnt(9)
s_barrier
s_add_u32 s40, s40, 128
s_add_u32 s41, s41, 128
s_add_u32 s78, s78, 1
s_cmp_eq_u32 s78, 10
s_cselect_b32 s79, 1280, 0
s_cselect_b32 s72, 1280, 0
s_cselect_b32 s78, 0, s78
s_sub_u32 s40, s40, s79
s_sub_u32 s41, s41, s72
s_add_u32 s47, s47, 36864
s_add_u32 s43, s43, 1
s_cmp_eq_u32 s43, 3
s_cselect_b32 s45, 110592, 0
s_cselect_b32 s43, 0, s43
s_sub_u32 s47, s47, s45
s_add_u32 s44, s42, s47
s_add_u32 m0, s44, 0
s_add_u32 s44, s40, 0
buffer_load_dwordx4 v2, s[4:7], s44 offen lds
s_add_u32 s44, s42, s47
s_add_u32 m0, s44, 4096
s_add_u32 s44, s40, 40960
buffer_load_dwordx4 v8, s[4:7], s44 offen lds
s_add_u32 s44, s42, s47
s_add_u32 m0, s44, 8192
s_add_u32 s44, s40, 81920
buffer_load_dwordx4 v2, s[4:7], s44 offen lds
s_add_u32 s44, s42, s47
s_add_u32 m0, s44, 12288
s_add_u32 s44, s40, 122880
buffer_load_dwordx4 v8, s[4:7], s44 offen lds
s_add_u32 s44, s46, s47
s_add_u32 m0, s44, 0
s_add_u32 s44, s41, 0
buffer_load_dwordx4 v3, s[8:11], s44 offen lds
s_add_u32 s44, s46, s47
s_add_u32 m0, s44, 2048
s_add_u32 s44, s41, 20480
buffer_load_dwordx4 v3, s[8:11], s44 offen lds
s_add_u32 s44, s46, s47
s_add_u32 m0, s44, 4096
s_add_u32 s44, s41, 40960
buffer_load_dwordx4 v3, s[8:11], s44 offen lds
s_add_u32 s44, s46, s47
s_add_u32 m0, s44, 6144
s_add_u32 s44, s41, 61440
buffer_load_dwordx4 v3, s[8:11], s44 offen lds
s_add_u32 s44, s46, s47
s_add_u32 m0, s44, 8192
s_add_u32 s44, s41, 81920
buffer_load_dwordx4 v3, s[8:11], s44 offen lds
ds_read_b128 v[200:203], v207
ds_read_b128 v[208:211], v206 offset:384
s_waitcnt lgkmcnt(0)
v_dot2_f32_bf16 v204, v200, v208, v204
v_dot2_f32_bf16 v218, v201, v209, v218
v_dot2_f32_bf16 v204, v202, v210, v204
v_dot2_f32_bf16 v218, v203, v211, v218
v_fma_f32 v107, -v114, v109, v107
v_fmac_f32 v115, v114, v101
v_mul_f32 v121, v107, v101
v_mul_f32 v137, v107, v109
v_fma_f32 v121, -v115, v109, v121
v_fmac_f32 v137, v115, v101
v_mul_f32 v122, v121, v121
v_mul_f32 v138, v121, v137
v_fma_f32 v122, -v137, v137, v122
v_fmac_f32 v138, v137, v121
v_mul_f32 v123, v122, v121
v_mul_f32 v139, v122, v137
v_fma_f32 v123, -v138, v137, v123
v_fmac_f32 v139, v138, v121
v_mul_f32 v124, v123, v121
v_mul_f32 v140, v123, v137
v_fma_f32 v124, -v139, v137, v124
v_fmac_f32 v140, v139, v121
v_mul_f32 v125, v124, v121
v_mul_f32 v141, v124, v137
s_waitcnt vmcnt(9)
s_barrier
s_add_u32 s40, s40, 128
s_add_u32 s41, s41, 128
s_add_u32 s78, s78, 1
s_cmp_eq_u32 s78, 10
s_cselect_b32 s79, 1280, 0
s_cselect_b32 s72, 1280, 0
s_cselect_b32 s78, 0, s78
s_sub_u32 s40, s40, s79
s_sub_u32 s41, s41, s72
s_add_u32 s47, s47, 36864
s_add_u32 s43, s43, 1
s_cmp_eq_u32 s43, 3
s_cselect_b32 s45, 110592, 0
s_cselect_b32 s43, 0, s43
s_sub_u32 s47, s47, s45
s_add_u32 s44, s42, s47
s_add_u32 m0, s44, 0
s_add_u32 s44, s40, 0
buffer_load_dwordx4 v2, s[4:7], s44 offen lds
s_add_u32 s44, s42, s47
s_add_u32 m0, s44, 4096
s_add_u32 s44, s40, 40960
buffer_load_dwordx4 v8, s[4:7], s44 offen lds
s_add_u32 s44, s42, s47
s_add_u32 m0, s44, 8192
s_add_u32 s44, s40, 81920
buffer_load_dwordx4 v2, s[4:7], s44 offen lds
s_add_u32 s44, s42, s47
s_add_u32 m0, s44, 12288
s_add_u32 s44, s40, 122880
buffer_load_dwordx4 v8, s[4:7], s44 offen lds
s_add_u32 s44, s46, s47
s_add_u32 m0, s44, 0
s_add_u32 s44, s41, 0
buffer_load_dwordx4 v3, s[8:11], s44 offen lds
s_add_u32 s44, s46, s47
s_add_u32 m0, s44, 2048
s_add_u32 s44, s41, 20480
buffer_load_dwordx4 v3, s[8:11], s44 offen lds
s_add_u32 s44, s46, s47
s_add_u32 m0, s44, 4096
s_add_u32 s44, s41, 40960
buffer_load_dwordx4 v3, s[8:11], s44 offen lds
s_add_u32 s44, s46, s47
s_add_u32 m0, s44, 6144
s_add_u32 s44, s41, 61440
buffer_load_dwordx4 v3, s[8:11], s44 offen lds
s_add_u32 s44, s46, s47
s_add_u32 m0, s44, 8192
s_add_u32 s44, s41, 81920
buffer_load_dwordx4 v3, s[8:11], s44 offen lds
ds_read_b128 v[200:203], v212
ds_read_b128 v[208:211], v206 offset:512
s_waitcnt lgkmcnt(0)
v_dot2_f32_bf16 v204, v200, v208, v204
v_dot2_f32_bf16 v218, v201, v209, v218
v_dot2_f32_bf16 v204, v202, v210, v204
v_dot2_f32_bf16 v218, v203, v211, v218
v_fma_f32 v125, -v140, v137, v125
v_fmac_f32 v141, v140, v121
v_mul_f32 v126, v125, v121
v_mul_f32 v142, v125, v137
v_fma_f32 v126, -v141, v137, v126
v_fmac_f32 v142, v141, v121
v_mul_f32 v127, v126, v121
v_mul_f32 v143, v126, v137
v_fma_f32 v127, -v142, v137, v127
v_fmac_f32 v143, v142, v121
v_mul_f32 v128, v127, v121
v_mul_f32 v144, v127, v137
v_fma_f32 v128, -v143, v137, v128
v_fmac_f32 v144, v143, v121
v_mul_f32 v129, v128, v121
v_mul_f32 v145, v128, v137
v_fma_f32 v129, -v144, v137, v129
v_fmac_f32 v145, v144, v121
v_mul_f32 v130, v129, v121
v_mul_f32 v146, v129, v137
s_waitcnt vmcnt(9)
s_barrier
s_add_u32 s40, s40, 128
s_add_u32 s41, s41, 128
s_add_u32 s78, s78, 1
s_cmp_eq_u32 s78, 10
s_cselect_b32 s79, 1280, 0
s_cselect_b32 s72, 1280, 0
s_cselect_b32 s78, 0, s78
s_sub_u32 s40, s40, s79
s_sub_u32 s41, s41, s72
s_add_u32 s47, s47, 36864
s_add_u32 s43, s43, 1
s_cmp_eq_u32 s43, 3
s_cselect_b32 s45, 110592, 0
s_cselect_b32 s43, 0, s43
s_sub_u32 s47, s47, s45
s_add_u32 s44, s42, s47
s_add_u32 m0, s44, 0
s_add_u32 s44, s40, 0
buffer_load_dwordx4 v2, s[4:7], s44 offen lds
s_add_u32 s44, s42, s47
s_add_u32 m0, s44, 4096
s_add_u32 s44, s40, 40960
buffer_load_dwordx4 v8, s[4:7], s44 offen lds
s_add_u32 s44, s42, s47
s_add_u32 m0, s44, 8192
s_add_u32 s44, s40, 81920
buffer_load_dwordx4 v2, s[4:7], s44 offen lds
s_add_u32 s44, s42, s47
s_add_u32 m0, s44, 12288
s_add_u32 s44, s40, 122880
buffer_load_dwordx4 v8, s[4:7], s44 offen lds
s_add_u32 s44, s46, s47
s_add_u32 m0, s44, 0
s_add_u32 s44, s41, 0
buffer_load_dwordx4 v3, s[8:11], s44 offen lds
s_add_u32 s44, s46, s47
s_add_u32 m0, s44, 2048
s_add_u32 s44, s41, 20480
buffer_load_dwordx4 v3, s[8:11], s44 offen lds
s_add_u32 s44, s46, s47
s_add_u32 m0, s44, 4096
s_add_u32 s44, s41, 40960
buffer_load_dwordx4 v3, s[8:11], s44 offen lds
s_add_u32 s44, s46, s47
s_add_u32 m0, s44, 6144
s_add_u32 s44, s41, 61440
buffer_load_dwordx4 v3, s[8:11], s44 offen lds
s_add_u32 s44, s46, s47
s_add_u32 m0, s44, 8192
s_add_u32 s44, s41, 81920
buffer_load_dwordx4 v3, s[8:11], s44 offen lds
ds_read_b128 v[200:203], v213
ds_read_b128 v[208:211], v206 offset:640
s_waitcnt lgkmcnt(0)
v_dot2_f32_bf16 v204, v200, v208, v204
v_dot2_f32_bf16 v218, v201, v209, v218
v_dot2_f32_bf16 v204, v202, v210, v204
v_dot2_f32_bf16 v218, v203, v211, v218
v_fma_f32 v130, -v145, v137, v130
v_fmac_f32 v146, v145, v121
v_mul_f32 v131, v130, v121
v_mul_f32 v147, v130, v137
v_fma_f32 v131, -v146, v137, v131
v_fmac_f32 v147, v146, v121
v_mul_f32 v132, v131, v121
v_mul_f32 v148, v131, v137
v_fma_f32 v132, -v147, v137, v132
v_fmac_f32 v148, v147, v121
v_mul_f32 v133, v132, v121
v_mul_f32 v149, v132, v137
v_fma_f32 v133, -v148, v137, v133
v_fmac_f32 v149, v148, v121
v_mul_f32 v134, v133, v121
v_mul_f32 v150, v133, v137
v_fma_f32 v134, -v149, v137, v134
v_fmac_f32 v150, v149, v121
v_mul_f32 v109, v27, v109
v_mul_f32 v110, v27, v110
s_waitcnt vmcnt(9)
s_barrier
s_add_u32 s40, s40, 128
s_add_u32 s41, s41, 128
s_add_u32 s78, s78, 1
s_cmp_eq_u32 s78, 10
s_cselect_b32 s79, 1280, 0
s_cselect_b32 s72, 1280, 0
s_cselect_b32 s78, 0, s78
s_sub_u32 s40, s40, s79
s_sub_u32 s41, s41, s72
s_add_u32 s47, s47, 36864
s_add_u32 s43, s43, 1
s_cmp_eq_u32 s43, 3
s_cselect_b32 s45, 110592, 0
s_cselect_b32 s43, 0, s43
s_sub_u32 s47, s47, s45
s_add_u32 s44, s42, s47
s_add_u32 m0, s44, 0
s_add_u32 s44, s40, 0
buffer_load_dwordx4 v2, s[4:7], s44 offen lds
s_add_u32 s44, s42, s47
s_add_u32 m0, s44, 4096
s_add_u32 s44, s40, 40960
buffer_load_dwordx4 v8, s[4:7], s44 offen lds
s_add_u32 s44, s42, s47
s_add_u32 m0, s44, 8192
s_add_u32 s44, s40, 81920
buffer_load_dwordx4 v2, s[4:7], s44 offen lds
s_add_u32 s44, s42, s47
s_add_u32 m0, s44, 12288
s_add_u32 s44, s40, 122880
buffer_load_dwordx4 v8, s[4:7], s44 offen lds
s_add_u32 s44, s46, s47
s_add_u32 m0, s44, 0
s_add_u32 s44, s41, 0
buffer_load_dwordx4 v3, s[8:11], s44 offen lds
s_add_u32 s44, s46, s47
s_add_u32 m0, s44, 2048
s_add_u32 s44, s41, 20480
buffer_load_dwordx4 v3, s[8:11], s44 offen lds
s_add_u32 s44, s46, s47
s_add_u32 m0, s44, 4096
s_add_u32 s44, s41, 40960
buffer_load_dwordx4 v3, s[8:11], s44 offen lds
s_add_u32 s44, s46, s47
s_add_u32 m0, s44, 6144
s_add_u32 s44, s41, 61440
buffer_load_dwordx4 v3, s[8:11], s44 offen lds
s_add_u32 s44, s46, s47
s_add_u32 m0, s44, 8192
s_add_u32 s44, s41, 81920
buffer_load_dwordx4 v3, s[8:11], s44 offen lds
ds_read_b128 v[200:203], v207
ds_read_b128 v[208:211], v206 offset:768
s_waitcnt lgkmcnt(0)
v_dot2_f32_bf16 v204, v200, v208, v204
v_dot2_f32_bf16 v218, v201, v209, v218
v_dot2_f32_bf16 v204, v202, v210, v204
v_dot2_f32_bf16 v218, v203, v211, v218
v_mul_f32 v111, v27, v111
v_mul_f32 v112, v27, v112
v_mul_f32 v113, v27, v113
v_mul_f32 v114, v27, v114
v_mul_f32 v115, v27, v115
v_mul_f32 v137, v27, v137
v_mul_f32 v138, v27, v138
v_mul_f32 v139, v27, v139
v_mul_f32 v140, v27, v140
v_mul_f32 v141, v27, v141
v_mul_f32 v142, v27, v142
v_mul_f32 v143, v27, v143
v_mul_f32 v144, v27, v144
v_mul_f32 v145, v27, v145
v_mul_f32 v146, v27, v146
v_mul_f32 v147, v27, v147
v_mul_f32 v148, v27, v148
v_mul_f32 v149, v27, v149
v_mul_f32 v150, v27, v150
s_waitcnt lgkmcnt(0)
s_waitcnt vmcnt(9)
s_barrier
s_add_u32 s40, s40, 128
s_add_u32 s41, s41, 128
s_add_u32 s78, s78, 1
s_cmp_eq_u32 s78, 10
s_cselect_b32 s79, 1280, 0
s_cselect_b32 s72, 1280, 0
s_cselect_b32 s78, 0, s78
s_sub_u32 s40, s40, s79
s_sub_u32 s41, s41, s72
s_add_u32 s47, s47, 36864
s_add_u32 s43, s43, 1
s_cmp_eq_u32 s43, 3
s_cselect_b32 s45, 110592, 0
s_cselect_b32 s43, 0, s43
s_sub_u32 s47, s47, s45
s_add_u32 s44, s42, s47
s_add_u32 m0, s44, 0
s_add_u32 s44, s40, 0
buffer_load_dwordx4 v2, s[4:7], s44 offen lds
s_add_u32 s44, s42, s47
s_add_u32 m0, s44, 4096
s_add_u32 s44, s40, 40960
buffer_load_dwordx4 v8, s[4:7], s44 offen lds
s_add_u32 s44, s42, s47
s_add_u32 m0, s44, 8192
s_add_u32 s44, s40, 81920
buffer_load_dwordx4 v2, s[4:7], s44 offen lds
s_add_u32 s44, s42, s47
s_add_u32 m0, s44, 12288
s_add_u32 s44, s40, 122880
buffer_load_dwordx4 v8, s[4:7], s44 offen lds
s_add_u32 s44, s46, s47
s_add_u32 m0, s44, 0
s_add_u32 s44, s41, 0
buffer_load_dwordx4 v3, s[8:11], s44 offen lds
s_add_u32 s44, s46, s47
s_add_u32 m0, s44, 2048
s_add_u32 s44, s41, 20480
buffer_load_dwordx4 v3, s[8:11], s44 offen lds
s_add_u32 s44, s46, s47
s_add_u32 m0, s44, 4096
s_add_u32 s44, s41, 40960
buffer_load_dwordx4 v3, s[8:11], s44 offen lds
s_add_u32 s44, s46, s47
s_add_u32 m0, s44, 6144
s_add_u32 s44, s41, 61440
buffer_load_dwordx4 v3, s[8:11], s44 offen lds
s_add_u32 s44, s46, s47
s_add_u32 m0, s44, 8192
s_add_u32 s44, s41, 81920
buffer_load_dwordx4 v3, s[8:11], s44 offen lds
ds_read_b128 v[200:203], v212
ds_read_b128 v[208:211], v206 offset:896
s_waitcnt lgkmcnt(0)
v_dot2_f32_bf16 v204, v200, v208, v204
v_dot2_f32_bf16 v218, v201, v209, v218
v_dot2_f32_bf16 v204, v202, v210, v204
v_dot2_f32_bf16 v218, v203, v211, v218
s_waitcnt vmcnt(9)
s_barrier
s_add_u32 s40, s40, 128
s_add_u32 s41, s41, 128
s_add_u32 s78, s78, 1
s_cmp_eq_u32 s78, 10
s_cselect_b32 s79, 1280, 0
s_cselect_b32 s72, 1280, 0
s_cselect_b32 s78, 0, s78
s_sub_u32 s40, s40, s79
s_sub_u32 s41, s41, s72
s_add_u32 s47, s47, 36864
s_add_u32 s43, s43, 1
s_cmp_eq_u32 s43, 3
s_cselect_b32 s45, 110592, 0
s_cselect_b32 s43, 0, s43
s_sub_u32 s47, s47, s45
s_cmp_eq_u32 s20, 7
s_cbranch_scc0 PT_9_N
s_mul_i32 s32, s21, 327680
s_add_u32 s32, s32, 8388608
s_mul_i32 s33, s22, 80
v_lshrrev_b32 v238, 2, v0
v_add_u32 v238, 0, v238
v_add_u32 v238, s33, v238
v_lshrrev_b32 v239, 6, v238
v_and_b32 v238, 63, v238
v_bfe_u32 v240, v0, 1, 1
v_lshl_add_u32 v239, v239, 1, v240
v_lshl_add_u32 v239, v239, 6, v238
v_and_b32 v240, 1, v0
v_lshlrev_b32 v239, 8, v239
v_lshl_add_u32 v239, v240, 7, v239
buffer_load_dword v237, v239, s[12:15], s32 offen
v_lshrrev_b32 v238, 2, v0
v_add_u32 v238, 16, v238
v_add_u32 v238, s33, v238
v_lshrrev_b32 v239, 6, v238
v_and_b32 v238, 63, v238
v_bfe_u32 v240, v0, 1, 1
v_lshl_add_u32 v239, v239, 1, v240
v_lshl_add_u32 v239, v239, 6, v238
v_and_b32 v240, 1, v0
v_lshlrev_b32 v239, 8, v239
v_lshl_add_u32 v239, v240, 7, v239
buffer_load_dword v237, v239, s[12:15], s32 offen
v_lshrrev_b32 v238, 2, v0
v_add_u32 v238, 32, v238
v_add_u32 v238, s33, v238
v_lshrrev_b32 v239, 6, v238
v_and_b32 v238, 63, v238
v_bfe_u32 v240, v0, 1, 1
v_lshl_add_u32 v239, v239, 1, v240
v_lshl_add_u32 v239, v239, 6, v238
v_and_b32 v240, 1, v0
v_lshlrev_b32 v239, 8, v239
v_lshl_add_u32 v239, v240, 7, v239
buffer_load_dword v237, v239, s[12:15], s32 offen
v_lshrrev_b32 v238, 2, v0
v_add_u32 v238, 48, v238
v_add_u32 v238, s33, v238
v_lshrrev_b32 v239, 6, v238
v_and_b32 v238, 63, v238
v_bfe_u32 v240, v0, 1, 1
v_lshl_add_u32 v239, v239, 1, v240
v_lshl_add_u32 v239, v239, 6, v238
v_and_b32 v240, 1, v0
v_lshlrev_b32 v239, 8, v239
v_lshl_add_u32 v239, v240, 7, v239
buffer_load_dword v237, v239, s[12:15], s32 offen
v_lshrrev_b32 v238, 2, v0
v_add_u32 v238, 64, v238
v_add_u32 v238, s33, v238
v_lshrrev_b32 v239, 6, v238
v_and_b32 v238, 63, v238
v_bfe_u32 v240, v0, 1, 1
v_lshl_add_u32 v239, v239, 1, v240
v_lshl_add_u32 v239, v239, 6, v238
v_and_b32 v240, 1, v0
v_lshlrev_b32 v239, 8, v239
v_lshl_add_u32 v239, v240, 7, v239
buffer_load_dword v237, v239, s[12:15], s32 offen
v_lshlrev_b32 v236, 7, v0
s_lshl_b32 s32, s21, 2
s_lshr_b32 s33, s22, 2
s_and_b32 s33, s33, 3
s_add_u32 s32, s32, s33
s_lshl_b32 s34, s32, 6
s_add_u32 s34, s34, 16351232
s_mov_b64 s[76:77], exec
s_mov_b64 exec, 1
buffer_load_dword v237, v236, s[12:15], s34 offen
s_lshl_b32 s34, s32, 9
s_and_b32 s33, s22, 3
s_lshl_b32 s33, s33, 7
s_add_u32 s34, s34, s33
s_add_u32 s34, s34, 14680064
buffer_load_dword v237, v236, s[12:15], s34 offen
s_mov_b64 exec, s[76:77]
ds_read_b128 v[200:203], v213
ds_read_b128 v[208:211], v206 offset:1024
s_waitcnt lgkmcnt(0)
v_dot2_f32_bf16 v204, v200, v208, v204
v_dot2_f32_bf16 v218, v201, v209, v218
v_dot2_f32_bf16 v204, v202, v210, v204
v_dot2_f32_bf16 v218, v203, v211, v218
s_waitcnt vmcnt(7)
s_branch PT_9_E
PT_9_N:
ds_read_b128 v[200:203], v213
ds_read_b128 v[208:211], v206 offset:1024
s_waitcnt lgkmcnt(0)
v_dot2_f32_bf16 v204, v200, v208, v204
v_dot2_f32_bf16 v218, v201, v209, v218
v_dot2_f32_bf16 v204, v202, v210, v204
v_dot2_f32_bf16 v218, v203, v211, v218
s_waitcnt vmcnt(0)
PT_9_E:
s_barrier
ds_read_b128 v[200:203], v207
ds_read_b128 v[208:211], v206 offset:1152
s_waitcnt lgkmcnt(0)
v_dot2_f32_bf16 v204, v200, v208, v204
v_dot2_f32_bf16 v218, v201, v209, v218
v_dot2_f32_bf16 v204, v202, v210, v204
v_dot2_f32_bf16 v218, v203, v211, v218
s_nop 3
v_add_f32 v204, v204, v218
s_nop 1
v_add_f32_dpp v204, v204, v204 quad_perm:[1,0,3,2] row_mask:0xf bank_mask:0xf
s_nop 1
v_add_f32_dpp v204, v204, v204 quad_perm:[2,3,0,1] row_mask:0xf bank_mask:0xf
s_nop 1
v_add_f32_dpp v204, v204, v204 row_half_mirror row_mask:0xf bank_mask:0xf
v_mul_f32 v204, 0xbfb8aa3b, v204
v_exp_f32 v204, v204
s_nop 0
v_add_f32 v204, 1.0, v204
v_rcp_f32 v204, v204
v_lshlrev_b32 v12, 2, v10
v_add_u32 v12, 122880, v12
v_lshlrev_b32 v13, 3, v10
s_mul_i32 s33, s22, 20480
s_add_u32 s33, s33, 15728640
s_mul_i32 s34, s21, 1280
s_add_u32 s34, s34, s33
s_setprio 3
s_barrier
v_mov_b32 v230, 159744
ds_read_b64 v[232:233], v230
s_waitcnt lgkmcnt(0)
v_readfirstlane_b32 s90, v232
v_readfirstlane_b32 s91, v233
s_mov_b32 s91, 0
s_cmp_ge_u32 s30, 3
s_cbranch_scc1 SSM_H_BX2
v_cmp_gt_u32 vcc, 160, v10
s_and_saveexec_b64 s[74:75], vcc
ds_read_b32 v40, v12 offset:0
ds_read_b32 v41, v12 offset:640
ds_read_b32 v42, v12 offset:1280
ds_read_b32 v43, v12 offset:1920
ds_read_b32 v44, v12 offset:2560
ds_read_b32 v45, v12 offset:3200
ds_read_b32 v46, v12 offset:3840
ds_read_b32 v47, v12 offset:4480
v_mov_b32 v59, s90
s_waitcnt lgkmcnt(0)
v_mov_b32 v58, v47
v_mul_f32 v56, v107, v40
v_mul_f32 v57, v106, v41
v_fmac_f32_dpp v56, v40, v115 quad_perm:[1,0,3,2] row_mask:0xf bank_mask:0xf
v_fmac_f32_dpp v57, v41, v114 quad_perm:[1,0,3,2] row_mask:0xf bank_mask:0xf
v_fmac_f32 v58, v105, v42
v_fmac_f32_dpp v58, v42, v113 quad_perm:[1,0,3,2] row_mask:0xf bank_mask:0xf
v_fmac_f32 v56, v104, v43
v_fmac_f32_dpp v56, v43, v112 quad_perm:[1,0,3,2] row_mask:0xf bank_mask:0xf
v_fmac_f32 v57, v103, v44
v_fmac_f32_dpp v57, v44, v111 quad_perm:[1,0,3,2] row_mask:0xf bank_mask:0xf
v_fmac_f32 v58, v102, v45
v_fmac_f32_dpp v58, v45, v110 quad_perm:[1,0,3,2] row_mask:0xf bank_mask:0xf
v_fmac_f32 v56, v101, v46
v_fmac_f32_dpp v56, v46, v109 quad_perm:[1,0,3,2] row_mask:0xf bank_mask:0xf
v_add_f32 v58, v58, v56
v_add_f32 v58, v58, v57
buffer_store_dwordx2 v[58:59], v13, s[12:15], s34 offen sc1
v_mov_b32 v60, 0
s_mov_b32 s36, 0
s_cmp_le_u32 s21, 0
s_cbranch_scc1 LB_10
s_sub_u32 s35, s34, 1280
buffer_load_dwordx2 v[64:65], v13, s[12:15], s35 offen sc1
s_cmp_le_u32 s21, 1
s_cbranch_scc1 LB_10
s_sub_u32 s35, s34, 2560
buffer_load_dwordx2 v[66:67], v13, s[12:15], s35 offen sc1
s_cmp_le_u32 s21, 2
s_cbranch_scc1 LB_10
s_sub_u32 s35, s34, 3840
buffer_load_dwordx2 v[68:69], v13, s[12:15], s35 offen sc1
s_cmp_le_u32 s21, 3
s_cbranch_scc1 LB_10
s_sub_u32 s35, s34, 5120
buffer_load_dwordx2 v[70:71], v13, s[12:15], s35 offen sc1
s_cmp_le_u32 s21, 4
s_cbranch_scc1 LB_10
s_sub_u32 s35, s34, 6400
buffer_load_dwordx2 v[72:73], v13, s[12:15], s35 offen sc1
s_cmp_le_u32 s21, 5
s_cbranch_scc1 LB_10
s_sub_u32 s35, s34, 7680
buffer_load_dwordx2 v[74:75], v13, s[12:15], s35 offen sc1
s_cmp_le_u32 s21, 6
s_cbranch_scc1 LB_10
s_sub_u32 s35, s34, 8960
buffer_load_dwordx2 v[76:77], v13, s[12:15], s35 offen sc1
s_cmp_le_u32 s21, 7
s_cbranch_scc1 LB_10
s_sub_u32 s35, s34, 10240
buffer_load_dwordx2 v[78:79], v13, s[12:15], s35 offen sc1
s_cmp_le_u32 s21, 8
s_cbranch_scc1 LB_10
s_sub_u32 s35, s34, 11520
buffer_load_dwordx2 v[80:81], v13, s[12:15], s35 offen sc1
s_cmp_le_u32 s21, 9
s_cbranch_scc1 LB_10
s_sub_u32 s35, s34, 12800
buffer_load_dwordx2 v[82:83], v13, s[12:15], s35 offen sc1
s_cmp_le_u32 s21, 10
s_cbranch_scc1 LB_10
s_sub_u32 s35, s34, 14080
buffer_load_dwordx2 v[84:85], v13, s[12:15], s35 offen sc1
s_cmp_le_u32 s21, 11
s_cbranch_scc1 LB_10
s_sub_u32 s35, s34, 15360
buffer_load_dwordx2 v[86:87], v13, s[12:15], s35 offen sc1
s_cmp_le_u32 s21, 12
s_cbranch_scc1 LB_10
s_sub_u32 s35, s34, 16640
buffer_load_dwordx2 v[88:89], v13, s[12:15], s35 offen sc1
s_cmp_le_u32 s21, 13
s_cbranch_scc1 LB_10
s_sub_u32 s35, s34, 17920
buffer_load_dwordx2 v[90:91], v13, s[12:15], s35 offen sc1
s_cmp_le_u32 s21, 14
s_cbranch_scc1 LB_10
s_sub_u32 s35, s34, 19200
buffer_load_dwordx2 v[92:93], v13, s[12:15], s35 offen sc1
LB_10:
v_mov_b32 v50, 0
v_mov_b32 v51, v40
v_fma_f32 v52, v101, v51, v41
s_nop 0
v_fmac_f32_dpp v52, v51, v109 quad_perm:[1,0,3,2] row_mask:0xf bank_mask:0xf
s_nop 0
v_fma_f32 v53, v101, v52, v42
s_nop 0
v_fmac_f32_dpp v53, v52, v109 quad_perm:[1,0,3,2] row_mask:0xf bank_mask:0xf
s_nop 0
v_fma_f32 v54, v101, v53, v43
s_nop 0
v_fmac_f32_dpp v54, v53, v109 quad_perm:[1,0,3,2] row_mask:0xf bank_mask:0xf
s_nop 0
v_fma_f32 v55, v101, v54, v44
s_nop 0
v_fmac_f32_dpp v55, v54, v109 quad_perm:[1,0,3,2] row_mask:0xf bank_mask:0xf
s_nop 0
v_fma_f32 v56, v101, v55, v45
s_nop 0
v_fmac_f32_dpp v56, v55, v109 quad_perm:[1,0,3,2] row_mask:0xf bank_mask:0xf
s_nop 0
v_fma_f32 v57, v101, v56, v46
s_nop 0
v_fmac_f32_dpp v57, v56, v109 quad_perm:[1,0,3,2] row_mask:0xf bank_mask:0xf
s_nop 0
s_cmp_eq_u32 s21, 0
s_cbranch_scc1 SSM_H_HDONE
SSM_H_POLL:
s_waitcnt vmcnt(0)
s_mov_b64 s[76:77], exec
v_cmp_eq_u32 vcc, s90, v65
s_and_b64 s[76:77], s[76:77], vcc
s_cmp_le_u32 s21, 1
s_cbranch_scc1 SSM_H_CHECKED
v_cmp_eq_u32 vcc, s90, v67
s_and_b64 s[76:77], s[76:77], vcc
s_cmp_le_u32 s21, 2
s_cbranch_scc1 SSM_H_CHECKED
v_cmp_eq_u32 vcc, s90, v69
s_and_b64 s[76:77], s[76:77], vcc
s_cmp_le_u32 s21, 3
s_cbranch_scc1 SSM_H_CHECKED
v_cmp_eq_u32 vcc, s90, v71
s_and_b64 s[76:77], s[76:77], vcc
s_cmp_le_u32 s21, 4
s_cbranch_scc1 SSM_H_CHECKED
v_cmp_eq_u32 vcc, s90, v73
s_and_b64 s[76:77], s[76:77], vcc
s_cmp_le_u32 s21, 5
s_cbranch_scc1 SSM_H_CHECKED
v_cmp_eq_u32 vcc, s90, v75
s_and_b64 s[76:77], s[76:77], vcc
s_cmp_le_u32 s21, 6
s_cbranch_scc1 SSM_H_CHECKED
v_cmp_eq_u32 vcc, s90, v77
s_and_b64 s[76:77], s[76:77], vcc
s_cmp_le_u32 s21, 7
s_cbranch_scc1 SSM_H_CHECKED
v_cmp_eq_u32 vcc, s90, v79
s_and_b64 s[76:77], s[76:77], vcc
s_cmp_le_u32 s21, 8
s_cbranch_scc1 SSM_H_CHECKED
v_cmp_eq_u32 vcc, s90, v81
s_and_b64 s[76:77], s[76:77], vcc
s_cmp_le_u32 s21, 9
s_cbranch_scc1 SSM_H_CHECKED
v_cmp_eq_u32 vcc, s90, v83
s_and_b64 s[76:77], s[76:77], vcc
s_cmp_le_u32 s21, 10
s_cbranch_scc1 SSM_H_CHECKED
v_cmp_eq_u32 vcc, s90, v85
s_and_b64 s[76:77], s[76:77], vcc
s_cmp_le_u32 s21, 11
s_cbranch_scc1 SSM_H_CHECKED
v_cmp_eq_u32 vcc, s90, v87
s_and_b64 s[76:77], s[76:77], vcc
s_cmp_le_u32 s21, 12
s_cbranch_scc1 SSM_H_CHECKED
v_cmp_eq_u32 vcc, s90, v89
s_and_b64 s[76:77], s[76:77], vcc
s_cmp_le_u32 s21, 13
s_cbranch_scc1 SSM_H_CHECKED
v_cmp_eq_u32 vcc, s90, v91
s_and_b64 s[76:77], s[76:77], vcc
s_cmp_le_u32 s21, 14
s_cbranch_scc1 SSM_H_CHECKED
v_cmp_eq_u32 vcc, s90, v93
s_and_b64 s[76:77], s[76:77], vcc
SSM_H_CHECKED:
s_cmp_eq_u64 s[76:77], exec
s_cbranch_scc1 SSM_H_OK
s_add_u32 s36, s36, 1
s_cmp_lt_u32 s36, 0x4000
s_cbranch_scc0 SSM_H_OK
s_cmp_le_u32 s21, 0
s_cbranch_scc1 LB_11
s_sub_u32 s35, s34, 1280
buffer_load_dwordx2 v[64:65], v13, s[12:15], s35 offen sc1
s_cmp_le_u32 s21, 1
s_cbranch_scc1 LB_11
s_sub_u32 s35, s34, 2560
buffer_load_dwordx2 v[66:67], v13, s[12:15], s35 offen sc1
s_cmp_le_u32 s21, 2
s_cbranch_scc1 LB_11
s_sub_u32 s35, s34, 3840
buffer_load_dwordx2 v[68:69], v13, s[12:15], s35 offen sc1
s_cmp_le_u32 s21, 3
s_cbranch_scc1 LB_11
s_sub_u32 s35, s34, 5120
buffer_load_dwordx2 v[70:71], v13, s[12:15], s35 offen sc1
s_cmp_le_u32 s21, 4
s_cbranch_scc1 LB_11
s_sub_u32 s35, s34, 6400
buffer_load_dwordx2 v[72:73], v13, s[12:15], s35 offen sc1
s_cmp_le_u32 s21, 5
s_cbranch_scc1 LB_11
s_sub_u32 s35, s34, 7680
buffer_load_dwordx2 v[74:75], v13, s[12:15], s35 offen sc1
s_cmp_le_u32 s21, 6
s_cbranch_scc1 LB_11
s_sub_u32 s35, s34, 8960
buffer_load_dwordx2 v[76:77], v13, s[12:15], s35 offen sc1
s_cmp_le_u32 s21, 7
s_cbranch_scc1 LB_11
s_sub_u32 s35, s34, 10240
buffer_load_dwordx2 v[78:79], v13, s[12:15], s35 offen sc1
s_cmp_le_u32 s21, 8
s_cbranch_scc1 LB_11
s_sub_u32 s35, s34, 11520
buffer_load_dwordx2 v[80:81], v13, s[12:15], s35 offen sc1
s_cmp_le_u32 s21, 9
s_cbranch_scc1 LB_11
s_sub_u32 s35, s34, 12800
buffer_load_dwordx2 v[82:83], v13, s[12:15], s35 offen sc1
s_cmp_le_u32 s21, 10
s_cbranch_scc1 LB_11
s_sub_u32 s35, s34, 14080
buffer_load_dwordx2 v[84:85], v13, s[12:15], s35 offen sc1
s_cmp_le_u32 s21, 11
s_cbranch_scc1 LB_11
s_sub_u32 s35, s34, 15360
buffer_load_dwordx2 v[86:87], v13, s[12:15], s35 offen sc1
s_cmp_le_u32 s21, 12
s_cbranch_scc1 LB_11
s_sub_u32 s35, s34, 16640
buffer_load_dwordx2 v[88:89], v13, s[12:15], s35 offen sc1
s_cmp_le_u32 s21, 13
s_cbranch_scc1 LB_11
s_sub_u32 s35, s34, 17920
buffer_load_dwordx2 v[90:91], v13, s[12:15], s35 offen sc1
s_cmp_le_u32 s21, 14
s_cbranch_scc1 LB_11
s_sub_u32 s35, s34, 19200
buffer_load_dwordx2 v[92:93], v13, s[12:15], s35 offen sc1
LB_11:
s_branch SSM_H_POLL
SSM_H_OK:
v_mov_b32 v60, v64
v_mov_b32 v61, 0
v_mov_b32 v62, 0
s_cmp_le_u32 s21, 1
s_cbranch_scc1 SSM_H_HSUM
v_fmac_f32 v61, v121, v66
v_fmac_f32_dpp v61, v66, v137 quad_perm:[1,0,3,2] row_mask:0xf bank_mask:0xf
s_cmp_le_u32 s21, 2
s_cbranch_scc1 SSM_H_HSUM
v_fmac_f32 v62, v122, v68
v_fmac_f32_dpp v62, v68, v138 quad_perm:[1,0,3,2] row_mask:0xf bank_mask:0xf
s_cmp_le_u32 s21, 3
s_cbranch_scc1 SSM_H_HSUM
v_fmac_f32 v60, v123, v70
v_fmac_f32_dpp v60, v70, v139 quad_perm:[1,0,3,2] row_mask:0xf bank_mask:0xf
s_cmp_le_u32 s21, 4
s_cbranch_scc1 SSM_H_HSUM
v_fmac_f32 v61, v124, v72
v_fmac_f32_dpp v61, v72, v140 quad_perm:[1,0,3,2] row_mask:0xf bank_mask:0xf
s_cmp_le_u32 s21, 5
s_cbranch_scc1 SSM_H_HSUM
v_fmac_f32 v62, v125, v74
v_fmac_f32_dpp v62, v74, v141 quad_perm:[1,0,3,2] row_mask:0xf bank_mask:0xf
s_cmp_le_u32 s21, 6
s_cbranch_scc1 SSM_H_HSUM
v_fmac_f32 v60, v126, v76
v_fmac_f32_dpp v60, v76, v142 quad_perm:[1,0,3,2] row_mask:0xf bank_mask:0xf
s_cmp_le_u32 s21, 7
s_cbranch_scc1 SSM_H_HSUM
v_fmac_f32 v61, v127, v78
v_fmac_f32_dpp v61, v78, v143 quad_perm:[1,0,3,2] row_mask:0xf bank_mask:0xf
s_cmp_le_u32 s21, 8
s_cbranch_scc1 SSM_H_HSUM
v_fmac_f32 v62, v128, v80
v_fmac_f32_dpp v62, v80, v144 quad_perm:[1,0,3,2] row_mask:0xf bank_mask:0xf
s_cmp_le_u32 s21, 9
s_cbranch_scc1 SSM_H_HSUM
v_fmac_f32 v60, v129, v82
v_fmac_f32_dpp v60, v82, v145 quad_perm:[1,0,3,2] row_mask:0xf bank_mask:0xf
s_cmp_le_u32 s21, 10
s_cbranch_scc1 SSM_H_HSUM
v_fmac_f32 v61, v130, v84
v_fmac_f32_dpp v61, v84, v146 quad_perm:[1,0,3,2] row_mask:0xf bank_mask:0xf
s_cmp_le_u32 s21, 11
s_cbranch_scc1 SSM_H_HSUM
v_fmac_f32 v62, v131, v86
v_fmac_f32_dpp v62, v86, v147 quad_perm:[1,0,3,2] row_mask:0xf bank_mask:0xf
s_cmp_le_u32 s21, 12
s_cbranch_scc1 SSM_H_HSUM
v_fmac_f32 v60, v132, v88
v_fmac_f32_dpp v60, v88, v148 quad_perm:[1,0,3,2] row_mask:0xf bank_mask:0xf
s_cmp_le_u32 s21, 13
s_cbranch_scc1 SSM_H_HSUM
v_fmac_f32 v61, v133, v90
v_fmac_f32_dpp v61, v90, v149 quad_perm:[1,0,3,2] row_mask:0xf bank_mask:0xf
s_cmp_le_u32 s21, 14
s_cbranch_scc1 SSM_H_HSUM
v_fmac_f32 v62, v134, v92
v_fmac_f32_dpp v62, v92, v150 quad_perm:[1,0,3,2] row_mask:0xf bank_mask:0xf
SSM_H_HSUM:
v_add_f32 v60, v60, v61
v_add_f32 v60, v60, v62
SSM_H_HDONE:
v_add_u32 v12, 5120, v12
s_nop 0
ds_write_b32 v12, v60
v_fmac_f32 v51, v101, v60
v_fmac_f32 v52, v102, v60
v_fmac_f32 v53, v103, v60
v_fmac_f32 v54, v104, v60
v_fmac_f32 v55, v105, v60
v_fmac_f32 v56, v106, v60
v_fmac_f32 v57, v107, v60
v_fmac_f32_dpp v51, v60, v109 quad_perm:[1,0,3,2] row_mask:0xf bank_mask:0xf
v_fmac_f32_dpp v52, v60, v110 quad_perm:[1,0,3,2] row_mask:0xf bank_mask:0xf
v_fmac_f32_dpp v53, v60, v111 quad_perm:[1,0,3,2] row_mask:0xf bank_mask:0xf
v_fmac_f32_dpp v54, v60, v112 quad_perm:[1,0,3,2] row_mask:0xf bank_mask:0xf
v_fmac_f32_dpp v55, v60, v113 quad_perm:[1,0,3,2] row_mask:0xf bank_mask:0xf
v_fmac_f32_dpp v56, v60, v114 quad_perm:[1,0,3,2] row_mask:0xf bank_mask:0xf
v_fmac_f32_dpp v57, v60, v115 quad_perm:[1,0,3,2] row_mask:0xf bank_mask:0xf
ds_write_b32 v12, v51 offset:640
ds_write_b32 v12, v52 offset:1280
ds_write_b32 v12, v53 offset:1920
ds_write_b32 v12, v54 offset:2560
ds_write_b32 v12, v55 offset:3200
ds_write_b32 v12, v56 offset:3840
ds_write_b32 v12, v57 offset:4480
s_waitcnt lgkmcnt(0)
s_mov_b64 exec, s[74:75]
SSM_H_BX2:
s_barrier
v_mov_b32 v230, 159744
ds_read_b64 v[232:233], v230
s_waitcnt lgkmcnt(0)
v_readfirstlane_b32 s90, v232
v_readfirstlane_b32 s91, v233
v_and_b32 v205, 7, v0
v_cmp_eq_u32 vcc, 0, v205
s_and_saveexec_b64 s[76:77], vcc
s_cmp_eq_u32 s91, 1
s_cbranch_scc1 GS_12_F
buffer_store_dword v204, v214, s[12:15], 0 offen sc1
s_branch GS_12_E
GS_12_F:
buffer_store_dword v204, v214, s[12:15], 0 offen
GS_12_E:
s_mov_b64 exec, s[76:77]
s_and_b32 s23, s22, 3
s_lshr_b32 s24, s22, 2
s_mov_b32 s25, 10
s_load_dwordx2 s[60:61], s[0:1], 40
s_load_dwordx2 s[62:63], s[0:1], 48
v_lshrrev_b32 v1, 3, v0
v_and_b32 v4, 7, v0
v_lshrrev_b32 v5, 4, v0
v_lshlrev_b32 v2, 4, v0
v_mul_u32_u24 v7, 1280, v1
s_lshl_b32 s42, s30, 10
s_mov_b32 s43, 0
s_and_b32 s31, s30, 1
s_lshl_b32 s32, s31, 2
v_add_u32 v6, s32, v5
v_and_b32 v6, 7, v6
v_xor_b32 v6, v4, v6
v_lshlrev_b32 v6, 4, v6
v_add_u32 v3, v6, v7
s_mul_i32 s40, s21, 20
s_mul_i32 s33, s24, 10
s_add_u32 s40, s40, s33
s_lshl_b32 s40, s40, 14
s_lshl_b32 s33, s30, 10
s_add_u32 s40, s40, s33
s_add_u32 s40, s40, 8388608
s_mul_i32 s41, s23, 160
s_lshl_b32 s33, s30, 3
s_add_u32 s41, s41, s33
s_mul_i32 s41, s41, 1280
s_mul_i32 s33, s24, 640
s_add_u32 s41, s41, s33
s_mov_b32 s46, 0
s_waitcnt lgkmcnt(0)
s_mov_b32 s8, s60
s_and_b32 s9, s61, 0xffff
s_mov_b32 s10, 819200
s_mov_b32 s11, 0x20000
s_mov_b32 s68, s40
s_mov_b32 s69, s41
s_mul_i32 s33, s23, s25
s_lshr_b32 s78, s33, 2
s_lshl_b32 s32, s78, 14
s_add_u32 s40, s68, s32
s_lshr_b32 s32, s78, 1
s_lshl_b32 s32, s32, 7
s_add_u32 s41, s69, s32
s_and_b32 s32, s78, 1
s_cmp_eq_u32 s32, 1
s_cselect_b32 s8, s62, s60
s_cselect_b32 s32, s63, s61
s_and_b32 s9, s32, 0xffff
s_add_u32 m0, s42, 16384
s_add_u32 s44, s41, 0
buffer_load_dwordx4 v3, s[8:11], s44 offen lds
s_add_u32 m0, s42, 20480
s_add_u32 s44, s41, 40960
buffer_load_dwordx4 v3, s[8:11], s44 offen lds
s_add_u32 m0, s42, 24576
s_add_u32 s44, s41, 81920
buffer_load_dwordx4 v3, s[8:11], s44 offen lds
s_add_u32 m0, s42, 28672
s_add_u32 s44, s41, 122880
buffer_load_dwordx4 v3, s[8:11], s44 offen lds
s_add_u32 m0, s42, 32768
s_add_u32 s44, s41, 163840
buffer_load_dwordx4 v3, s[8:11], s44 offen lds
s_mov_b32 s50, s40
s_mov_b32 s51, s42
s_add_u32 s78, s78, 1
s_cmp_eq_u32 s78, s25
s_cselect_b32 s78, 0, s78
s_lshl_b32 s32, s78, 14
s_add_u32 s40, s68, s32
s_lshr_b32 s32, s78, 1
s_lshl_b32 s32, s32, 7
s_add_u32 s41, s69, s32
s_and_b32 s32, s78, 1
s_cmp_eq_u32 s32, 1
s_cselect_b32 s8, s62, s60
s_cselect_b32 s32, s63, s61
s_and_b32 s9, s32, 0xffff
s_add_u32 s42, s42, 40960
s_add_u32 s43, s43, 1
s_cmp_eq_u32 s43, 3
s_cselect_b32 s45, 122880, 0
s_cselect_b32 s43, 0, s43
s_sub_u32 s42, s42, s45
s_add_u32 m0, s42, 16384
s_add_u32 s44, s41, 0
buffer_load_dwordx4 v3, s[8:11], s44 offen lds
s_add_u32 m0, s42, 20480
s_add_u32 s44, s41, 40960
buffer_load_dwordx4 v3, s[8:11], s44 offen lds
s_add_u32 m0, s42, 24576
s_add_u32 s44, s41, 81920
buffer_load_dwordx4 v3, s[8:11], s44 offen lds
s_add_u32 m0, s42, 28672
s_add_u32 s44, s41, 122880
buffer_load_dwordx4 v3, s[8:11], s44 offen lds
s_add_u32 m0, s42, 32768
s_add_u32 s44, s41, 163840
buffer_load_dwordx4 v3, s[8:11], s44 offen lds
s_waitcnt vmcnt(0)
s_barrier
s_lshl_b32 s32, s21, 2
s_add_u32 s32, s32, s24
s_lshl_b32 s32, s32, 6
s_add_u32 s32, s32, 16351232
s_mov_b64 s[76:77], exec
s_mov_b64 exec, 1
v_mov_b32 v16, s90
s_lshl_b32 s33, s23, 2
v_mov_b32 v17, s33
s_cmp_eq_u32 s30, 0
s_cbranch_scc0 P2SPF_13_NF
s_cmp_eq_u32 s91, 1
s_cbranch_scc1 P2SPF_13_FF
buffer_store_dword v16, v17, s[12:15], s32 offen sc1
s_branch P2SPF_13_NF
P2SPF_13_FF:
buffer_store_dword v16, v17, s[12:15], s32 offen
P2SPF_13_NF:
v_mov_b32 v17, 0
s_mov_b32 s36, 0
P2SPF_13_P:
buffer_load_dwordx4 v[20:23], v17, s[12:15], s32 offen sc1
s_waitcnt vmcnt(0)
s_mov_b32 s35, 1
v_readfirstlane_b32 s37, v20
s_cmp_eq_u32 s37, s90
s_cselect_b32 s35, s35, 0
v_readfirstlane_b32 s37, v21
s_cmp_eq_u32 s37, s90
s_cselect_b32 s35, s35, 0
v_readfirstlane_b32 s37, v22
s_cmp_eq_u32 s37, s90
s_cselect_b32 s35, s35, 0
v_readfirstlane_b32 s37, v23
s_cmp_eq_u32 s37, s90
s_cselect_b32 s35, s35, 0
s_cmp_eq_u32 s35, 1
s_cbranch_scc1 P2SPF_13_D
s_add_u32 s36, s36, 1
s_cmp_lt_u32 s36, 0x4000
s_cbranch_scc0 P2SPF_13_D
s_branch P2SPF_13_P
P2SPF_13_D:
s_mov_b64 exec, s[76:77]
s_add_u32 m0, s51, 0
s_add_u32 s44, s50, 0
buffer_load_dwordx4 v2, s[12:15], s44 offen sc1 lds
s_add_u32 m0, s51, 4096
s_add_u32 s44, s50, 4096
buffer_load_dwordx4 v2, s[12:15], s44 offen sc1 lds
s_add_u32 m0, s51, 8192
s_add_u32 s44, s50, 8192
buffer_load_dwordx4 v2, s[12:15], s44 offen sc1 lds
s_add_u32 m0, s51, 12288
s_add_u32 s44, s50, 12288
buffer_load_dwordx4 v2, s[12:15], s44 offen sc1 lds
s_add_u32 m0, s42, 0
s_add_u32 s44, s40, 0
buffer_load_dwordx4 v2, s[12:15], s44 offen sc1 lds
s_add_u32 m0, s42, 4096
s_add_u32 s44, s40, 4096
buffer_load_dwordx4 v2, s[12:15], s44 offen sc1 lds
s_add_u32 m0, s42, 8192
s_add_u32 s44, s40, 8192
buffer_load_dwordx4 v2, s[12:15], s44 offen sc1 lds
s_add_u32 m0, s42, 12288
s_add_u32 s44, s40, 12288
buffer_load_dwordx4 v2, s[12:15], s44 offen sc1 lds
s_waitcnt vmcnt(4)
s_barrier
s_add_u32 s78, s78, 1
s_cmp_eq_u32 s78, s25
s_cselect_b32 s78, 0, s78
s_lshl_b32 s32, s78, 14
s_add_u32 s40, s68, s32
s_lshr_b32 s32, s78, 1
s_lshl_b32 s32, s32, 7
s_add_u32 s41, s69, s32
s_and_b32 s32, s78, 1
s_cmp_eq_u32 s32, 1
s_cselect_b32 s8, s62, s60
s_cselect_b32 s32, s63, s61
s_and_b32 s9, s32, 0xffff
s_add_u32 s42, s42, 40960
s_add_u32 s43, s43, 1
s_cmp_eq_u32 s43, 3
s_cselect_b32 s45, 122880, 0
s_cselect_b32 s43, 0, s43
s_sub_u32 s42, s42, s45
s_add_u32 m0, s42, 16384
s_add_u32 s44, s41, 0
buffer_load_dwordx4 v3, s[8:11], s44 offen lds
s_add_u32 m0, s42, 20480
s_add_u32 s44, s41, 40960
buffer_load_dwordx4 v3, s[8:11], s44 offen lds
s_add_u32 m0, s42, 24576
s_add_u32 s44, s41, 81920
buffer_load_dwordx4 v3, s[8:11], s44 offen lds
s_add_u32 m0, s42, 28672
s_add_u32 s44, s41, 122880
buffer_load_dwordx4 v3, s[8:11], s44 offen lds
s_add_u32 m0, s42, 32768
s_add_u32 s44, s41, 163840
buffer_load_dwordx4 v3, s[8:11], s44 offen lds
s_add_u32 m0, s42, 0
s_add_u32 s44, s40, 0
buffer_load_dwordx4 v2, s[12:15], s44 offen sc1 lds
s_add_u32 m0, s42, 4096
s_add_u32 s44, s40, 4096
buffer_load_dwordx4 v2, s[12:15], s44 offen sc1 lds
s_add_u32 m0, s42, 8192
s_add_u32 s44, s40, 8192
buffer_load_dwordx4 v2, s[12:15], s44 offen sc1 lds
s_add_u32 m0, s42, 12288
s_add_u32 s44, s40, 12288
buffer_load_dwordx4 v2, s[12:15], s44 offen sc1 lds
s_waitcnt vmcnt(9)
s_barrier
s_sub_u32 s49, s25, 3
P2S_LL:
s_add_u32 s78, s78, 1
s_cmp_eq_u32 s78, s25
s_cselect_b32 s78, 0, s78
s_lshl_b32 s32, s78, 14
s_add_u32 s40, s68, s32
s_lshr_b32 s32, s78, 1
s_lshl_b32 s32, s32, 7
s_add_u32 s41, s69, s32
s_and_b32 s32, s78, 1
s_cmp_eq_u32 s32, 1
s_cselect_b32 s8, s62, s60
s_cselect_b32 s32, s63, s61
s_and_b32 s9, s32, 0xffff
s_add_u32 s42, s42, 40960
s_add_u32 s43, s43, 1
s_cmp_eq_u32 s43, 3
s_cselect_b32 s45, 122880, 0
s_cselect_b32 s43, 0, s43
s_sub_u32 s42, s42, s45
s_add_u32 m0, s42, 16384
s_add_u32 s44, s41, 0
buffer_load_dwordx4 v3, s[8:11], s44 offen lds
s_add_u32 m0, s42, 20480
s_add_u32 s44, s41, 40960
buffer_load_dwordx4 v3, s[8:11], s44 offen lds
s_add_u32 m0, s42, 24576
s_add_u32 s44, s41, 81920
buffer_load_dwordx4 v3, s[8:11], s44 offen lds
s_add_u32 m0, s42, 28672
s_add_u32 s44, s41, 122880
buffer_load_dwordx4 v3, s[8:11], s44 offen lds
s_add_u32 m0, s42, 32768
s_add_u32 s44, s41, 163840
buffer_load_dwordx4 v3, s[8:11], s44 offen lds
s_add_u32 m0, s42, 0
s_add_u32 s44, s40, 0
buffer_load_dwordx4 v2, s[12:15], s44 offen sc1 lds
s_add_u32 m0, s42, 4096
s_add_u32 s44, s40, 4096
buffer_load_dwordx4 v2, s[12:15], s44 offen sc1 lds
s_add_u32 m0, s42, 8192
s_add_u32 s44, s40, 8192
buffer_load_dwordx4 v2, s[12:15], s44 offen sc1 lds
s_add_u32 m0, s42, 12288
s_add_u32 s44, s40, 12288
buffer_load_dwordx4 v2, s[12:15], s44 offen sc1 lds
s_waitcnt vmcnt(9)
s_barrier
s_sub_u32 s49, s49, 1
s_cmp_lg_u32 s49, 0
s_cbranch_scc1 P2S_LL
s_waitcnt vmcnt(0)
s_barrier
s_cmp_lg_u32 s2, 0
s_cbranch_scc1 EU_14_E
s_cmp_lg_u32 s20, 5
s_cbranch_scc1 EU_14_E
v_lshlrev_b32 v4, 7, v0
v_add_u32 v4, 16318464, v4
s_mov_b32 s36, 0
EU_14_T:
buffer_load_dwordx4 v[8:11], v4, s[12:15], 0 offen sc1
buffer_load_dwordx4 v[12:15], v4, s[12:15], 0 offen offset:16 sc1
s_waitcnt vmcnt(0)
v_cmp_eq_u32 vcc, s90, v8
v_cmp_eq_u32 s[32:33], s90, v10
v_cmp_eq_u32 s[34:35], s90, v12
v_cmp_eq_u32 s[76:77], s90, v14
s_nop 1
s_and_b64 vcc, vcc, s[32:33]
s_and_b64 s[34:35], s[34:35], s[76:77]
s_and_b64 vcc, vcc, s[34:35]
s_cmp_eq_u64 vcc, -1
s_cbranch_scc1 EU_14_OK
s_add_u32 s36, s36, 1
s_cmp_lt_u32 s36, 0x4000
s_cbranch_scc1 EU_14_T
EU_14_OK:
v_mov_b32 v4, 16252928
v_mov_b32 v5, s90
s_mov_b64 exec, 1
buffer_store_dword v5, v4, s[12:15], 0 offen sc1
s_mov_b64 exec, -1
EU_14_E:
s_branch FIN
R_SSM_C:
s_lshr_b32 s32, s2, 3
s_cmp_lt_u32 s32, 8
s_cbranch_scc0 CP_15
s_cmp_eq_u32 s20, 0
s_cbranch_scc0 CP_15
s_getpc_b64 s[34:35]
CP_15_PC:
s_lshl_b32 s32, s32, 13
v_lshlrev_b32 v244, 7, v0
v_add_u32 v244, s32, v244
v_cmp_gt_u32 vcc, CODE_END-CP_15_PC, v244
s_and_saveexec_b64 s[76:77], vcc
s_cbranch_execz CP_15_X
global_load_dword v254, v244, s[34:35]
CP_15_X:
s_mov_b64 exec, s[76:77]
CP_15:
s_cmp_eq_u32 s20, 2
s_cbranch_scc0 R_SSM_NE
s_mul_i32 s33, s22, 20480
s_mul_i32 s34, s21, 1280
s_add_u32 s33, s33, s34
s_add_u32 s33, s33, 15728640
v_lshlrev_b32 v244, 7, v0
s_mov_b64 s[76:77], exec
s_mov_b64 exec, 0x3ff
buffer_load_dword v254, v244, s[12:15], s33 offen
s_mov_b64 exec, s[76:77]
R_SSM_NE:
s_lshr_b32 s30, s20, 1
s_and_b32 s31, s20, 1
v_lshrrev_b32 v1, 4, v0
v_and_b32 v2, 15, v0
s_mul_i32 s33, s22, 80
s_mul_i32 s34, s31, 40
s_add_u32 s33, s33, s34
v_lshrrev_b32 v3, 1, v2
v_add_u32 v8, s33, v3
v_lshrrev_b32 v10, 2, v2
v_and_b32 v11, 3, v2
v_lshrrev_b32 v12, 1, v11
v_lshl_or_b32 v12, v10, 1, v12
v_xor_b32 v12, v1, v12
v_lshlrev_b32 v12, 4, v12
v_lshl_add_u32 v10, v10, 4, v11
v_lshl_add_u32 v12, v10, 7, v12
s_lshl_b32 s32, s30, 13
v_add_u32 v4, s32, v12
v_xor_b32 v5, 64, v4
v_and_b32 v10, 1, v2
v_and_b32 v11, 6, v3
v_or_b32 v11, v11, v10
v_xor_b32 v11, v1, v11
v_lshlrev_b32 v11, 4, v11
v_lshl_add_u32 v11, v3, 7, v11
v_mul_u32_u24 v12, 10240, v10
v_add_u32 v11, v11, v12
s_mul_i32 s32, s31, 5120
s_add_u32 s32, s32, 16384
v_add_u32 v6, s32, v11
v_xor_b32 v7, 64, v6
s_lshl_b32 s32, s30, 2
v_add_u32 v12, s32, v1
v_add_u32 v13, 0, v8
v_lshrrev_b32 v14, 6, v13
v_and_b32 v13, 63, v13
v_lshl_add_u32 v14, v14, 1, v10
v_lshl_add_u32 v14, v14, 6, v13
v_lshlrev_b32 v14, 8, v14
v_and_b32 v15, 3, v13
v_bfe_u32 v13, v13, 3, 1
v_lshl_or_b32 v15, v13, 2, v15
v_xor_b32 v15, v12, v15
v_lshl_add_u32 v108, v15, 5, v14
v_add_u32 v13, 8, v8
v_lshrrev_b32 v14, 6, v13
v_and_b32 v13, 63, v13
v_lshl_add_u32 v14, v14, 1, v10
v_lshl_add_u32 v14, v14, 6, v13
v_lshlrev_b32 v14, 8, v14
v_and_b32 v15, 3, v13
v_bfe_u32 v13, v13, 3, 1
v_lshl_or_b32 v15, v13, 2, v15
v_xor_b32 v15, v12, v15
v_lshl_add_u32 v109, v15, 5, v14
v_add_u32 v13, 16, v8
v_lshrrev_b32 v14, 6, v13
v_and_b32 v13, 63, v13
v_lshl_add_u32 v14, v14, 1, v10
v_lshl_add_u32 v14, v14, 6, v13
v_lshlrev_b32 v14, 8, v14
v_and_b32 v15, 3, v13
v_bfe_u32 v13, v13, 3, 1
v_lshl_or_b32 v15, v13, 2, v15
v_xor_b32 v15, v12, v15
v_lshl_add_u32 v110, v15, 5, v14
v_add_u32 v13, 24, v8
v_lshrrev_b32 v14, 6, v13
v_and_b32 v13, 63, v13
v_lshl_add_u32 v14, v14, 1, v10
v_lshl_add_u32 v14, v14, 6, v13
v_lshlrev_b32 v14, 8, v14
v_and_b32 v15, 3, v13
v_bfe_u32 v13, v13, 3, 1
v_lshl_or_b32 v15, v13, 2, v15
v_xor_b32 v15, v12, v15
v_lshl_add_u32 v111, v15, 5, v14
v_add_u32 v13, 32, v8
v_lshrrev_b32 v14, 6, v13
v_and_b32 v13, 63, v13
v_lshl_add_u32 v14, v14, 1, v10
v_lshl_add_u32 v14, v14, 6, v13
v_lshlrev_b32 v14, 8, v14
v_and_b32 v15, 3, v13
v_bfe_u32 v13, v13, 3, 1
v_lshl_or_b32 v15, v13, 2, v15
v_xor_b32 v15, v12, v15
v_lshl_add_u32 v112, v15, 5, v14
v_mul_u32_u24 v13, 640, v12
v_lshl_add_u32 v13, v2, 2, v13
s_mul_i32 s32, s31, 320
s_add_u32 s32, s32, 122880
v_add_u32 v13, s32, v13
s_mul_i32 s32, s31, 1280
s_add_u32 s32, s32, 133120
v_lshlrev_b32 v14, 4, v2
v_add_u32 v14, s32, v14
s_cmp_eq_u32 s20, 3
s_cbranch_scc0 T2_16
v_lshlrev_b32 v240, 7, v0
s_mov_b32 s56, s72
s_and_b32 s57, s73, 0xffff
s_mov_b32 s58, 2211840
s_mov_b32 s59, 0x20000
s_mul_i32 s33, s2, 8640
buffer_load_dword v254, v240, s[56:59], s33 offen
s_add_u32 s33, s33, 8192
v_cmp_gt_u32 vcc, 4, v0
s_and_saveexec_b64 s[76:77], vcc
buffer_load_dword v254, v240, s[56:59], s33 offen
s_mov_b64 exec, s[76:77]
s_mul_i32 s33, s2, 3200
v_cmp_gt_u32 vcc, 25, v0
s_and_saveexec_b64 s[76:77], vcc
s_mov_b32 s56, s74
s_and_b32 s57, s75, 0xffff
s_mov_b32 s58, 819200
s_mov_b32 s59, 0x20000
buffer_load_dword v254, v240, s[56:59], s33 offen
s_mov_b32 s56, s78
s_and_b32 s57, s79, 0xffff
s_mov_b32 s58, 819200
s_mov_b32 s59, 0x20000
buffer_load_dword v254, v240, s[56:59], s33 offen
s_mov_b64 exec, s[76:77]
T2_16:
s_lshl_b32 s33, s21, 2
s_bfe_u32 s32, s22, 0x20002
s_add_u32 s33, s33, s32
s_lshl_b32 s33, s33, 7
s_add_u32 s33, s33, 16318464
v_mov_b32 v250, s33
v_and_b32 v249, 3, v0
v_lshl_add_u32 v249, v249, 3, v250
s_cmp_eq_u32 s20, 1
s_cbranch_scc0 XS_17
s_load_dword s90, s[86:87], 0
s_getreg_b32 s32, hwreg(HW_REG_XCC_ID, 0, 4)
s_and_b32 s33, s22, 3
s_lshl_b32 s33, s33, 3
s_waitcnt lgkmcnt(0)
s_add_u32 s90, s90, 1
v_mov_b32 v248, 159744
v_mov_b32 v246, s90
v_mov_b32 v247, s32
ds_write_b32 v248, v246
ds_write_b32 v248, v247 offset:8
v_add_u32 v248, s33, v250
s_mov_b64 s[76:77], exec
s_mov_b64 exec, 1
buffer_store_dwordx2 v[246:247], v248, s[12:15], 0 offen sc1
s_mov_b64 exec, s[76:77]
s_waitcnt lgkmcnt(0)
XS_17:
s_barrier
s_mov_b32 s36, 36864
s_mov_b32 s39, 36864
s_mov_b32 s29, 4294893568
s_mov_b32 s37, 0
ds_read_b128 v[32:35], v6 offset:0
ds_read_b128 v[16:19], v4 offset:0
ds_read_b128 v[36:39], v6 offset:1024
ds_read_b128 v[20:23], v4 offset:512
ds_read_b128 v[40:43], v6 offset:2048
ds_read_b128 v[24:27], v4 offset:1024
ds_read_b128 v[44:47], v6 offset:3072
ds_read_b128 v[28:31], v4 offset:1536
ds_read_b128 v[48:51], v6 offset:4096
s_mov_b32 s38, 9
.p2align 3
s_waitcnt lgkmcnt(0)
s_nop 0
v_mfma_f32_16x16x32_bf16 v[128:131], v[16:19], v[32:35], 0
ds_read_b128 v[68:71], v7 offset:0
v_mfma_f32_16x16x32_bf16 v[148:151], v[20:23], v[32:35], 0
ds_read_b128 v[52:55], v5 offset:0
v_mfma_f32_16x16x32_bf16 v[168:171], v[24:27], v[32:35], 0
ds_read_b128 v[72:75], v7 offset:1024
v_mfma_f32_16x16x32_bf16 v[188:191], v[28:31], v[32:35], 0
ds_read_b128 v[56:59], v5 offset:512
v_mfma_f32_16x16x32_bf16 v[132:135], v[16:19], v[36:39], 0
ds_read_b128 v[76:79], v7 offset:2048
v_mfma_f32_16x16x32_bf16 v[152:155], v[20:23], v[36:39], 0
ds_read_b128 v[60:63], v5 offset:1024
v_mfma_f32_16x16x32_bf16 v[172:175], v[24:27], v[36:39], 0
ds_read_b128 v[80:83], v7 offset:3072
v_mfma_f32_16x16x32_bf16 v[192:195], v[28:31], v[36:39], 0
ds_read_b128 v[64:67], v5 offset:1536
v_mfma_f32_16x16x32_bf16 v[136:139], v[16:19], v[40:43], 0
ds_read_b128 v[84:87], v7 offset:4096
v_mfma_f32_16x16x32_bf16 v[156:159], v[20:23], v[40:43], 0
v_add_u32_e64 v4, s36, v4
v_mfma_f32_16x16x32_bf16 v[176:179], v[24:27], v[40:43], 0
v_add_u32_e64 v5, s36, v5
v_mfma_f32_16x16x32_bf16 v[196:199], v[28:31], v[40:43], 0
v_add_u32_e64 v6, s36, v6
v_mfma_f32_16x16x32_bf16 v[140:143], v[16:19], v[44:47], 0
v_add_u32_e64 v7, s36, v7
v_mfma_f32_16x16x32_bf16 v[160:163], v[20:23], v[44:47], 0
v_mfma_f32_16x16x32_bf16 v[180:183], v[24:27], v[44:47], 0
v_mfma_f32_16x16x32_bf16 v[200:203], v[28:31], v[44:47], 0
v_mfma_f32_16x16x32_bf16 v[144:147], v[16:19], v[48:51], 0
v_mfma_f32_16x16x32_bf16 v[164:167], v[20:23], v[48:51], 0
v_mfma_f32_16x16x32_bf16 v[184:187], v[24:27], v[48:51], 0
v_mfma_f32_16x16x32_bf16 v[204:207], v[28:31], v[48:51], 0
s_waitcnt lgkmcnt(0)
s_barrier
v_mfma_f32_16x16x32_bf16 v[128:131], v[52:55], v[68:71], v[128:131]
ds_read_b128 v[32:35], v6 offset:0
v_mfma_f32_16x16x32_bf16 v[148:151], v[56:59], v[68:71], v[148:151]
ds_read_b128 v[16:19], v4 offset:0
v_mfma_f32_16x16x32_bf16 v[168:171], v[60:63], v[68:71], v[168:171]
ds_read_b128 v[36:39], v6 offset:1024
v_mfma_f32_16x16x32_bf16 v[188:191], v[64:67], v[68:71], v[188:191]
ds_read_b128 v[20:23], v4 offset:512
v_mfma_f32_16x16x32_bf16 v[132:135], v[52:55], v[72:75], v[132:135]
ds_read_b128 v[40:43], v6 offset:2048
v_mfma_f32_16x16x32_bf16 v[152:155], v[56:59], v[72:75], v[152:155]
ds_read_b128 v[24:27], v4 offset:1024
v_mfma_f32_16x16x32_bf16 v[172:175], v[60:63], v[72:75], v[172:175]
ds_read_b128 v[44:47], v6 offset:3072
v_mfma_f32_16x16x32_bf16 v[192:195], v[64:67], v[72:75], v[192:195]
ds_read_b128 v[28:31], v4 offset:1536
v_mfma_f32_16x16x32_bf16 v[136:139], v[52:55], v[76:79], v[136:139]
ds_read_b128 v[48:51], v6 offset:4096
v_mfma_f32_16x16x32_bf16 v[156:159], v[56:59], v[76:79], v[156:159]
s_add_u32 s37, s37, 1
s_cmp_eq_u32 s37, 2
v_mfma_f32_16x16x32_bf16 v[176:179], v[60:63], v[76:79], v[176:179]
s_cselect_b32 s36, s29, s39
s_cmp_eq_u32 s37, 3
v_mfma_f32_16x16x32_bf16 v[196:199], v[64:67], v[76:79], v[196:199]
s_cselect_b32 s37, 0, s37
s_sub_u32 s38, s38, 1
v_mfma_f32_16x16x32_bf16 v[140:143], v[52:55], v[80:83], v[140:143]
v_mfma_f32_16x16x32_bf16 v[160:163], v[56:59], v[80:83], v[160:163]
v_mfma_f32_16x16x32_bf16 v[180:183], v[60:63], v[80:83], v[180:183]
v_mfma_f32_16x16x32_bf16 v[200:203], v[64:67], v[80:83], v[200:203]
v_mfma_f32_16x16x32_bf16 v[144:147], v[52:55], v[84:87], v[144:147]
v_mfma_f32_16x16x32_bf16 v[164:167], v[56:59], v[84:87], v[164:167]
v_mfma_f32_16x16x32_bf16 v[184:187], v[60:63], v[84:87], v[184:187]
v_mfma_f32_16x16x32_bf16 v[204:207], v[64:67], v[84:87], v[204:207]
.p2align 6
SSM_LOOP:
s_waitcnt lgkmcnt(0)
s_cmp_eq_u32 s38, 4
s_cbranch_scc0 SSM_NX
s_nop 0
buffer_load_dwordx2 v[252:253], v249, s[12:15], 0 offen sc1
SSM_NX:
v_mfma_f32_16x16x32_bf16 v[128:131], v[16:19], v[32:35], v[128:131]
ds_read_b128 v[68:71], v7 offset:0
v_mfma_f32_16x16x32_bf16 v[148:151], v[20:23], v[32:35], v[148:151]
ds_read_b128 v[52:55], v5 offset:0
v_mfma_f32_16x16x32_bf16 v[168:171], v[24:27], v[32:35], v[168:171]
ds_read_b128 v[72:75], v7 offset:1024
v_mfma_f32_16x16x32_bf16 v[188:191], v[28:31], v[32:35], v[188:191]
ds_read_b128 v[56:59], v5 offset:512
v_mfma_f32_16x16x32_bf16 v[132:135], v[16:19], v[36:39], v[132:135]
ds_read_b128 v[76:79], v7 offset:2048
v_mfma_f32_16x16x32_bf16 v[152:155], v[20:23], v[36:39], v[152:155]
ds_read_b128 v[60:63], v5 offset:1024
v_mfma_f32_16x16x32_bf16 v[172:175], v[24:27], v[36:39], v[172:175]
ds_read_b128 v[80:83], v7 offset:3072
v_mfma_f32_16x16x32_bf16 v[192:195], v[28:31], v[36:39], v[192:195]
ds_read_b128 v[64:67], v5 offset:1536
v_mfma_f32_16x16x32_bf16 v[136:139], v[16:19], v[40:43], v[136:139]
ds_read_b128 v[84:87], v7 offset:4096
v_mfma_f32_16x16x32_bf16 v[156:159], v[20:23], v[40:43], v[156:159]
v_add_u32_e64 v4, s36, v4
v_mfma_f32_16x16x32_bf16 v[176:179], v[24:27], v[40:43], v[176:179]
v_add_u32_e64 v5, s36, v5
v_mfma_f32_16x16x32_bf16 v[196:199], v[28:31], v[40:43], v[196:199]
v_add_u32_e64 v6, s36, v6
v_mfma_f32_16x16x32_bf16 v[140:143], v[16:19], v[44:47], v[140:143]
v_add_u32_e64 v7, s36, v7
v_mfma_f32_16x16x32_bf16 v[160:163], v[20:23], v[44:47], v[160:163]
v_mfma_f32_16x16x32_bf16 v[180:183], v[24:27], v[44:47], v[180:183]
v_mfma_f32_16x16x32_bf16 v[200:203], v[28:31], v[44:47], v[200:203]
v_mfma_f32_16x16x32_bf16 v[144:147], v[16:19], v[48:51], v[144:147]
v_mfma_f32_16x16x32_bf16 v[164:167], v[20:23], v[48:51], v[164:167]
v_mfma_f32_16x16x32_bf16 v[184:187], v[24:27], v[48:51], v[184:187]
v_mfma_f32_16x16x32_bf16 v[204:207], v[28:31], v[48:51], v[204:207]
s_waitcnt lgkmcnt(0)
s_barrier
v_mfma_f32_16x16x32_bf16 v[128:131], v[52:55], v[68:71], v[128:131]
ds_read_b128 v[32:35], v6 offset:0
v_mfma_f32_16x16x32_bf16 v[148:151], v[56:59], v[68:71], v[148:151]
ds_read_b128 v[16:19], v4 offset:0
v_mfma_f32_16x16x32_bf16 v[168:171], v[60:63], v[68:71], v[168:171]
ds_read_b128 v[36:39], v6 offset:1024
v_mfma_f32_16x16x32_bf16 v[188:191], v[64:67], v[68:71], v[188:191]
ds_read_b128 v[20:23], v4 offset:512
v_mfma_f32_16x16x32_bf16 v[132:135], v[52:55], v[72:75], v[132:135]
ds_read_b128 v[40:43], v6 offset:2048
v_mfma_f32_16x16x32_bf16 v[152:155], v[56:59], v[72:75], v[152:155]
ds_read_b128 v[24:27], v4 offset:1024
v_mfma_f32_16x16x32_bf16 v[172:175], v[60:63], v[72:75], v[172:175]
ds_read_b128 v[44:47], v6 offset:3072
v_mfma_f32_16x16x32_bf16 v[192:195], v[64:67], v[72:75], v[192:195]
ds_read_b128 v[28:31], v4 offset:1536
v_mfma_f32_16x16x32_bf16 v[136:139], v[52:55], v[76:79], v[136:139]
ds_read_b128 v[48:51], v6 offset:4096
v_mfma_f32_16x16x32_bf16 v[156:159], v[56:59], v[76:79], v[156:159]
s_add_u32 s37, s37, 1
s_cmp_eq_u32 s37, 2
v_mfma_f32_16x16x32_bf16 v[176:179], v[60:63], v[76:79], v[176:179]
s_cselect_b32 s36, s29, s39
s_cmp_eq_u32 s37, 3
v_mfma_f32_16x16x32_bf16 v[196:199], v[64:67], v[76:79], v[196:199]
s_cselect_b32 s37, 0, s37
s_sub_u32 s38, s38, 1
v_mfma_f32_16x16x32_bf16 v[140:143], v[52:55], v[80:83], v[140:143]
v_mfma_f32_16x16x32_bf16 v[160:163], v[56:59], v[80:83], v[160:163]
v_mfma_f32_16x16x32_bf16 v[180:183], v[60:63], v[80:83], v[180:183]
v_mfma_f32_16x16x32_bf16 v[200:203], v[64:67], v[80:83], v[200:203]
v_mfma_f32_16x16x32_bf16 v[144:147], v[52:55], v[84:87], v[144:147]
v_mfma_f32_16x16x32_bf16 v[164:167], v[56:59], v[84:87], v[164:167]
v_mfma_f32_16x16x32_bf16 v[184:187], v[60:63], v[84:87], v[184:187]
v_mfma_f32_16x16x32_bf16 v[204:207], v[64:67], v[84:87], v[204:207]
s_cmp_lg_u32 s38, 0
s_cbranch_scc1 SSM_LOOP
s_waitcnt lgkmcnt(0)
s_nop 0
v_mfma_f32_16x16x32_bf16 v[128:131], v[16:19], v[32:35], v[128:131]
ds_read_b128 v[68:71], v7 offset:0
v_mfma_f32_16x16x32_bf16 v[148:151], v[20:23], v[32:35], v[148:151]
ds_read_b128 v[52:55], v5 offset:0
v_mfma_f32_16x16x32_bf16 v[168:171], v[24:27], v[32:35], v[168:171]
ds_read_b128 v[72:75], v7 offset:1024
v_mfma_f32_16x16x32_bf16 v[188:191], v[28:31], v[32:35], v[188:191]
ds_read_b128 v[56:59], v5 offset:512
v_mfma_f32_16x16x32_bf16 v[132:135], v[16:19], v[36:39], v[132:135]
ds_read_b128 v[76:79], v7 offset:2048
v_mfma_f32_16x16x32_bf16 v[152:155], v[20:23], v[36:39], v[152:155]
ds_read_b128 v[60:63], v5 offset:1024
v_mfma_f32_16x16x32_bf16 v[172:175], v[24:27], v[36:39], v[172:175]
ds_read_b128 v[80:83], v7 offset:3072
v_mfma_f32_16x16x32_bf16 v[192:195], v[28:31], v[36:39], v[192:195]
ds_read_b128 v[64:67], v5 offset:1536
v_mfma_f32_16x16x32_bf16 v[136:139], v[16:19], v[40:43], v[136:139]
ds_read_b128 v[84:87], v7 offset:4096
v_mfma_f32_16x16x32_bf16 v[156:159], v[20:23], v[40:43], v[156:159]
v_mfma_f32_16x16x32_bf16 v[176:179], v[24:27], v[40:43], v[176:179]
v_mfma_f32_16x16x32_bf16 v[196:199], v[28:31], v[40:43], v[196:199]
v_mfma_f32_16x16x32_bf16 v[140:143], v[16:19], v[44:47], v[140:143]
v_mfma_f32_16x16x32_bf16 v[160:163], v[20:23], v[44:47], v[160:163]
v_mfma_f32_16x16x32_bf16 v[180:183], v[24:27], v[44:47], v[180:183]
v_mfma_f32_16x16x32_bf16 v[200:203], v[28:31], v[44:47], v[200:203]
v_mfma_f32_16x16x32_bf16 v[144:147], v[16:19], v[48:51], v[144:147]
v_mfma_f32_16x16x32_bf16 v[164:167], v[20:23], v[48:51], v[164:167]
v_mfma_f32_16x16x32_bf16 v[184:187], v[24:27], v[48:51], v[184:187]
v_mfma_f32_16x16x32_bf16 v[204:207], v[28:31], v[48:51], v[204:207]
s_waitcnt lgkmcnt(0)
s_nop 0
v_mfma_f32_16x16x32_bf16 v[128:131], v[52:55], v[68:71], v[128:131]
ds_read_b128 v[88:91], v14 offset:0
v_mfma_f32_16x16x32_bf16 v[148:151], v[56:59], v[68:71], v[148:151]
ds_read_b128 v[92:95], v14 offset:256
v_mfma_f32_16x16x32_bf16 v[168:171], v[60:63], v[68:71], v[168:171]
ds_read_b128 v[96:99], v14 offset:512
v_mfma_f32_16x16x32_bf16 v[188:191], v[64:67], v[68:71], v[188:191]
ds_read_b128 v[100:103], v14 offset:768
v_mfma_f32_16x16x32_bf16 v[132:135], v[52:55], v[72:75], v[132:135]
ds_read_b128 v[104:107], v14 offset:1024
v_mfma_f32_16x16x32_bf16 v[152:155], v[56:59], v[72:75], v[152:155]
v_mfma_f32_16x16x32_bf16 v[172:175], v[60:63], v[72:75], v[172:175]
v_mfma_f32_16x16x32_bf16 v[192:195], v[64:67], v[72:75], v[192:195]
v_mfma_f32_16x16x32_bf16 v[136:139], v[52:55], v[76:79], v[136:139]
v_mfma_f32_16x16x32_bf16 v[156:159], v[56:59], v[76:79], v[156:159]
v_mfma_f32_16x16x32_bf16 v[176:179], v[60:63], v[76:79], v[176:179]
v_mfma_f32_16x16x32_bf16 v[196:199], v[64:67], v[76:79], v[196:199]
v_mfma_f32_16x16x32_bf16 v[140:143], v[52:55], v[80:83], v[140:143]
v_mfma_f32_16x16x32_bf16 v[160:163], v[56:59], v[80:83], v[160:163]
v_mfma_f32_16x16x32_bf16 v[180:183], v[60:63], v[80:83], v[180:183]
v_mfma_f32_16x16x32_bf16 v[200:203], v[64:67], v[80:83], v[200:203]
v_mfma_f32_16x16x32_bf16 v[144:147], v[52:55], v[84:87], v[144:147]
v_mfma_f32_16x16x32_bf16 v[164:167], v[56:59], v[84:87], v[164:167]
v_mfma_f32_16x16x32_bf16 v[184:187], v[60:63], v[84:87], v[184:187]
v_mfma_f32_16x16x32_bf16 v[204:207], v[64:67], v[84:87], v[204:207]
s_waitcnt lgkmcnt(0)
s_nop 4
v_fmac_f32 v129, v88, v128
v_fmac_f32 v133, v92, v132
v_fmac_f32 v137, v96, v136
v_fmac_f32 v141, v100, v140
v_fmac_f32 v145, v104, v144
v_fmac_f32_dpp v129, v128, v89 quad_perm:[1,0,3,2] row_mask:0xf bank_mask:0xf
v_fmac_f32_dpp v133, v132, v93 quad_perm:[1,0,3,2] row_mask:0xf bank_mask:0xf
v_fmac_f32_dpp v137, v136, v97 quad_perm:[1,0,3,2] row_mask:0xf bank_mask:0xf
v_fmac_f32_dpp v141, v140, v101 quad_perm:[1,0,3,2] row_mask:0xf bank_mask:0xf
v_fmac_f32_dpp v145, v144, v105 quad_perm:[1,0,3,2] row_mask:0xf bank_mask:0xf
v_fmac_f32 v130, v88, v129
v_fmac_f32 v134, v92, v133
v_fmac_f32 v138, v96, v137
v_fmac_f32 v142, v100, v141
v_fmac_f32 v146, v104, v145
v_fmac_f32_dpp v130, v129, v89 quad_perm:[1,0,3,2] row_mask:0xf bank_mask:0xf
v_fmac_f32_dpp v134, v133, v93 quad_perm:[1,0,3,2] row_mask:0xf bank_mask:0xf
v_fmac_f32_dpp v138, v137, v97 quad_perm:[1,0,3,2] row_mask:0xf bank_mask:0xf
v_fmac_f32_dpp v142, v141, v101 quad_perm:[1,0,3,2] row_mask:0xf bank_mask:0xf
v_fmac_f32_dpp v146, v145, v105 quad_perm:[1,0,3,2] row_mask:0xf bank_mask:0xf
v_fmac_f32 v131, v88, v130
v_fmac_f32 v135, v92, v134
v_fmac_f32 v139, v96, v138
v_fmac_f32 v143, v100, v142
v_fmac_f32 v147, v104, v146
v_fmac_f32_dpp v131, v130, v89 quad_perm:[1,0,3,2] row_mask:0xf bank_mask:0xf
v_fmac_f32_dpp v135, v134, v93 quad_perm:[1,0,3,2] row_mask:0xf bank_mask:0xf
v_fmac_f32_dpp v139, v138, v97 quad_perm:[1,0,3,2] row_mask:0xf bank_mask:0xf
v_fmac_f32_dpp v143, v142, v101 quad_perm:[1,0,3,2] row_mask:0xf bank_mask:0xf
v_fmac_f32_dpp v147, v146, v105 quad_perm:[1,0,3,2] row_mask:0xf bank_mask:0xf
v_fmac_f32 v148, v88, v131
v_fmac_f32 v152, v92, v135
v_fmac_f32 v156, v96, v139
v_fmac_f32 v160, v100, v143
v_fmac_f32 v164, v104, v147
v_fmac_f32_dpp v148, v131, v89 quad_perm:[1,0,3,2] row_mask:0xf bank_mask:0xf
v_fmac_f32_dpp v152, v135, v93 quad_perm:[1,0,3,2] row_mask:0xf bank_mask:0xf
v_fmac_f32_dpp v156, v139, v97 quad_perm:[1,0,3,2] row_mask:0xf bank_mask:0xf
v_fmac_f32_dpp v160, v143, v101 quad_perm:[1,0,3,2] row_mask:0xf bank_mask:0xf
v_fmac_f32_dpp v164, v147, v105 quad_perm:[1,0,3,2] row_mask:0xf bank_mask:0xf
v_fmac_f32 v149, v88, v148
v_fmac_f32 v153, v92, v152
v_fmac_f32 v157, v96, v156
v_fmac_f32 v161, v100, v160
v_fmac_f32 v165, v104, v164
v_fmac_f32_dpp v149, v148, v89 quad_perm:[1,0,3,2] row_mask:0xf bank_mask:0xf
v_fmac_f32_dpp v153, v152, v93 quad_perm:[1,0,3,2] row_mask:0xf bank_mask:0xf
v_fmac_f32_dpp v157, v156, v97 quad_perm:[1,0,3,2] row_mask:0xf bank_mask:0xf
v_fmac_f32_dpp v161, v160, v101 quad_perm:[1,0,3,2] row_mask:0xf bank_mask:0xf
v_fmac_f32_dpp v165, v164, v105 quad_perm:[1,0,3,2] row_mask:0xf bank_mask:0xf
v_fmac_f32 v150, v88, v149
v_fmac_f32 v154, v92, v153
v_fmac_f32 v158, v96, v157
v_fmac_f32 v162, v100, v161
v_fmac_f32 v166, v104, v165
v_fmac_f32_dpp v150, v149, v89 quad_perm:[1,0,3,2] row_mask:0xf bank_mask:0xf
v_fmac_f32_dpp v154, v153, v93 quad_perm:[1,0,3,2] row_mask:0xf bank_mask:0xf
v_fmac_f32_dpp v158, v157, v97 quad_perm:[1,0,3,2] row_mask:0xf bank_mask:0xf
v_fmac_f32_dpp v162, v161, v101 quad_perm:[1,0,3,2] row_mask:0xf bank_mask:0xf
v_fmac_f32_dpp v166, v165, v105 quad_perm:[1,0,3,2] row_mask:0xf bank_mask:0xf
v_fmac_f32 v151, v88, v150
v_fmac_f32 v155, v92, v154
v_fmac_f32 v159, v96, v158
v_fmac_f32 v163, v100, v162
v_fmac_f32 v167, v104, v166
v_fmac_f32_dpp v151, v150, v89 quad_perm:[1,0,3,2] row_mask:0xf bank_mask:0xf
v_fmac_f32_dpp v155, v154, v93 quad_perm:[1,0,3,2] row_mask:0xf bank_mask:0xf
v_fmac_f32_dpp v159, v158, v97 quad_perm:[1,0,3,2] row_mask:0xf bank_mask:0xf
v_fmac_f32_dpp v163, v162, v101 quad_perm:[1,0,3,2] row_mask:0xf bank_mask:0xf
v_fmac_f32_dpp v167, v166, v105 quad_perm:[1,0,3,2] row_mask:0xf bank_mask:0xf
v_fmac_f32 v168, v88, v151
v_fmac_f32 v172, v92, v155
v_fmac_f32 v176, v96, v159
v_fmac_f32 v180, v100, v163
v_fmac_f32 v184, v104, v167
v_fmac_f32_dpp v168, v151, v89 quad_perm:[1,0,3,2] row_mask:0xf bank_mask:0xf
v_fmac_f32_dpp v172, v155, v93 quad_perm:[1,0,3,2] row_mask:0xf bank_mask:0xf
v_fmac_f32_dpp v176, v159, v97 quad_perm:[1,0,3,2] row_mask:0xf bank_mask:0xf
v_fmac_f32_dpp v180, v163, v101 quad_perm:[1,0,3,2] row_mask:0xf bank_mask:0xf
v_fmac_f32_dpp v184, v167, v105 quad_perm:[1,0,3,2] row_mask:0xf bank_mask:0xf
v_fmac_f32 v169, v88, v168
v_fmac_f32 v173, v92, v172
v_fmac_f32 v177, v96, v176
v_fmac_f32 v181, v100, v180
v_fmac_f32 v185, v104, v184
v_fmac_f32_dpp v169, v168, v89 quad_perm:[1,0,3,2] row_mask:0xf bank_mask:0xf
v_fmac_f32_dpp v173, v172, v93 quad_perm:[1,0,3,2] row_mask:0xf bank_mask:0xf
v_fmac_f32_dpp v177, v176, v97 quad_perm:[1,0,3,2] row_mask:0xf bank_mask:0xf
v_fmac_f32_dpp v181, v180, v101 quad_perm:[1,0,3,2] row_mask:0xf bank_mask:0xf
v_fmac_f32_dpp v185, v184, v105 quad_perm:[1,0,3,2] row_mask:0xf bank_mask:0xf
v_fmac_f32 v170, v88, v169
v_fmac_f32 v174, v92, v173
v_fmac_f32 v178, v96, v177
v_fmac_f32 v182, v100, v181
v_fmac_f32 v186, v104, v185
v_fmac_f32_dpp v170, v169, v89 quad_perm:[1,0,3,2] row_mask:0xf bank_mask:0xf
v_fmac_f32_dpp v174, v173, v93 quad_perm:[1,0,3,2] row_mask:0xf bank_mask:0xf
v_fmac_f32_dpp v178, v177, v97 quad_perm:[1,0,3,2] row_mask:0xf bank_mask:0xf
v_fmac_f32_dpp v182, v181, v101 quad_perm:[1,0,3,2] row_mask:0xf bank_mask:0xf
v_fmac_f32_dpp v186, v185, v105 quad_perm:[1,0,3,2] row_mask:0xf bank_mask:0xf
v_fmac_f32 v171, v88, v170
v_fmac_f32 v175, v92, v174
v_fmac_f32 v179, v96, v178
v_fmac_f32 v183, v100, v182
v_fmac_f32 v187, v104, v186
v_fmac_f32_dpp v171, v170, v89 quad_perm:[1,0,3,2] row_mask:0xf bank_mask:0xf
v_fmac_f32_dpp v175, v174, v93 quad_perm:[1,0,3,2] row_mask:0xf bank_mask:0xf
v_fmac_f32_dpp v179, v178, v97 quad_perm:[1,0,3,2] row_mask:0xf bank_mask:0xf
v_fmac_f32_dpp v183, v182, v101 quad_perm:[1,0,3,2] row_mask:0xf bank_mask:0xf
v_fmac_f32_dpp v187, v186, v105 quad_perm:[1,0,3,2] row_mask:0xf bank_mask:0xf
v_fmac_f32 v188, v88, v171
v_fmac_f32 v192, v92, v175
v_fmac_f32 v196, v96, v179
v_fmac_f32 v200, v100, v183
v_fmac_f32 v204, v104, v187
v_fmac_f32_dpp v188, v171, v89 quad_perm:[1,0,3,2] row_mask:0xf bank_mask:0xf
v_fmac_f32_dpp v192, v175, v93 quad_perm:[1,0,3,2] row_mask:0xf bank_mask:0xf
v_fmac_f32_dpp v196, v179, v97 quad_perm:[1,0,3,2] row_mask:0xf bank_mask:0xf
v_fmac_f32_dpp v200, v183, v101 quad_perm:[1,0,3,2] row_mask:0xf bank_mask:0xf
v_fmac_f32_dpp v204, v187, v105 quad_perm:[1,0,3,2] row_mask:0xf bank_mask:0xf
v_fmac_f32 v189, v88, v188
v_fmac_f32 v193, v92, v192
v_fmac_f32 v197, v96, v196
v_fmac_f32 v201, v100, v200
v_fmac_f32 v205, v104, v204
v_fmac_f32_dpp v189, v188, v89 quad_perm:[1,0,3,2] row_mask:0xf bank_mask:0xf
v_fmac_f32_dpp v193, v192, v93 quad_perm:[1,0,3,2] row_mask:0xf bank_mask:0xf
v_fmac_f32_dpp v197, v196, v97 quad_perm:[1,0,3,2] row_mask:0xf bank_mask:0xf
v_fmac_f32_dpp v201, v200, v101 quad_perm:[1,0,3,2] row_mask:0xf bank_mask:0xf
v_fmac_f32_dpp v205, v204, v105 quad_perm:[1,0,3,2] row_mask:0xf bank_mask:0xf
v_fmac_f32 v190, v88, v189
v_fmac_f32 v194, v92, v193
v_fmac_f32 v198, v96, v197
v_fmac_f32 v202, v100, v201
v_fmac_f32 v206, v104, v205
v_fmac_f32_dpp v190, v189, v89 quad_perm:[1,0,3,2] row_mask:0xf bank_mask:0xf
v_fmac_f32_dpp v194, v193, v93 quad_perm:[1,0,3,2] row_mask:0xf bank_mask:0xf
v_fmac_f32_dpp v198, v197, v97 quad_perm:[1,0,3,2] row_mask:0xf bank_mask:0xf
v_fmac_f32_dpp v202, v201, v101 quad_perm:[1,0,3,2] row_mask:0xf bank_mask:0xf
v_fmac_f32_dpp v206, v205, v105 quad_perm:[1,0,3,2] row_mask:0xf bank_mask:0xf
v_fmac_f32 v191, v88, v190
v_fmac_f32 v195, v92, v194
v_fmac_f32 v199, v96, v198
v_fmac_f32 v203, v100, v202
v_fmac_f32 v207, v104, v206
v_fmac_f32_dpp v191, v190, v89 quad_perm:[1,0,3,2] row_mask:0xf bank_mask:0xf
v_fmac_f32_dpp v195, v194, v93 quad_perm:[1,0,3,2] row_mask:0xf bank_mask:0xf
v_fmac_f32_dpp v199, v198, v97 quad_perm:[1,0,3,2] row_mask:0xf bank_mask:0xf
v_fmac_f32_dpp v203, v202, v101 quad_perm:[1,0,3,2] row_mask:0xf bank_mask:0xf
v_fmac_f32_dpp v207, v206, v105 quad_perm:[1,0,3,2] row_mask:0xf bank_mask:0xf
ds_write_b32 v13, v191 offset:0
ds_write_b32 v13, v195 offset:64
ds_write_b32 v13, v199 offset:128
ds_write_b32 v13, v203 offset:192
ds_write_b32 v13, v207 offset:256
s_waitcnt lgkmcnt(0)
s_barrier
v_mul_f32 v16, v90, v128
v_mul_f32 v17, v94, v132
v_mul_f32 v18, v98, v136
v_mul_f32 v19, v102, v140
v_mul_f32 v20, v106, v144
v_fmac_f32_dpp v16, v128, v91 quad_perm:[1,0,3,2] row_mask:0xf bank_mask:0xf
v_fmac_f32_dpp v17, v132, v95 quad_perm:[1,0,3,2] row_mask:0xf bank_mask:0xf
v_fmac_f32_dpp v18, v136, v99 quad_perm:[1,0,3,2] row_mask:0xf bank_mask:0xf
v_fmac_f32_dpp v19, v140, v103 quad_perm:[1,0,3,2] row_mask:0xf bank_mask:0xf
v_fmac_f32_dpp v20, v144, v107 quad_perm:[1,0,3,2] row_mask:0xf bank_mask:0xf
v_mul_f32 v21, v90, v129
v_mul_f32 v22, v94, v133
v_mul_f32 v23, v98, v137
v_mul_f32 v24, v102, v141
v_mul_f32 v25, v106, v145
v_fmac_f32_dpp v21, v129, v91 quad_perm:[1,0,3,2] row_mask:0xf bank_mask:0xf
v_fmac_f32_dpp v22, v133, v95 quad_perm:[1,0,3,2] row_mask:0xf bank_mask:0xf
v_fmac_f32_dpp v23, v137, v99 quad_perm:[1,0,3,2] row_mask:0xf bank_mask:0xf
v_fmac_f32_dpp v24, v141, v103 quad_perm:[1,0,3,2] row_mask:0xf bank_mask:0xf
v_fmac_f32_dpp v25, v145, v107 quad_perm:[1,0,3,2] row_mask:0xf bank_mask:0xf
v_mul_f32 v26, v90, v130
v_mul_f32 v27, v94, v134
v_mul_f32 v28, v98, v138
v_mul_f32 v29, v102, v142
v_mul_f32 v30, v106, v146
v_fmac_f32_dpp v26, v130, v91 quad_perm:[1,0,3,2] row_mask:0xf bank_mask:0xf
v_fmac_f32_dpp v27, v134, v95 quad_perm:[1,0,3,2] row_mask:0xf bank_mask:0xf
v_fmac_f32_dpp v28, v138, v99 quad_perm:[1,0,3,2] row_mask:0xf bank_mask:0xf
v_fmac_f32_dpp v29, v142, v103 quad_perm:[1,0,3,2] row_mask:0xf bank_mask:0xf
v_fmac_f32_dpp v30, v146, v107 quad_perm:[1,0,3,2] row_mask:0xf bank_mask:0xf
v_mul_f32 v31, v90, v131
v_mul_f32 v32, v94, v135
v_mul_f32 v33, v98, v139
v_mul_f32 v34, v102, v143
v_mul_f32 v35, v106, v147
v_fmac_f32_dpp v31, v131, v91 quad_perm:[1,0,3,2] row_mask:0xf bank_mask:0xf
v_fmac_f32_dpp v32, v135, v95 quad_perm:[1,0,3,2] row_mask:0xf bank_mask:0xf
v_fmac_f32_dpp v33, v139, v99 quad_perm:[1,0,3,2] row_mask:0xf bank_mask:0xf
v_fmac_f32_dpp v34, v143, v103 quad_perm:[1,0,3,2] row_mask:0xf bank_mask:0xf
v_fmac_f32_dpp v35, v147, v107 quad_perm:[1,0,3,2] row_mask:0xf bank_mask:0xf
v_mul_f32 v36, v90, v148
v_mul_f32 v37, v94, v152
v_mul_f32 v38, v98, v156
v_mul_f32 v39, v102, v160
v_mul_f32 v40, v106, v164
v_fmac_f32_dpp v36, v148, v91 quad_perm:[1,0,3,2] row_mask:0xf bank_mask:0xf
v_fmac_f32_dpp v37, v152, v95 quad_perm:[1,0,3,2] row_mask:0xf bank_mask:0xf
v_fmac_f32_dpp v38, v156, v99 quad_perm:[1,0,3,2] row_mask:0xf bank_mask:0xf
v_fmac_f32_dpp v39, v160, v103 quad_perm:[1,0,3,2] row_mask:0xf bank_mask:0xf
v_fmac_f32_dpp v40, v164, v107 quad_perm:[1,0,3,2] row_mask:0xf bank_mask:0xf
v_mul_f32 v41, v90, v149
v_mul_f32 v42, v94, v153
v_mul_f32 v43, v98, v157
v_mul_f32 v44, v102, v161
v_mul_f32 v45, v106, v165
v_fmac_f32_dpp v41, v149, v91 quad_perm:[1,0,3,2] row_mask:0xf bank_mask:0xf
v_fmac_f32_dpp v42, v153, v95 quad_perm:[1,0,3,2] row_mask:0xf bank_mask:0xf
v_fmac_f32_dpp v43, v157, v99 quad_perm:[1,0,3,2] row_mask:0xf bank_mask:0xf
v_fmac_f32_dpp v44, v161, v103 quad_perm:[1,0,3,2] row_mask:0xf bank_mask:0xf
v_fmac_f32_dpp v45, v165, v107 quad_perm:[1,0,3,2] row_mask:0xf bank_mask:0xf
v_mul_f32 v46, v90, v150
v_mul_f32 v47, v94, v154
v_mul_f32 v48, v98, v158
v_mul_f32 v49, v102, v162
v_mul_f32 v50, v106, v166
v_fmac_f32_dpp v46, v150, v91 quad_perm:[1,0,3,2] row_mask:0xf bank_mask:0xf
v_fmac_f32_dpp v47, v154, v95 quad_perm:[1,0,3,2] row_mask:0xf bank_mask:0xf
v_fmac_f32_dpp v48, v158, v99 quad_perm:[1,0,3,2] row_mask:0xf bank_mask:0xf
v_fmac_f32_dpp v49, v162, v103 quad_perm:[1,0,3,2] row_mask:0xf bank_mask:0xf
v_fmac_f32_dpp v50, v166, v107 quad_perm:[1,0,3,2] row_mask:0xf bank_mask:0xf
v_mul_f32 v51, v90, v151
v_mul_f32 v52, v94, v155
v_mul_f32 v53, v98, v159
v_mul_f32 v54, v102, v163
v_mul_f32 v55, v106, v167
v_fmac_f32_dpp v51, v151, v91 quad_perm:[1,0,3,2] row_mask:0xf bank_mask:0xf
v_fmac_f32_dpp v52, v155, v95 quad_perm:[1,0,3,2] row_mask:0xf bank_mask:0xf
v_fmac_f32_dpp v53, v159, v99 quad_perm:[1,0,3,2] row_mask:0xf bank_mask:0xf
v_fmac_f32_dpp v54, v163, v103 quad_perm:[1,0,3,2] row_mask:0xf bank_mask:0xf
v_fmac_f32_dpp v55, v167, v107 quad_perm:[1,0,3,2] row_mask:0xf bank_mask:0xf
v_mul_f32 v56, v90, v168
v_mul_f32 v57, v94, v172
v_mul_f32 v58, v98, v176
v_mul_f32 v59, v102, v180
v_mul_f32 v60, v106, v184
v_fmac_f32_dpp v56, v168, v91 quad_perm:[1,0,3,2] row_mask:0xf bank_mask:0xf
v_fmac_f32_dpp v57, v172, v95 quad_perm:[1,0,3,2] row_mask:0xf bank_mask:0xf
v_fmac_f32_dpp v58, v176, v99 quad_perm:[1,0,3,2] row_mask:0xf bank_mask:0xf
v_fmac_f32_dpp v59, v180, v103 quad_perm:[1,0,3,2] row_mask:0xf bank_mask:0xf
v_fmac_f32_dpp v60, v184, v107 quad_perm:[1,0,3,2] row_mask:0xf bank_mask:0xf
v_mul_f32 v61, v90, v169
v_mul_f32 v62, v94, v173
v_mul_f32 v63, v98, v177
v_mul_f32 v64, v102, v181
v_mul_f32 v65, v106, v185
v_fmac_f32_dpp v61, v169, v91 quad_perm:[1,0,3,2] row_mask:0xf bank_mask:0xf
v_fmac_f32_dpp v62, v173, v95 quad_perm:[1,0,3,2] row_mask:0xf bank_mask:0xf
v_fmac_f32_dpp v63, v177, v99 quad_perm:[1,0,3,2] row_mask:0xf bank_mask:0xf
v_fmac_f32_dpp v64, v181, v103 quad_perm:[1,0,3,2] row_mask:0xf bank_mask:0xf
v_fmac_f32_dpp v65, v185, v107 quad_perm:[1,0,3,2] row_mask:0xf bank_mask:0xf
v_mul_f32 v66, v90, v170
v_mul_f32 v67, v94, v174
v_mul_f32 v68, v98, v178
v_mul_f32 v69, v102, v182
v_mul_f32 v70, v106, v186
v_fmac_f32_dpp v66, v170, v91 quad_perm:[1,0,3,2] row_mask:0xf bank_mask:0xf
v_fmac_f32_dpp v67, v174, v95 quad_perm:[1,0,3,2] row_mask:0xf bank_mask:0xf
v_fmac_f32_dpp v68, v178, v99 quad_perm:[1,0,3,2] row_mask:0xf bank_mask:0xf
v_fmac_f32_dpp v69, v182, v103 quad_perm:[1,0,3,2] row_mask:0xf bank_mask:0xf
v_fmac_f32_dpp v70, v186, v107 quad_perm:[1,0,3,2] row_mask:0xf bank_mask:0xf
v_mul_f32 v71, v90, v171
v_mul_f32 v72, v94, v175
v_mul_f32 v73, v98, v179
v_mul_f32 v74, v102, v183
v_mul_f32 v75, v106, v187
v_fmac_f32_dpp v71, v171, v91 quad_perm:[1,0,3,2] row_mask:0xf bank_mask:0xf
v_fmac_f32_dpp v72, v175, v95 quad_perm:[1,0,3,2] row_mask:0xf bank_mask:0xf
v_fmac_f32_dpp v73, v179, v99 quad_perm:[1,0,3,2] row_mask:0xf bank_mask:0xf
v_fmac_f32_dpp v74, v183, v103 quad_perm:[1,0,3,2] row_mask:0xf bank_mask:0xf
v_fmac_f32_dpp v75, v187, v107 quad_perm:[1,0,3,2] row_mask:0xf bank_mask:0xf
v_mul_f32 v76, v90, v188
v_mul_f32 v77, v94, v192
v_mul_f32 v78, v98, v196
v_mul_f32 v79, v102, v200
v_mul_f32 v80, v106, v204
v_fmac_f32_dpp v76, v188, v91 quad_perm:[1,0,3,2] row_mask:0xf bank_mask:0xf
v_fmac_f32_dpp v77, v192, v95 quad_perm:[1,0,3,2] row_mask:0xf bank_mask:0xf
v_fmac_f32_dpp v78, v196, v99 quad_perm:[1,0,3,2] row_mask:0xf bank_mask:0xf
v_fmac_f32_dpp v79, v200, v103 quad_perm:[1,0,3,2] row_mask:0xf bank_mask:0xf
v_fmac_f32_dpp v80, v204, v107 quad_perm:[1,0,3,2] row_mask:0xf bank_mask:0xf
v_mul_f32 v81, v90, v189
v_mul_f32 v82, v94, v193
v_mul_f32 v83, v98, v197
v_mul_f32 v84, v102, v201
v_mul_f32 v85, v106, v205
v_fmac_f32_dpp v81, v189, v91 quad_perm:[1,0,3,2] row_mask:0xf bank_mask:0xf
v_fmac_f32_dpp v82, v193, v95 quad_perm:[1,0,3,2] row_mask:0xf bank_mask:0xf
v_fmac_f32_dpp v83, v197, v99 quad_perm:[1,0,3,2] row_mask:0xf bank_mask:0xf
v_fmac_f32_dpp v84, v201, v103 quad_perm:[1,0,3,2] row_mask:0xf bank_mask:0xf
v_fmac_f32_dpp v85, v205, v107 quad_perm:[1,0,3,2] row_mask:0xf bank_mask:0xf
v_mul_f32 v86, v90, v190
v_mul_f32 v87, v94, v194
v_mul_f32 v208, v98, v198
v_mul_f32 v209, v102, v202
v_mul_f32 v210, v106, v206
v_fmac_f32_dpp v86, v190, v91 quad_perm:[1,0,3,2] row_mask:0xf bank_mask:0xf
v_fmac_f32_dpp v87, v194, v95 quad_perm:[1,0,3,2] row_mask:0xf bank_mask:0xf
v_fmac_f32_dpp v208, v198, v99 quad_perm:[1,0,3,2] row_mask:0xf bank_mask:0xf
v_fmac_f32_dpp v209, v202, v103 quad_perm:[1,0,3,2] row_mask:0xf bank_mask:0xf
v_fmac_f32_dpp v210, v206, v107 quad_perm:[1,0,3,2] row_mask:0xf bank_mask:0xf
v_mul_f32 v211, v90, v191
v_mul_f32 v212, v94, v195
v_mul_f32 v213, v98, v199
v_mul_f32 v214, v102, v203
v_mul_f32 v215, v106, v207
v_fmac_f32_dpp v211, v191, v91 quad_perm:[1,0,3,2] row_mask:0xf bank_mask:0xf
v_fmac_f32_dpp v212, v195, v95 quad_perm:[1,0,3,2] row_mask:0xf bank_mask:0xf
v_fmac_f32_dpp v213, v199, v99 quad_perm:[1,0,3,2] row_mask:0xf bank_mask:0xf
v_fmac_f32_dpp v214, v203, v103 quad_perm:[1,0,3,2] row_mask:0xf bank_mask:0xf
v_fmac_f32_dpp v215, v207, v107 quad_perm:[1,0,3,2] row_mask:0xf bank_mask:0xf
v_mov_b32 v248, 159744
ds_read_b32 v251, v248
ds_read_b32 v250, v248 offset:8
s_waitcnt lgkmcnt(0)
v_readfirstlane_b32 s90, v251
v_readfirstlane_b32 s32, v250
s_mov_b32 s36, 0
XC_18_T:
s_waitcnt vmcnt(0)
v_cmp_eq_u32 vcc, s90, v252
s_nop 1
s_cmp_eq_u64 vcc, -1
s_cbranch_scc1 XC_18_OK
s_add_u32 s36, s36, 1
s_cmp_lt_u32 s36, 0x4000
s_cbranch_scc0 XC_18_OK
buffer_load_dwordx2 v[252:253], v249, s[12:15], 0 offen sc1
s_branch XC_18_T
XC_18_OK:
v_cmp_eq_u32 vcc, s32, v253
s_nop 1
s_cmp_eq_u64 vcc, -1
s_cselect_b32 s91, 1, 0
s_cmp_eq_u32 s20, 0
s_cbranch_scc0 XC_18_E
v_mov_b32 v251, s91
ds_write_b32 v248, v251 offset:4
s_waitcnt lgkmcnt(0)
XC_18_E:
s_and_b32 s23, s22, 3
s_lshr_b32 s24, s22, 2
s_mov_b32 s25, 10
v_lshrrev_b32 v250, 4, v0
v_and_b32 v251, 15, v0
v_bfe_u32 v252, v0, 2, 2
v_and_b32 v253, 3, v0
v_lshl_add_u32 v248, v250, 3, v252
v_lshlrev_b32 v248, 8, v248
v_lshl_add_u32 v248, v253, 3, v248
v_and_b32 v249, 1, v250
v_lshl_or_b32 v249, v249, 2, v252
s_lshl_b32 s32, s30, 2
s_add_u32 s33, s32, 0
v_xor_b32 v253, s33, v249
v_lshl_add_u32 v4, v253, 5, v248
s_add_u32 s33, s32, 1
v_xor_b32 v253, s33, v249
v_lshl_add_u32 v5, v253, 5, v248
s_add_u32 s33, s32, 2
v_xor_b32 v253, s33, v249
v_lshl_add_u32 v6, v253, 5, v248
s_add_u32 s33, s32, 3
v_xor_b32 v253, s33, v249
v_lshl_add_u32 v7, v253, 5, v248
v_lshrrev_b32 v248, 1, v251
v_xor_b32 v248, v250, v248
v_lshlrev_b32 v248, 4, v248
v_lshl_add_u32 v248, v251, 7, v248
s_mul_i32 s32, s31, 10240
s_add_u32 s32, s32, 16384
v_add_u32 v8, s32, v248
v_xor_b32 v9, 64, v8
s_lshl_b32 s32, s21, 7
s_lshl_b32 s33, s30, 6
s_add_u32 s32, s32, s33
s_lshl_b32 s33, s24, 4
s_add_u32 s32, s32, s33
v_add_u32 v248, s32, v251
s_mul_i32 s33, s23, 160
s_mul_i32 s34, s31, 80
s_add_u32 s33, s33, s34
v_lshl_add_u32 v249, v250, 2, s33
v_mul_u32_u24 v247, 640, v248
v_add_u32 v247, v247, v249
v_lshlrev_b32 v246, 2, v247
v_lshlrev_b32 v247, 1, v247
v_lshlrev_b32 v248, 1, v249
v_lshlrev_b32 v249, 2, v251
s_lshl_b32 s32, s21, 2
s_add_u32 s32, s32, s24
s_lshl_b32 s32, s32, 9
s_add_u32 s32, s32, 14680064
s_lshl_b32 s33, s30, 8
s_add_u32 s46, s32, s33
s_mov_b32 s16, s48
s_and_b32 s17, s49, 0xffff
s_mov_b32 s18, 5242880
s_mov_b32 s19, 0x20000
s_mov_b32 s60, s50
s_and_b32 s61, s51, 0xffff
s_mov_b32 s62, 1280
s_mov_b32 s63, 0x20000
s_mov_b32 s64, s52
s_and_b32 s65, s53, 0xffff
s_mov_b32 s66, 1280
s_mov_b32 s67, 0x20000
v_sub_f32 v220, 0, v89
v_sub_f32 v221, 0, v93
v_sub_f32 v222, 0, v97
v_sub_f32 v223, 0, v101
v_sub_f32 v224, 0, v105
s_mul_i32 s33, s21, 327680
s_add_u32 s33, s33, 8388608
s_barrier
ds_read_b32 v113, v13 offset:5120
ds_read_b32 v114, v13 offset:5184
ds_read_b32 v115, v13 offset:5248
ds_read_b32 v116, v13 offset:5312
ds_read_b32 v117, v13 offset:5376
s_waitcnt lgkmcnt(0)
v_mul_f32 v118, v88, v113
v_mul_f32 v119, v92, v114
v_mul_f32 v120, v96, v115
v_mul_f32 v121, v100, v116
v_mul_f32 v122, v104, v117
v_fmac_f32_dpp v118, v113, v89 quad_perm:[1,0,3,2] row_mask:0xf bank_mask:0xf
v_fmac_f32_dpp v119, v114, v93 quad_perm:[1,0,3,2] row_mask:0xf bank_mask:0xf
v_fmac_f32_dpp v120, v115, v97 quad_perm:[1,0,3,2] row_mask:0xf bank_mask:0xf
v_fmac_f32_dpp v121, v116, v101 quad_perm:[1,0,3,2] row_mask:0xf bank_mask:0xf
v_fmac_f32_dpp v122, v117, v105 quad_perm:[1,0,3,2] row_mask:0xf bank_mask:0xf
v_mul_f32 v113, v90, v118
v_mul_f32 v114, v94, v119
v_mul_f32 v115, v98, v120
v_mul_f32 v116, v102, v121
v_mul_f32 v117, v106, v122
v_fmac_f32_dpp v113, v118, v91 quad_perm:[1,0,3,2] row_mask:0xf bank_mask:0xf
v_fmac_f32_dpp v114, v119, v95 quad_perm:[1,0,3,2] row_mask:0xf bank_mask:0xf
v_fmac_f32_dpp v115, v120, v99 quad_perm:[1,0,3,2] row_mask:0xf bank_mask:0xf
v_fmac_f32_dpp v116, v121, v103 quad_perm:[1,0,3,2] row_mask:0xf bank_mask:0xf
v_fmac_f32_dpp v117, v122, v107 quad_perm:[1,0,3,2] row_mask:0xf bank_mask:0xf
s_cmp_eq_u32 s91, 1
s_cbranch_scc1 SP_F
v_add_f32 v128, v16, v113
v_add_f32 v132, v17, v114
v_add_f32 v136, v18, v115
v_add_f32 v140, v19, v116
v_add_f32 v144, v20, v117
v_mul_f32 v118, v88, v113
v_mul_f32 v119, v92, v114
v_mul_f32 v120, v96, v115
v_mul_f32 v121, v100, v116
v_mul_f32 v122, v104, v117
v_fmac_f32_dpp v118, v113, v220 quad_perm:[1,0,3,2] row_mask:0xf bank_mask:0xf
v_fmac_f32_dpp v119, v114, v221 quad_perm:[1,0,3,2] row_mask:0xf bank_mask:0xf
v_fmac_f32_dpp v120, v115, v222 quad_perm:[1,0,3,2] row_mask:0xf bank_mask:0xf
v_fmac_f32_dpp v121, v116, v223 quad_perm:[1,0,3,2] row_mask:0xf bank_mask:0xf
v_fmac_f32_dpp v122, v117, v224 quad_perm:[1,0,3,2] row_mask:0xf bank_mask:0xf
v_add_f32 v129, v21, v118
v_add_f32 v133, v22, v119
v_add_f32 v137, v23, v120
v_add_f32 v141, v24, v121
v_add_f32 v145, v25, v122
v_mul_f32 v113, v88, v118
v_mul_f32 v114, v92, v119
v_mul_f32 v115, v96, v120
v_mul_f32 v116, v100, v121
v_mul_f32 v117, v104, v122
v_fmac_f32_dpp v113, v118, v220 quad_perm:[1,0,3,2] row_mask:0xf bank_mask:0xf
v_fmac_f32_dpp v114, v119, v221 quad_perm:[1,0,3,2] row_mask:0xf bank_mask:0xf
v_fmac_f32_dpp v115, v120, v222 quad_perm:[1,0,3,2] row_mask:0xf bank_mask:0xf
v_fmac_f32_dpp v116, v121, v223 quad_perm:[1,0,3,2] row_mask:0xf bank_mask:0xf
v_fmac_f32_dpp v117, v122, v224 quad_perm:[1,0,3,2] row_mask:0xf bank_mask:0xf
v_add_f32 v130, v26, v113
v_add_f32 v134, v27, v114
v_add_f32 v138, v28, v115
v_add_f32 v142, v29, v116
v_add_f32 v146, v30, v117
v_mul_f32 v118, v88, v113
v_mul_f32 v119, v92, v114
v_mul_f32 v120, v96, v115
v_mul_f32 v121, v100, v116
v_mul_f32 v122, v104, v117
v_fmac_f32_dpp v118, v113, v220 quad_perm:[1,0,3,2] row_mask:0xf bank_mask:0xf
v_fmac_f32_dpp v119, v114, v221 quad_perm:[1,0,3,2] row_mask:0xf bank_mask:0xf
v_fmac_f32_dpp v120, v115, v222 quad_perm:[1,0,3,2] row_mask:0xf bank_mask:0xf
v_fmac_f32_dpp v121, v116, v223 quad_perm:[1,0,3,2] row_mask:0xf bank_mask:0xf
v_fmac_f32_dpp v122, v117, v224 quad_perm:[1,0,3,2] row_mask:0xf bank_mask:0xf
v_add_f32 v131, v31, v118
v_add_f32 v135, v32, v119
v_add_f32 v139, v33, v120
v_add_f32 v143, v34, v121
v_add_f32 v147, v35, v122
v_mul_f32 v113, v88, v118
v_mul_f32 v114, v92, v119
v_mul_f32 v115, v96, v120
v_mul_f32 v116, v100, v121
v_mul_f32 v117, v104, v122
v_fmac_f32_dpp v113, v118, v220 quad_perm:[1,0,3,2] row_mask:0xf bank_mask:0xf
v_fmac_f32_dpp v114, v119, v221 quad_perm:[1,0,3,2] row_mask:0xf bank_mask:0xf
v_fmac_f32_dpp v115, v120, v222 quad_perm:[1,0,3,2] row_mask:0xf bank_mask:0xf
v_fmac_f32_dpp v116, v121, v223 quad_perm:[1,0,3,2] row_mask:0xf bank_mask:0xf
v_fmac_f32_dpp v117, v122, v224 quad_perm:[1,0,3,2] row_mask:0xf bank_mask:0xf
v_add_f32 v148, v36, v113
v_add_f32 v152, v37, v114
v_add_f32 v156, v38, v115
v_add_f32 v160, v39, v116
v_add_f32 v164, v40, v117
v_mul_f32 v118, v88, v113
v_mul_f32 v119, v92, v114
v_mul_f32 v120, v96, v115
v_mul_f32 v121, v100, v116
v_mul_f32 v122, v104, v117
v_fmac_f32_dpp v118, v113, v220 quad_perm:[1,0,3,2] row_mask:0xf bank_mask:0xf
v_fmac_f32_dpp v119, v114, v221 quad_perm:[1,0,3,2] row_mask:0xf bank_mask:0xf
v_fmac_f32_dpp v120, v115, v222 quad_perm:[1,0,3,2] row_mask:0xf bank_mask:0xf
v_fmac_f32_dpp v121, v116, v223 quad_perm:[1,0,3,2] row_mask:0xf bank_mask:0xf
v_fmac_f32_dpp v122, v117, v224 quad_perm:[1,0,3,2] row_mask:0xf bank_mask:0xf
v_add_f32 v149, v41, v118
v_add_f32 v153, v42, v119
v_add_f32 v157, v43, v120
v_add_f32 v161, v44, v121
v_add_f32 v165, v45, v122
v_mul_f32 v113, v88, v118
v_mul_f32 v114, v92, v119
v_mul_f32 v115, v96, v120
v_mul_f32 v116, v100, v121
v_mul_f32 v117, v104, v122
v_fmac_f32_dpp v113, v118, v220 quad_perm:[1,0,3,2] row_mask:0xf bank_mask:0xf
v_fmac_f32_dpp v114, v119, v221 quad_perm:[1,0,3,2] row_mask:0xf bank_mask:0xf
v_fmac_f32_dpp v115, v120, v222 quad_perm:[1,0,3,2] row_mask:0xf bank_mask:0xf
v_fmac_f32_dpp v116, v121, v223 quad_perm:[1,0,3,2] row_mask:0xf bank_mask:0xf
v_fmac_f32_dpp v117, v122, v224 quad_perm:[1,0,3,2] row_mask:0xf bank_mask:0xf
v_add_f32 v150, v46, v113
v_add_f32 v154, v47, v114
v_add_f32 v158, v48, v115
v_add_f32 v162, v49, v116
v_add_f32 v166, v50, v117
v_mul_f32 v118, v88, v113
v_mul_f32 v119, v92, v114
v_mul_f32 v120, v96, v115
v_mul_f32 v121, v100, v116
v_mul_f32 v122, v104, v117
v_fmac_f32_dpp v118, v113, v220 quad_perm:[1,0,3,2] row_mask:0xf bank_mask:0xf
v_fmac_f32_dpp v119, v114, v221 quad_perm:[1,0,3,2] row_mask:0xf bank_mask:0xf
v_fmac_f32_dpp v120, v115, v222 quad_perm:[1,0,3,2] row_mask:0xf bank_mask:0xf
v_fmac_f32_dpp v121, v116, v223 quad_perm:[1,0,3,2] row_mask:0xf bank_mask:0xf
v_fmac_f32_dpp v122, v117, v224 quad_perm:[1,0,3,2] row_mask:0xf bank_mask:0xf
v_add_f32 v151, v51, v118
v_add_f32 v155, v52, v119
v_add_f32 v159, v53, v120
v_add_f32 v163, v54, v121
v_add_f32 v167, v55, v122
v_mul_f32 v113, v88, v118
v_mul_f32 v114, v92, v119
v_mul_f32 v115, v96, v120
v_mul_f32 v116, v100, v121
v_mul_f32 v117, v104, v122
v_fmac_f32_dpp v113, v118, v220 quad_perm:[1,0,3,2] row_mask:0xf bank_mask:0xf
v_fmac_f32_dpp v114, v119, v221 quad_perm:[1,0,3,2] row_mask:0xf bank_mask:0xf
v_fmac_f32_dpp v115, v120, v222 quad_perm:[1,0,3,2] row_mask:0xf bank_mask:0xf
v_fmac_f32_dpp v116, v121, v223 quad_perm:[1,0,3,2] row_mask:0xf bank_mask:0xf
v_fmac_f32_dpp v117, v122, v224 quad_perm:[1,0,3,2] row_mask:0xf bank_mask:0xf
v_add_f32 v168, v56, v113
v_add_f32 v172, v57, v114
v_add_f32 v176, v58, v115
v_add_f32 v180, v59, v116
v_add_f32 v184, v60, v117
v_mul_f32 v118, v88, v113
v_mul_f32 v119, v92, v114
v_mul_f32 v120, v96, v115
v_mul_f32 v121, v100, v116
v_mul_f32 v122, v104, v117
v_fmac_f32_dpp v118, v113, v220 quad_perm:[1,0,3,2] row_mask:0xf bank_mask:0xf
v_fmac_f32_dpp v119, v114, v221 quad_perm:[1,0,3,2] row_mask:0xf bank_mask:0xf
v_fmac_f32_dpp v120, v115, v222 quad_perm:[1,0,3,2] row_mask:0xf bank_mask:0xf
v_fmac_f32_dpp v121, v116, v223 quad_perm:[1,0,3,2] row_mask:0xf bank_mask:0xf
v_fmac_f32_dpp v122, v117, v224 quad_perm:[1,0,3,2] row_mask:0xf bank_mask:0xf
v_cvt_pk_bf16_f32 v228, v128, v129
v_cvt_pk_bf16_f32 v229, v130, v131
v_cvt_pk_bf16_f32 v230, v148, v149
v_cvt_pk_bf16_f32 v231, v150, v151
buffer_store_dwordx4 v[228:231], v108, s[12:15], s33 offen offset:0 sc1
v_add_f32 v169, v61, v118
v_add_f32 v173, v62, v119
v_add_f32 v177, v63, v120
v_add_f32 v181, v64, v121
v_add_f32 v185, v65, v122
v_mul_f32 v113, v88, v118
v_mul_f32 v114, v92, v119
v_mul_f32 v115, v96, v120
v_mul_f32 v116, v100, v121
v_mul_f32 v117, v104, v122
v_fmac_f32_dpp v113, v118, v220 quad_perm:[1,0,3,2] row_mask:0xf bank_mask:0xf
v_fmac_f32_dpp v114, v119, v221 quad_perm:[1,0,3,2] row_mask:0xf bank_mask:0xf
v_fmac_f32_dpp v115, v120, v222 quad_perm:[1,0,3,2] row_mask:0xf bank_mask:0xf
v_fmac_f32_dpp v116, v121, v223 quad_perm:[1,0,3,2] row_mask:0xf bank_mask:0xf
v_fmac_f32_dpp v117, v122, v224 quad_perm:[1,0,3,2] row_mask:0xf bank_mask:0xf
v_cvt_pk_bf16_f32 v232, v132, v133
v_cvt_pk_bf16_f32 v233, v134, v135
v_cvt_pk_bf16_f32 v234, v152, v153
v_cvt_pk_bf16_f32 v235, v154, v155
buffer_store_dwordx4 v[232:235], v109, s[12:15], s33 offen offset:0 sc1
v_add_f32 v170, v66, v113
v_add_f32 v174, v67, v114
v_add_f32 v178, v68, v115
v_add_f32 v182, v69, v116
v_add_f32 v186, v70, v117
v_mul_f32 v118, v88, v113
v_mul_f32 v119, v92, v114
v_mul_f32 v120, v96, v115
v_mul_f32 v121, v100, v116
v_mul_f32 v122, v104, v117
v_fmac_f32_dpp v118, v113, v220 quad_perm:[1,0,3,2] row_mask:0xf bank_mask:0xf
v_fmac_f32_dpp v119, v114, v221 quad_perm:[1,0,3,2] row_mask:0xf bank_mask:0xf
v_fmac_f32_dpp v120, v115, v222 quad_perm:[1,0,3,2] row_mask:0xf bank_mask:0xf
v_fmac_f32_dpp v121, v116, v223 quad_perm:[1,0,3,2] row_mask:0xf bank_mask:0xf
v_fmac_f32_dpp v122, v117, v224 quad_perm:[1,0,3,2] row_mask:0xf bank_mask:0xf
v_cvt_pk_bf16_f32 v236, v136, v137
v_cvt_pk_bf16_f32 v237, v138, v139
v_cvt_pk_bf16_f32 v238, v156, v157
v_cvt_pk_bf16_f32 v239, v158, v159
buffer_store_dwordx4 v[236:239], v110, s[12:15], s33 offen offset:0 sc1
v_add_f32 v171, v71, v118
v_add_f32 v175, v72, v119
v_add_f32 v179, v73, v120
v_add_f32 v183, v74, v121
v_add_f32 v187, v75, v122
v_mul_f32 v113, v88, v118
v_mul_f32 v114, v92, v119
v_mul_f32 v115, v96, v120
v_mul_f32 v116, v100, v121
v_mul_f32 v117, v104, v122
v_fmac_f32_dpp v113, v118, v220 quad_perm:[1,0,3,2] row_mask:0xf bank_mask:0xf
v_fmac_f32_dpp v114, v119, v221 quad_perm:[1,0,3,2] row_mask:0xf bank_mask:0xf
v_fmac_f32_dpp v115, v120, v222 quad_perm:[1,0,3,2] row_mask:0xf bank_mask:0xf
v_fmac_f32_dpp v116, v121, v223 quad_perm:[1,0,3,2] row_mask:0xf bank_mask:0xf
v_fmac_f32_dpp v117, v122, v224 quad_perm:[1,0,3,2] row_mask:0xf bank_mask:0xf
v_cvt_pk_bf16_f32 v240, v140, v141
v_cvt_pk_bf16_f32 v241, v142, v143
v_cvt_pk_bf16_f32 v242, v160, v161
v_cvt_pk_bf16_f32 v243, v162, v163
buffer_store_dwordx4 v[240:243], v111, s[12:15], s33 offen offset:0 sc1
v_add_f32 v188, v76, v113
v_add_f32 v192, v77, v114
v_add_f32 v196, v78, v115
v_add_f32 v200, v79, v116
v_add_f32 v204, v80, v117
v_mul_f32 v118, v88, v113
v_mul_f32 v119, v92, v114
v_mul_f32 v120, v96, v115
v_mul_f32 v121, v100, v116
v_mul_f32 v122, v104, v117
v_fmac_f32_dpp v118, v113, v220 quad_perm:[1,0,3,2] row_mask:0xf bank_mask:0xf
v_fmac_f32_dpp v119, v114, v221 quad_perm:[1,0,3,2] row_mask:0xf bank_mask:0xf
v_fmac_f32_dpp v120, v115, v222 quad_perm:[1,0,3,2] row_mask:0xf bank_mask:0xf
v_fmac_f32_dpp v121, v116, v223 quad_perm:[1,0,3,2] row_mask:0xf bank_mask:0xf
v_fmac_f32_dpp v122, v117, v224 quad_perm:[1,0,3,2] row_mask:0xf bank_mask:0xf
v_cvt_pk_bf16_f32 v228, v144, v145
v_cvt_pk_bf16_f32 v229, v146, v147
v_cvt_pk_bf16_f32 v230, v164, v165
v_cvt_pk_bf16_f32 v231, v166, v167
buffer_store_dwordx4 v[228:231], v112, s[12:15], s33 offen offset:0 sc1
v_add_f32 v189, v81, v118
v_add_f32 v193, v82, v119
v_add_f32 v197, v83, v120
v_add_f32 v201, v84, v121
v_add_f32 v205, v85, v122
v_mul_f32 v113, v88, v118
v_mul_f32 v114, v92, v119
v_mul_f32 v115, v96, v120
v_mul_f32 v116, v100, v121
v_mul_f32 v117, v104, v122
v_fmac_f32_dpp v113, v118, v220 quad_perm:[1,0,3,2] row_mask:0xf bank_mask:0xf
v_fmac_f32_dpp v114, v119, v221 quad_perm:[1,0,3,2] row_mask:0xf bank_mask:0xf
v_fmac_f32_dpp v115, v120, v222 quad_perm:[1,0,3,2] row_mask:0xf bank_mask:0xf
v_fmac_f32_dpp v116, v121, v223 quad_perm:[1,0,3,2] row_mask:0xf bank_mask:0xf
v_fmac_f32_dpp v117, v122, v224 quad_perm:[1,0,3,2] row_mask:0xf bank_mask:0xf
v_add_f32 v190, v86, v113
v_add_f32 v194, v87, v114
v_add_f32 v198, v208, v115
v_add_f32 v202, v209, v116
v_add_f32 v206, v210, v117
v_mul_f32 v118, v88, v113
v_mul_f32 v119, v92, v114
v_mul_f32 v120, v96, v115
v_mul_f32 v121, v100, v116
v_mul_f32 v122, v104, v117
v_fmac_f32_dpp v118, v113, v220 quad_perm:[1,0,3,2] row_mask:0xf bank_mask:0xf
v_fmac_f32_dpp v119, v114, v221 quad_perm:[1,0,3,2] row_mask:0xf bank_mask:0xf
v_fmac_f32_dpp v120, v115, v222 quad_perm:[1,0,3,2] row_mask:0xf bank_mask:0xf
v_fmac_f32_dpp v121, v116, v223 quad_perm:[1,0,3,2] row_mask:0xf bank_mask:0xf
v_fmac_f32_dpp v122, v117, v224 quad_perm:[1,0,3,2] row_mask:0xf bank_mask:0xf
v_add_f32 v191, v211, v118
v_add_f32 v195, v212, v119
v_add_f32 v199, v213, v120
v_add_f32 v203, v214, v121
v_add_f32 v207, v215, v122
v_cvt_pk_bf16_f32 v232, v168, v169
v_cvt_pk_bf16_f32 v233, v170, v171
v_cvt_pk_bf16_f32 v234, v188, v189
v_cvt_pk_bf16_f32 v235, v190, v191
buffer_store_dwordx4 v[232:235], v108, s[12:15], s33 offen offset:16 sc1
v_cvt_pk_bf16_f32 v236, v172, v173
v_cvt_pk_bf16_f32 v237, v174, v175
v_cvt_pk_bf16_f32 v238, v192, v193
v_cvt_pk_bf16_f32 v239, v194, v195
buffer_store_dwordx4 v[236:239], v109, s[12:15], s33 offen offset:16 sc1
v_cvt_pk_bf16_f32 v240, v176, v177
v_cvt_pk_bf16_f32 v241, v178, v179
v_cvt_pk_bf16_f32 v242, v196, v197
v_cvt_pk_bf16_f32 v243, v198, v199
buffer_store_dwordx4 v[240:243], v110, s[12:15], s33 offen offset:16 sc1
v_cvt_pk_bf16_f32 v228, v180, v181
v_cvt_pk_bf16_f32 v229, v182, v183
v_cvt_pk_bf16_f32 v230, v200, v201
v_cvt_pk_bf16_f32 v231, v202, v203
buffer_store_dwordx4 v[228:231], v111, s[12:15], s33 offen offset:16 sc1
v_cvt_pk_bf16_f32 v232, v184, v185
v_cvt_pk_bf16_f32 v233, v186, v187
v_cvt_pk_bf16_f32 v234, v204, v205
v_cvt_pk_bf16_f32 v235, v206, v207
buffer_store_dwordx4 v[232:235], v112, s[12:15], s33 offen offset:16 sc1
s_branch SP_E
SP_F:
v_add_f32 v128, v16, v113
v_add_f32 v132, v17, v114
v_add_f32 v136, v18, v115
v_add_f32 v140, v19, v116
v_add_f32 v144, v20, v117
v_mul_f32 v118, v88, v113
v_mul_f32 v119, v92, v114
v_mul_f32 v120, v96, v115
v_mul_f32 v121, v100, v116
v_mul_f32 v122, v104, v117
v_fmac_f32_dpp v118, v113, v220 quad_perm:[1,0,3,2] row_mask:0xf bank_mask:0xf
v_fmac_f32_dpp v119, v114, v221 quad_perm:[1,0,3,2] row_mask:0xf bank_mask:0xf
v_fmac_f32_dpp v120, v115, v222 quad_perm:[1,0,3,2] row_mask:0xf bank_mask:0xf
v_fmac_f32_dpp v121, v116, v223 quad_perm:[1,0,3,2] row_mask:0xf bank_mask:0xf
v_fmac_f32_dpp v122, v117, v224 quad_perm:[1,0,3,2] row_mask:0xf bank_mask:0xf
v_add_f32 v129, v21, v118
v_add_f32 v133, v22, v119
v_add_f32 v137, v23, v120
v_add_f32 v141, v24, v121
v_add_f32 v145, v25, v122
v_mul_f32 v113, v88, v118
v_mul_f32 v114, v92, v119
v_mul_f32 v115, v96, v120
v_mul_f32 v116, v100, v121
v_mul_f32 v117, v104, v122
v_fmac_f32_dpp v113, v118, v220 quad_perm:[1,0,3,2] row_mask:0xf bank_mask:0xf
v_fmac_f32_dpp v114, v119, v221 quad_perm:[1,0,3,2] row_mask:0xf bank_mask:0xf
v_fmac_f32_dpp v115, v120, v222 quad_perm:[1,0,3,2] row_mask:0xf bank_mask:0xf
v_fmac_f32_dpp v116, v121, v223 quad_perm:[1,0,3,2] row_mask:0xf bank_mask:0xf
v_fmac_f32_dpp v117, v122, v224 quad_perm:[1,0,3,2] row_mask:0xf bank_mask:0xf
v_add_f32 v130, v26, v113
v_add_f32 v134, v27, v114
v_add_f32 v138, v28, v115
v_add_f32 v142, v29, v116
v_add_f32 v146, v30, v117
v_mul_f32 v118, v88, v113
v_mul_f32 v119, v92, v114
v_mul_f32 v120, v96, v115
v_mul_f32 v121, v100, v116
v_mul_f32 v122, v104, v117
v_fmac_f32_dpp v118, v113, v220 quad_perm:[1,0,3,2] row_mask:0xf bank_mask:0xf
v_fmac_f32_dpp v119, v114, v221 quad_perm:[1,0,3,2] row_mask:0xf bank_mask:0xf
v_fmac_f32_dpp v120, v115, v222 quad_perm:[1,0,3,2] row_mask:0xf bank_mask:0xf
v_fmac_f32_dpp v121, v116, v223 quad_perm:[1,0,3,2] row_mask:0xf bank_mask:0xf
v_fmac_f32_dpp v122, v117, v224 quad_perm:[1,0,3,2] row_mask:0xf bank_mask:0xf
v_add_f32 v131, v31, v118
v_add_f32 v135, v32, v119
v_add_f32 v139, v33, v120
v_add_f32 v143, v34, v121
v_add_f32 v147, v35, v122
v_mul_f32 v113, v88, v118
v_mul_f32 v114, v92, v119
v_mul_f32 v115, v96, v120
v_mul_f32 v116, v100, v121
v_mul_f32 v117, v104, v122
v_fmac_f32_dpp v113, v118, v220 quad_perm:[1,0,3,2] row_mask:0xf bank_mask:0xf
v_fmac_f32_dpp v114, v119, v221 quad_perm:[1,0,3,2] row_mask:0xf bank_mask:0xf
v_fmac_f32_dpp v115, v120, v222 quad_perm:[1,0,3,2] row_mask:0xf bank_mask:0xf
v_fmac_f32_dpp v116, v121, v223 quad_perm:[1,0,3,2] row_mask:0xf bank_mask:0xf
v_fmac_f32_dpp v117, v122, v224 quad_perm:[1,0,3,2] row_mask:0xf bank_mask:0xf
v_add_f32 v148, v36, v113
v_add_f32 v152, v37, v114
v_add_f32 v156, v38, v115
v_add_f32 v160, v39, v116
v_add_f32 v164, v40, v117
v_mul_f32 v118, v88, v113
v_mul_f32 v119, v92, v114
v_mul_f32 v120, v96, v115
v_mul_f32 v121, v100, v116
v_mul_f32 v122, v104, v117
v_fmac_f32_dpp v118, v113, v220 quad_perm:[1,0,3,2] row_mask:0xf bank_mask:0xf
v_fmac_f32_dpp v119, v114, v221 quad_perm:[1,0,3,2] row_mask:0xf bank_mask:0xf
v_fmac_f32_dpp v120, v115, v222 quad_perm:[1,0,3,2] row_mask:0xf bank_mask:0xf
v_fmac_f32_dpp v121, v116, v223 quad_perm:[1,0,3,2] row_mask:0xf bank_mask:0xf
v_fmac_f32_dpp v122, v117, v224 quad_perm:[1,0,3,2] row_mask:0xf bank_mask:0xf
v_add_f32 v149, v41, v118
v_add_f32 v153, v42, v119
v_add_f32 v157, v43, v120
v_add_f32 v161, v44, v121
v_add_f32 v165, v45, v122
v_mul_f32 v113, v88, v118
v_mul_f32 v114, v92, v119
v_mul_f32 v115, v96, v120
v_mul_f32 v116, v100, v121
v_mul_f32 v117, v104, v122
v_fmac_f32_dpp v113, v118, v220 quad_perm:[1,0,3,2] row_mask:0xf bank_mask:0xf
v_fmac_f32_dpp v114, v119, v221 quad_perm:[1,0,3,2] row_mask:0xf bank_mask:0xf
v_fmac_f32_dpp v115, v120, v222 quad_perm:[1,0,3,2] row_mask:0xf bank_mask:0xf
v_fmac_f32_dpp v116, v121, v223 quad_perm:[1,0,3,2] row_mask:0xf bank_mask:0xf
v_fmac_f32_dpp v117, v122, v224 quad_perm:[1,0,3,2] row_mask:0xf bank_mask:0xf
v_add_f32 v150, v46, v113
v_add_f32 v154, v47, v114
v_add_f32 v158, v48, v115
v_add_f32 v162, v49, v116
v_add_f32 v166, v50, v117
v_mul_f32 v118, v88, v113
v_mul_f32 v119, v92, v114
v_mul_f32 v120, v96, v115
v_mul_f32 v121, v100, v116
v_mul_f32 v122, v104, v117
v_fmac_f32_dpp v118, v113, v220 quad_perm:[1,0,3,2] row_mask:0xf bank_mask:0xf
v_fmac_f32_dpp v119, v114, v221 quad_perm:[1,0,3,2] row_mask:0xf bank_mask:0xf
v_fmac_f32_dpp v120, v115, v222 quad_perm:[1,0,3,2] row_mask:0xf bank_mask:0xf
v_fmac_f32_dpp v121, v116, v223 quad_perm:[1,0,3,2] row_mask:0xf bank_mask:0xf
v_fmac_f32_dpp v122, v117, v224 quad_perm:[1,0,3,2] row_mask:0xf bank_mask:0xf
v_add_f32 v151, v51, v118
v_add_f32 v155, v52, v119
v_add_f32 v159, v53, v120
v_add_f32 v163, v54, v121
v_add_f32 v167, v55, v122
v_mul_f32 v113, v88, v118
v_mul_f32 v114, v92, v119
v_mul_f32 v115, v96, v120
v_mul_f32 v116, v100, v121
v_mul_f32 v117, v104, v122
v_fmac_f32_dpp v113, v118, v220 quad_perm:[1,0,3,2] row_mask:0xf bank_mask:0xf
v_fmac_f32_dpp v114, v119, v221 quad_perm:[1,0,3,2] row_mask:0xf bank_mask:0xf
v_fmac_f32_dpp v115, v120, v222 quad_perm:[1,0,3,2] row_mask:0xf bank_mask:0xf
v_fmac_f32_dpp v116, v121, v223 quad_perm:[1,0,3,2] row_mask:0xf bank_mask:0xf
v_fmac_f32_dpp v117, v122, v224 quad_perm:[1,0,3,2] row_mask:0xf bank_mask:0xf
v_add_f32 v168, v56, v113
v_add_f32 v172, v57, v114
v_add_f32 v176, v58, v115
v_add_f32 v180, v59, v116
v_add_f32 v184, v60, v117
v_mul_f32 v118, v88, v113
v_mul_f32 v119, v92, v114
v_mul_f32 v120, v96, v115
v_mul_f32 v121, v100, v116
v_mul_f32 v122, v104, v117
v_fmac_f32_dpp v118, v113, v220 quad_perm:[1,0,3,2] row_mask:0xf bank_mask:0xf
v_fmac_f32_dpp v119, v114, v221 quad_perm:[1,0,3,2] row_mask:0xf bank_mask:0xf
v_fmac_f32_dpp v120, v115, v222 quad_perm:[1,0,3,2] row_mask:0xf bank_mask:0xf
v_fmac_f32_dpp v121, v116, v223 quad_perm:[1,0,3,2] row_mask:0xf bank_mask:0xf
v_fmac_f32_dpp v122, v117, v224 quad_perm:[1,0,3,2] row_mask:0xf bank_mask:0xf
v_cvt_pk_bf16_f32 v228, v128, v129
v_cvt_pk_bf16_f32 v229, v130, v131
v_cvt_pk_bf16_f32 v230, v148, v149
v_cvt_pk_bf16_f32 v231, v150, v151
buffer_store_dwordx4 v[228:231], v108, s[12:15], s33 offen offset:0
v_add_f32 v169, v61, v118
v_add_f32 v173, v62, v119
v_add_f32 v177, v63, v120
v_add_f32 v181, v64, v121
v_add_f32 v185, v65, v122
v_mul_f32 v113, v88, v118
v_mul_f32 v114, v92, v119
v_mul_f32 v115, v96, v120
v_mul_f32 v116, v100, v121
v_mul_f32 v117, v104, v122
v_fmac_f32_dpp v113, v118, v220 quad_perm:[1,0,3,2] row_mask:0xf bank_mask:0xf
v_fmac_f32_dpp v114, v119, v221 quad_perm:[1,0,3,2] row_mask:0xf bank_mask:0xf
v_fmac_f32_dpp v115, v120, v222 quad_perm:[1,0,3,2] row_mask:0xf bank_mask:0xf
v_fmac_f32_dpp v116, v121, v223 quad_perm:[1,0,3,2] row_mask:0xf bank_mask:0xf
v_fmac_f32_dpp v117, v122, v224 quad_perm:[1,0,3,2] row_mask:0xf bank_mask:0xf
v_cvt_pk_bf16_f32 v232, v132, v133
v_cvt_pk_bf16_f32 v233, v134, v135
v_cvt_pk_bf16_f32 v234, v152, v153
v_cvt_pk_bf16_f32 v235, v154, v155
buffer_store_dwordx4 v[232:235], v109, s[12:15], s33 offen offset:0
v_add_f32 v170, v66, v113
v_add_f32 v174, v67, v114
v_add_f32 v178, v68, v115
v_add_f32 v182, v69, v116
v_add_f32 v186, v70, v117
v_mul_f32 v118, v88, v113
v_mul_f32 v119, v92, v114
v_mul_f32 v120, v96, v115
v_mul_f32 v121, v100, v116
v_mul_f32 v122, v104, v117
v_fmac_f32_dpp v118, v113, v220 quad_perm:[1,0,3,2] row_mask:0xf bank_mask:0xf
v_fmac_f32_dpp v119, v114, v221 quad_perm:[1,0,3,2] row_mask:0xf bank_mask:0xf
v_fmac_f32_dpp v120, v115, v222 quad_perm:[1,0,3,2] row_mask:0xf bank_mask:0xf
v_fmac_f32_dpp v121, v116, v223 quad_perm:[1,0,3,2] row_mask:0xf bank_mask:0xf
v_fmac_f32_dpp v122, v117, v224 quad_perm:[1,0,3,2] row_mask:0xf bank_mask:0xf
v_cvt_pk_bf16_f32 v236, v136, v137
v_cvt_pk_bf16_f32 v237, v138, v139
v_cvt_pk_bf16_f32 v238, v156, v157
v_cvt_pk_bf16_f32 v239, v158, v159
buffer_store_dwordx4 v[236:239], v110, s[12:15], s33 offen offset:0
v_add_f32 v171, v71, v118
v_add_f32 v175, v72, v119
v_add_f32 v179, v73, v120
v_add_f32 v183, v74, v121
v_add_f32 v187, v75, v122
v_mul_f32 v113, v88, v118
v_mul_f32 v114, v92, v119
v_mul_f32 v115, v96, v120
v_mul_f32 v116, v100, v121
v_mul_f32 v117, v104, v122
v_fmac_f32_dpp v113, v118, v220 quad_perm:[1,0,3,2] row_mask:0xf bank_mask:0xf
v_fmac_f32_dpp v114, v119, v221 quad_perm:[1,0,3,2] row_mask:0xf bank_mask:0xf
v_fmac_f32_dpp v115, v120, v222 quad_perm:[1,0,3,2] row_mask:0xf bank_mask:0xf
v_fmac_f32_dpp v116, v121, v223 quad_perm:[1,0,3,2] row_mask:0xf bank_mask:0xf
v_fmac_f32_dpp v117, v122, v224 quad_perm:[1,0,3,2] row_mask:0xf bank_mask:0xf
v_cvt_pk_bf16_f32 v240, v140, v141
v_cvt_pk_bf16_f32 v241, v142, v143
v_cvt_pk_bf16_f32 v242, v160, v161
v_cvt_pk_bf16_f32 v243, v162, v163
buffer_store_dwordx4 v[240:243], v111, s[12:15], s33 offen offset:0
v_add_f32 v188, v76, v113
v_add_f32 v192, v77, v114
v_add_f32 v196, v78, v115
v_add_f32 v200, v79, v116
v_add_f32 v204, v80, v117
v_mul_f32 v118, v88, v113
v_mul_f32 v119, v92, v114
v_mul_f32 v120, v96, v115
v_mul_f32 v121, v100, v116
v_mul_f32 v122, v104, v117
v_fmac_f32_dpp v118, v113, v220 quad_perm:[1,0,3,2] row_mask:0xf bank_mask:0xf
v_fmac_f32_dpp v119, v114, v221 quad_perm:[1,0,3,2] row_mask:0xf bank_mask:0xf
v_fmac_f32_dpp v120, v115, v222 quad_perm:[1,0,3,2] row_mask:0xf bank_mask:0xf
v_fmac_f32_dpp v121, v116, v223 quad_perm:[1,0,3,2] row_mask:0xf bank_mask:0xf
v_fmac_f32_dpp v122, v117, v224 quad_perm:[1,0,3,2] row_mask:0xf bank_mask:0xf
v_cvt_pk_bf16_f32 v228, v144, v145
v_cvt_pk_bf16_f32 v229, v146, v147
v_cvt_pk_bf16_f32 v230, v164, v165
v_cvt_pk_bf16_f32 v231, v166, v167
buffer_store_dwordx4 v[228:231], v112, s[12:15], s33 offen offset:0
v_add_f32 v189, v81, v118
v_add_f32 v193, v82, v119
v_add_f32 v197, v83, v120
v_add_f32 v201, v84, v121
v_add_f32 v205, v85, v122
v_mul_f32 v113, v88, v118
v_mul_f32 v114, v92, v119
v_mul_f32 v115, v96, v120
v_mul_f32 v116, v100, v121
v_mul_f32 v117, v104, v122
v_fmac_f32_dpp v113, v118, v220 quad_perm:[1,0,3,2] row_mask:0xf bank_mask:0xf
v_fmac_f32_dpp v114, v119, v221 quad_perm:[1,0,3,2] row_mask:0xf bank_mask:0xf
v_fmac_f32_dpp v115, v120, v222 quad_perm:[1,0,3,2] row_mask:0xf bank_mask:0xf
v_fmac_f32_dpp v116, v121, v223 quad_perm:[1,0,3,2] row_mask:0xf bank_mask:0xf
v_fmac_f32_dpp v117, v122, v224 quad_perm:[1,0,3,2] row_mask:0xf bank_mask:0xf
v_add_f32 v190, v86, v113
v_add_f32 v194, v87, v114
v_add_f32 v198, v208, v115
v_add_f32 v202, v209, v116
v_add_f32 v206, v210, v117
v_mul_f32 v118, v88, v113
v_mul_f32 v119, v92, v114
v_mul_f32 v120, v96, v115
v_mul_f32 v121, v100, v116
v_mul_f32 v122, v104, v117
v_fmac_f32_dpp v118, v113, v220 quad_perm:[1,0,3,2] row_mask:0xf bank_mask:0xf
v_fmac_f32_dpp v119, v114, v221 quad_perm:[1,0,3,2] row_mask:0xf bank_mask:0xf
v_fmac_f32_dpp v120, v115, v222 quad_perm:[1,0,3,2] row_mask:0xf bank_mask:0xf
v_fmac_f32_dpp v121, v116, v223 quad_perm:[1,0,3,2] row_mask:0xf bank_mask:0xf
v_fmac_f32_dpp v122, v117, v224 quad_perm:[1,0,3,2] row_mask:0xf bank_mask:0xf
v_add_f32 v191, v211, v118
v_add_f32 v195, v212, v119
v_add_f32 v199, v213, v120
v_add_f32 v203, v214, v121
v_add_f32 v207, v215, v122
v_cvt_pk_bf16_f32 v232, v168, v169
v_cvt_pk_bf16_f32 v233, v170, v171
v_cvt_pk_bf16_f32 v234, v188, v189
v_cvt_pk_bf16_f32 v235, v190, v191
buffer_store_dwordx4 v[232:235], v108, s[12:15], s33 offen offset:16
v_cvt_pk_bf16_f32 v236, v172, v173
v_cvt_pk_bf16_f32 v237, v174, v175
v_cvt_pk_bf16_f32 v238, v192, v193
v_cvt_pk_bf16_f32 v239, v194, v195
buffer_store_dwordx4 v[236:239], v109, s[12:15], s33 offen offset:16
v_cvt_pk_bf16_f32 v240, v176, v177
v_cvt_pk_bf16_f32 v241, v178, v179
v_cvt_pk_bf16_f32 v242, v196, v197
v_cvt_pk_bf16_f32 v243, v198, v199
buffer_store_dwordx4 v[240:243], v110, s[12:15], s33 offen offset:16
v_cvt_pk_bf16_f32 v228, v180, v181
v_cvt_pk_bf16_f32 v229, v182, v183
v_cvt_pk_bf16_f32 v230, v200, v201
v_cvt_pk_bf16_f32 v231, v202, v203
buffer_store_dwordx4 v[228:231], v111, s[12:15], s33 offen offset:16
v_cvt_pk_bf16_f32 v232, v184, v185
v_cvt_pk_bf16_f32 v233, v186, v187
v_cvt_pk_bf16_f32 v234, v204, v205
v_cvt_pk_bf16_f32 v235, v206, v207
buffer_store_dwordx4 v[232:235], v112, s[12:15], s33 offen offset:16
SP_E:
s_waitcnt vmcnt(0)
s_barrier
s_barrier
buffer_load_dword v238, v249, s[12:15], s46 offen offset:0 sc1
buffer_load_dword v239, v249, s[12:15], s46 offen offset:64 sc1
buffer_load_dword v240, v249, s[12:15], s46 offen offset:128 sc1
buffer_load_dword v241, v249, s[12:15], s46 offen offset:192 sc1
buffer_load_dwordx2 v[208:209], v247, s[4:7], 0 offen offset:0
buffer_load_dwordx2 v[218:219], v248, s[60:63], 0 offen offset:0
buffer_load_dwordx2 v[228:229], v248, s[64:67], 0 offen offset:0
buffer_load_dwordx2 v[210:211], v247, s[4:7], 0 offen offset:32
buffer_load_dwordx2 v[220:221], v248, s[60:63], 0 offen offset:32
buffer_load_dwordx2 v[230:231], v248, s[64:67], 0 offen offset:32
buffer_load_dwordx2 v[212:213], v247, s[4:7], 0 offen offset:64
buffer_load_dwordx2 v[222:223], v248, s[60:63], 0 offen offset:64
buffer_load_dwordx2 v[232:233], v248, s[64:67], 0 offen offset:64
buffer_load_dwordx2 v[214:215], v247, s[4:7], 0 offen offset:96
buffer_load_dwordx2 v[224:225], v248, s[60:63], 0 offen offset:96
buffer_load_dwordx2 v[234:235], v248, s[64:67], 0 offen offset:96
buffer_load_dwordx2 v[216:217], v247, s[4:7], 0 offen offset:128
buffer_load_dwordx2 v[226:227], v248, s[60:63], 0 offen offset:128
buffer_load_dwordx2 v[236:237], v248, s[64:67], 0 offen offset:128
s_mov_b32 s36, 40960
s_mov_b32 s39, 40960
s_mov_b32 s29, 4294885376
s_mov_b32 s37, 0
ds_read_b128 v[32:35], v8 offset:0
ds_read_b64_tr_b16 v[16:17], v4 offset:0
ds_read_b64_tr_b16 v[18:19], v4 offset:1024
ds_read_b128 v[36:39], v8 offset:2048
ds_read_b64_tr_b16 v[20:21], v5 offset:0
ds_read_b64_tr_b16 v[22:23], v5 offset:1024
ds_read_b128 v[40:43], v8 offset:4096
ds_read_b64_tr_b16 v[24:25], v6 offset:0
ds_read_b64_tr_b16 v[26:27], v6 offset:1024
ds_read_b128 v[44:47], v8 offset:6144
ds_read_b64_tr_b16 v[28:29], v7 offset:0
ds_read_b64_tr_b16 v[30:31], v7 offset:1024
ds_read_b128 v[48:51], v8 offset:8192
s_sub_u32 s38, s25, 1
.p2align 3
s_waitcnt lgkmcnt(0)
s_nop 0
v_mfma_f32_16x16x32_bf16 v[128:131], v[32:35], v[16:19], 0
ds_read_b128 v[68:71], v9 offset:0
v_mfma_f32_16x16x32_bf16 v[148:151], v[32:35], v[20:23], 0
ds_read_b64_tr_b16 v[52:53], v4 offset:8192
v_mfma_f32_16x16x32_bf16 v[168:171], v[32:35], v[24:27], 0
ds_read_b64_tr_b16 v[54:55], v4 offset:9216
v_mfma_f32_16x16x32_bf16 v[188:191], v[32:35], v[28:31], 0
ds_read_b128 v[72:75], v9 offset:2048
v_mfma_f32_16x16x32_bf16 v[132:135], v[36:39], v[16:19], 0
ds_read_b64_tr_b16 v[56:57], v5 offset:8192
v_mfma_f32_16x16x32_bf16 v[152:155], v[36:39], v[20:23], 0
ds_read_b64_tr_b16 v[58:59], v5 offset:9216
v_mfma_f32_16x16x32_bf16 v[172:175], v[36:39], v[24:27], 0
ds_read_b128 v[76:79], v9 offset:4096
v_mfma_f32_16x16x32_bf16 v[192:195], v[36:39], v[28:31], 0
ds_read_b64_tr_b16 v[60:61], v6 offset:8192
v_mfma_f32_16x16x32_bf16 v[136:139], v[40:43], v[16:19], 0
ds_read_b64_tr_b16 v[62:63], v6 offset:9216
v_mfma_f32_16x16x32_bf16 v[156:159], v[40:43], v[20:23], 0
ds_read_b128 v[80:83], v9 offset:6144
v_mfma_f32_16x16x32_bf16 v[176:179], v[40:43], v[24:27], 0
ds_read_b64_tr_b16 v[64:65], v7 offset:8192
v_mfma_f32_16x16x32_bf16 v[196:199], v[40:43], v[28:31], 0
ds_read_b64_tr_b16 v[66:67], v7 offset:9216
v_mfma_f32_16x16x32_bf16 v[140:143], v[44:47], v[16:19], 0
ds_read_b128 v[84:87], v9 offset:8192
v_mfma_f32_16x16x32_bf16 v[160:163], v[44:47], v[20:23], 0
v_add_u32_e64 v4, s36, v4
v_mfma_f32_16x16x32_bf16 v[180:183], v[44:47], v[24:27], 0
v_add_u32_e64 v5, s36, v5
v_mfma_f32_16x16x32_bf16 v[200:203], v[44:47], v[28:31], 0
v_add_u32_e64 v6, s36, v6
v_mfma_f32_16x16x32_bf16 v[144:147], v[48:51], v[16:19], 0
v_add_u32_e64 v7, s36, v7
v_mfma_f32_16x16x32_bf16 v[164:167], v[48:51], v[20:23], 0
v_add_u32_e64 v8, s36, v8
v_mfma_f32_16x16x32_bf16 v[184:187], v[48:51], v[24:27], 0
v_add_u32_e64 v9, s36, v9
v_mfma_f32_16x16x32_bf16 v[204:207], v[48:51], v[28:31], 0
s_waitcnt lgkmcnt(0)
s_barrier
v_mfma_f32_16x16x32_bf16 v[128:131], v[68:71], v[52:55], v[128:131]
ds_read_b128 v[32:35], v8 offset:0
v_mfma_f32_16x16x32_bf16 v[148:151], v[68:71], v[56:59], v[148:151]
ds_read_b64_tr_b16 v[16:17], v4 offset:0
v_mfma_f32_16x16x32_bf16 v[168:171], v[68:71], v[60:63], v[168:171]
ds_read_b64_tr_b16 v[18:19], v4 offset:1024
v_mfma_f32_16x16x32_bf16 v[188:191], v[68:71], v[64:67], v[188:191]
ds_read_b128 v[36:39], v8 offset:2048
v_mfma_f32_16x16x32_bf16 v[132:135], v[72:75], v[52:55], v[132:135]
ds_read_b64_tr_b16 v[20:21], v5 offset:0
v_mfma_f32_16x16x32_bf16 v[152:155], v[72:75], v[56:59], v[152:155]
ds_read_b64_tr_b16 v[22:23], v5 offset:1024
v_mfma_f32_16x16x32_bf16 v[172:175], v[72:75], v[60:63], v[172:175]
ds_read_b128 v[40:43], v8 offset:4096
v_mfma_f32_16x16x32_bf16 v[192:195], v[72:75], v[64:67], v[192:195]
ds_read_b64_tr_b16 v[24:25], v6 offset:0
v_mfma_f32_16x16x32_bf16 v[136:139], v[76:79], v[52:55], v[136:139]
ds_read_b64_tr_b16 v[26:27], v6 offset:1024
v_mfma_f32_16x16x32_bf16 v[156:159], v[76:79], v[56:59], v[156:159]
ds_read_b128 v[44:47], v8 offset:6144
v_mfma_f32_16x16x32_bf16 v[176:179], v[76:79], v[60:63], v[176:179]
ds_read_b64_tr_b16 v[28:29], v7 offset:0
v_mfma_f32_16x16x32_bf16 v[196:199], v[76:79], v[64:67], v[196:199]
ds_read_b64_tr_b16 v[30:31], v7 offset:1024
v_mfma_f32_16x16x32_bf16 v[140:143], v[80:83], v[52:55], v[140:143]
ds_read_b128 v[48:51], v8 offset:8192
v_mfma_f32_16x16x32_bf16 v[160:163], v[80:83], v[56:59], v[160:163]
s_add_u32 s37, s37, 1
s_cmp_eq_u32 s37, 2
v_mfma_f32_16x16x32_bf16 v[180:183], v[80:83], v[60:63], v[180:183]
s_cselect_b32 s36, s29, s39
s_cmp_eq_u32 s37, 3
v_mfma_f32_16x16x32_bf16 v[200:203], v[80:83], v[64:67], v[200:203]
s_cselect_b32 s37, 0, s37
s_sub_u32 s38, s38, 1
v_mfma_f32_16x16x32_bf16 v[144:147], v[84:87], v[52:55], v[144:147]
v_mfma_f32_16x16x32_bf16 v[164:167], v[84:87], v[56:59], v[164:167]
v_mfma_f32_16x16x32_bf16 v[184:187], v[84:87], v[60:63], v[184:187]
v_mfma_f32_16x16x32_bf16 v[204:207], v[84:87], v[64:67], v[204:207]
.p2align 6
P2SC_LOOP:
s_waitcnt lgkmcnt(0)
s_cmp_eq_u32 s38, 4
v_mfma_f32_16x16x32_bf16 v[128:131], v[32:35], v[16:19], v[128:131]
ds_read_b128 v[68:71], v9 offset:0
v_mfma_f32_16x16x32_bf16 v[148:151], v[32:35], v[20:23], v[148:151]
ds_read_b64_tr_b16 v[52:53], v4 offset:8192
v_mfma_f32_16x16x32_bf16 v[168:171], v[32:35], v[24:27], v[168:171]
ds_read_b64_tr_b16 v[54:55], v4 offset:9216
v_mfma_f32_16x16x32_bf16 v[188:191], v[32:35], v[28:31], v[188:191]
ds_read_b128 v[72:75], v9 offset:2048
v_mfma_f32_16x16x32_bf16 v[132:135], v[36:39], v[16:19], v[132:135]
ds_read_b64_tr_b16 v[56:57], v5 offset:8192
v_mfma_f32_16x16x32_bf16 v[152:155], v[36:39], v[20:23], v[152:155]
ds_read_b64_tr_b16 v[58:59], v5 offset:9216
v_mfma_f32_16x16x32_bf16 v[172:175], v[36:39], v[24:27], v[172:175]
ds_read_b128 v[76:79], v9 offset:4096
v_mfma_f32_16x16x32_bf16 v[192:195], v[36:39], v[28:31], v[192:195]
ds_read_b64_tr_b16 v[60:61], v6 offset:8192
v_mfma_f32_16x16x32_bf16 v[136:139], v[40:43], v[16:19], v[136:139]
ds_read_b64_tr_b16 v[62:63], v6 offset:9216
v_mfma_f32_16x16x32_bf16 v[156:159], v[40:43], v[20:23], v[156:159]
ds_read_b128 v[80:83], v9 offset:6144
v_mfma_f32_16x16x32_bf16 v[176:179], v[40:43], v[24:27], v[176:179]
ds_read_b64_tr_b16 v[64:65], v7 offset:8192
v_mfma_f32_16x16x32_bf16 v[196:199], v[40:43], v[28:31], v[196:199]
ds_read_b64_tr_b16 v[66:67], v7 offset:9216
v_mfma_f32_16x16x32_bf16 v[140:143], v[44:47], v[16:19], v[140:143]
ds_read_b128 v[84:87], v9 offset:8192
v_mfma_f32_16x16x32_bf16 v[160:163], v[44:47], v[20:23], v[160:163]
v_add_u32_e64 v4, s36, v4
v_mfma_f32_16x16x32_bf16 v[180:183], v[44:47], v[24:27], v[180:183]
v_add_u32_e64 v5, s36, v5
v_mfma_f32_16x16x32_bf16 v[200:203], v[44:47], v[28:31], v[200:203]
v_add_u32_e64 v6, s36, v6
v_mfma_f32_16x16x32_bf16 v[144:147], v[48:51], v[16:19], v[144:147]
v_add_u32_e64 v7, s36, v7
v_mfma_f32_16x16x32_bf16 v[164:167], v[48:51], v[20:23], v[164:167]
v_add_u32_e64 v8, s36, v8
v_mfma_f32_16x16x32_bf16 v[184:187], v[48:51], v[24:27], v[184:187]
v_add_u32_e64 v9, s36, v9
v_mfma_f32_16x16x32_bf16 v[204:207], v[48:51], v[28:31], v[204:207]
s_waitcnt lgkmcnt(0)
s_barrier
v_mfma_f32_16x16x32_bf16 v[128:131], v[68:71], v[52:55], v[128:131]
ds_read_b128 v[32:35], v8 offset:0
v_mfma_f32_16x16x32_bf16 v[148:151], v[68:71], v[56:59], v[148:151]
ds_read_b64_tr_b16 v[16:17], v4 offset:0
v_mfma_f32_16x16x32_bf16 v[168:171], v[68:71], v[60:63], v[168:171]
ds_read_b64_tr_b16 v[18:19], v4 offset:1024
v_mfma_f32_16x16x32_bf16 v[188:191], v[68:71], v[64:67], v[188:191]
ds_read_b128 v[36:39], v8 offset:2048
v_mfma_f32_16x16x32_bf16 v[132:135], v[72:75], v[52:55], v[132:135]
ds_read_b64_tr_b16 v[20:21], v5 offset:0
v_mfma_f32_16x16x32_bf16 v[152:155], v[72:75], v[56:59], v[152:155]
ds_read_b64_tr_b16 v[22:23], v5 offset:1024
v_mfma_f32_16x16x32_bf16 v[172:175], v[72:75], v[60:63], v[172:175]
ds_read_b128 v[40:43], v8 offset:4096
v_mfma_f32_16x16x32_bf16 v[192:195], v[72:75], v[64:67], v[192:195]
ds_read_b64_tr_b16 v[24:25], v6 offset:0
v_mfma_f32_16x16x32_bf16 v[136:139], v[76:79], v[52:55], v[136:139]
ds_read_b64_tr_b16 v[26:27], v6 offset:1024
v_mfma_f32_16x16x32_bf16 v[156:159], v[76:79], v[56:59], v[156:159]
ds_read_b128 v[44:47], v8 offset:6144
v_mfma_f32_16x16x32_bf16 v[176:179], v[76:79], v[60:63], v[176:179]
ds_read_b64_tr_b16 v[28:29], v7 offset:0
v_mfma_f32_16x16x32_bf16 v[196:199], v[76:79], v[64:67], v[196:199]
ds_read_b64_tr_b16 v[30:31], v7 offset:1024
v_mfma_f32_16x16x32_bf16 v[140:143], v[80:83], v[52:55], v[140:143]
ds_read_b128 v[48:51], v8 offset:8192
v_mfma_f32_16x16x32_bf16 v[160:163], v[80:83], v[56:59], v[160:163]
s_add_u32 s37, s37, 1
s_cmp_eq_u32 s37, 2
v_mfma_f32_16x16x32_bf16 v[180:183], v[80:83], v[60:63], v[180:183]
s_cselect_b32 s36, s29, s39
s_cmp_eq_u32 s37, 3
v_mfma_f32_16x16x32_bf16 v[200:203], v[80:83], v[64:67], v[200:203]
s_cselect_b32 s37, 0, s37
s_sub_u32 s38, s38, 1
v_mfma_f32_16x16x32_bf16 v[144:147], v[84:87], v[52:55], v[144:147]
v_mfma_f32_16x16x32_bf16 v[164:167], v[84:87], v[56:59], v[164:167]
v_mfma_f32_16x16x32_bf16 v[184:187], v[84:87], v[60:63], v[184:187]
v_mfma_f32_16x16x32_bf16 v[204:207], v[84:87], v[64:67], v[204:207]
s_cmp_lg_u32 s38, 0
s_cbranch_scc1 P2SC_LOOP
s_waitcnt lgkmcnt(0)
s_nop 0
v_mfma_f32_16x16x32_bf16 v[128:131], v[32:35], v[16:19], v[128:131]
ds_read_b128 v[68:71], v9 offset:0
v_mfma_f32_16x16x32_bf16 v[148:151], v[32:35], v[20:23], v[148:151]
ds_read_b64_tr_b16 v[52:53], v4 offset:8192
v_mfma_f32_16x16x32_bf16 v[168:171], v[32:35], v[24:27], v[168:171]
ds_read_b64_tr_b16 v[54:55], v4 offset:9216
v_mfma_f32_16x16x32_bf16 v[188:191], v[32:35], v[28:31], v[188:191]
ds_read_b128 v[72:75], v9 offset:2048
v_mfma_f32_16x16x32_bf16 v[132:135], v[36:39], v[16:19], v[132:135]
ds_read_b64_tr_b16 v[56:57], v5 offset:8192
v_mfma_f32_16x16x32_bf16 v[152:155], v[36:39], v[20:23], v[152:155]
ds_read_b64_tr_b16 v[58:59], v5 offset:9216
v_mfma_f32_16x16x32_bf16 v[172:175], v[36:39], v[24:27], v[172:175]
ds_read_b128 v[76:79], v9 offset:4096
v_mfma_f32_16x16x32_bf16 v[192:195], v[36:39], v[28:31], v[192:195]
ds_read_b64_tr_b16 v[60:61], v6 offset:8192
v_mfma_f32_16x16x32_bf16 v[136:139], v[40:43], v[16:19], v[136:139]
ds_read_b64_tr_b16 v[62:63], v6 offset:9216
v_mfma_f32_16x16x32_bf16 v[156:159], v[40:43], v[20:23], v[156:159]
ds_read_b128 v[80:83], v9 offset:6144
v_mfma_f32_16x16x32_bf16 v[176:179], v[40:43], v[24:27], v[176:179]
ds_read_b64_tr_b16 v[64:65], v7 offset:8192
v_mfma_f32_16x16x32_bf16 v[196:199], v[40:43], v[28:31], v[196:199]
ds_read_b64_tr_b16 v[66:67], v7 offset:9216
v_mfma_f32_16x16x32_bf16 v[140:143], v[44:47], v[16:19], v[140:143]
ds_read_b128 v[84:87], v9 offset:8192
v_mfma_f32_16x16x32_bf16 v[160:163], v[44:47], v[20:23], v[160:163]
v_mfma_f32_16x16x32_bf16 v[180:183], v[44:47], v[24:27], v[180:183]
v_mfma_f32_16x16x32_bf16 v[200:203], v[44:47], v[28:31], v[200:203]
v_mfma_f32_16x16x32_bf16 v[144:147], v[48:51], v[16:19], v[144:147]
v_mfma_f32_16x16x32_bf16 v[164:167], v[48:51], v[20:23], v[164:167]
v_mfma_f32_16x16x32_bf16 v[184:187], v[48:51], v[24:27], v[184:187]
v_mfma_f32_16x16x32_bf16 v[204:207], v[48:51], v[28:31], v[204:207]
s_waitcnt lgkmcnt(0)
s_nop 0
v_mfma_f32_16x16x32_bf16 v[128:131], v[68:71], v[52:55], v[128:131]
v_mfma_f32_16x16x32_bf16 v[148:151], v[68:71], v[56:59], v[148:151]
v_mfma_f32_16x16x32_bf16 v[168:171], v[68:71], v[60:63], v[168:171]
v_mfma_f32_16x16x32_bf16 v[188:191], v[68:71], v[64:67], v[188:191]
v_mfma_f32_16x16x32_bf16 v[132:135], v[72:75], v[52:55], v[132:135]
v_mfma_f32_16x16x32_bf16 v[152:155], v[72:75], v[56:59], v[152:155]
v_mfma_f32_16x16x32_bf16 v[172:175], v[72:75], v[60:63], v[172:175]
v_mfma_f32_16x16x32_bf16 v[192:195], v[72:75], v[64:67], v[192:195]
v_mfma_f32_16x16x32_bf16 v[136:139], v[76:79], v[52:55], v[136:139]
v_mfma_f32_16x16x32_bf16 v[156:159], v[76:79], v[56:59], v[156:159]
v_mfma_f32_16x16x32_bf16 v[176:179], v[76:79], v[60:63], v[176:179]
v_mfma_f32_16x16x32_bf16 v[196:199], v[76:79], v[64:67], v[196:199]
v_mfma_f32_16x16x32_bf16 v[140:143], v[80:83], v[52:55], v[140:143]
v_mfma_f32_16x16x32_bf16 v[160:163], v[80:83], v[56:59], v[160:163]
v_mfma_f32_16x16x32_bf16 v[180:183], v[80:83], v[60:63], v[180:183]
v_mfma_f32_16x16x32_bf16 v[200:203], v[80:83], v[64:67], v[200:203]
v_mfma_f32_16x16x32_bf16 v[144:147], v[84:87], v[52:55], v[144:147]
v_mfma_f32_16x16x32_bf16 v[164:167], v[84:87], v[56:59], v[164:167]
v_mfma_f32_16x16x32_bf16 v[184:187], v[84:87], v[60:63], v[184:187]
v_mfma_f32_16x16x32_bf16 v[204:207], v[84:87], v[64:67], v[204:207]
s_waitcnt vmcnt(0)
v_mov_b32 v242, v238
v_mov_b32 v243, v239
v_mov_b32 v244, v240
v_mov_b32 v245, v241
s_lshl_b32 s32, s21, 2
s_add_u32 s32, s32, s23
s_mul_i32 s33, s32, 163840
s_add_u32 s33, s33, 16777216
s_mul_i32 s34, s20, 2560
s_add_u32 s33, s33, s34
s_mul_i32 s34, s24, 10240
s_add_u32 s40, s33, s34
v_lshlrev_b32 v14, 4, v0
v_lshlrev_b32 v13, 3, v0
s_lshl_b32 s41, s32, 10
s_lshl_b32 s34, s20, 6
s_add_u32 s41, s41, s34
s_add_u32 s41, s41, 16384000
s_nop 7
s_cmp_eq_u32 s24, 0
s_cbranch_scc1 P2SC_S0
s_add_u32 s34, s40, 0
v_pk_mul_f32 v[128:129], v[128:129], v[242:243] op_sel_hi:[1,0]
v_pk_mul_f32 v[130:131], v[130:131], v[242:243] op_sel_hi:[1,0]
v_cvt_pk_bf16_f32 v16, v128, v129
v_cvt_pk_bf16_f32 v17, v130, v131
v_pk_mul_f32 v[132:133], v[132:133], v[242:243] op_sel_hi:[1,0]
v_pk_mul_f32 v[134:135], v[134:135], v[242:243] op_sel_hi:[1,0]
v_cvt_pk_bf16_f32 v18, v132, v133
v_cvt_pk_bf16_f32 v19, v134, v135
v_pk_mul_f32 v[136:137], v[136:137], v[242:243] op_sel_hi:[1,0]
v_pk_mul_f32 v[138:139], v[138:139], v[242:243] op_sel_hi:[1,0]
v_cvt_pk_bf16_f32 v20, v136, v137
v_cvt_pk_bf16_f32 v21, v138, v139
v_pk_mul_f32 v[140:141], v[140:141], v[242:243] op_sel_hi:[1,0]
v_pk_mul_f32 v[142:143], v[142:143], v[242:243] op_sel_hi:[1,0]
v_cvt_pk_bf16_f32 v22, v140, v141
v_cvt_pk_bf16_f32 v23, v142, v143
v_pk_mul_f32 v[144:145], v[144:145], v[242:243] op_sel_hi:[1,0]
v_pk_mul_f32 v[146:147], v[146:147], v[242:243] op_sel_hi:[1,0]
v_cvt_pk_bf16_f32 v24, v144, v145
v_cvt_pk_bf16_f32 v25, v146, v147
buffer_store_dwordx4 v[16:19], v14, s[12:15], s34 offen sc1
buffer_store_dwordx4 v[20:23], v14, s[12:15], s34 offen offset:1024 sc1
buffer_store_dwordx2 v[24:25], v13, s[12:15], s34 offen offset:2048 sc1
s_add_u32 s34, s40, 81920
v_pk_mul_f32 v[168:169], v[168:169], v[244:245] op_sel_hi:[1,0]
v_pk_mul_f32 v[170:171], v[170:171], v[244:245] op_sel_hi:[1,0]
v_cvt_pk_bf16_f32 v28, v168, v169
v_cvt_pk_bf16_f32 v29, v170, v171
v_pk_mul_f32 v[172:173], v[172:173], v[244:245] op_sel_hi:[1,0]
v_pk_mul_f32 v[174:175], v[174:175], v[244:245] op_sel_hi:[1,0]
v_cvt_pk_bf16_f32 v30, v172, v173
v_cvt_pk_bf16_f32 v31, v174, v175
v_pk_mul_f32 v[176:177], v[176:177], v[244:245] op_sel_hi:[1,0]
v_pk_mul_f32 v[178:179], v[178:179], v[244:245] op_sel_hi:[1,0]
v_cvt_pk_bf16_f32 v32, v176, v177
v_cvt_pk_bf16_f32 v33, v178, v179
v_pk_mul_f32 v[180:181], v[180:181], v[244:245] op_sel_hi:[1,0]
v_pk_mul_f32 v[182:183], v[182:183], v[244:245] op_sel_hi:[1,0]
v_cvt_pk_bf16_f32 v34, v180, v181
v_cvt_pk_bf16_f32 v35, v182, v183
v_pk_mul_f32 v[184:185], v[184:185], v[244:245] op_sel_hi:[1,0]
v_pk_mul_f32 v[186:187], v[186:187], v[244:245] op_sel_hi:[1,0]
v_cvt_pk_bf16_f32 v36, v184, v185
v_cvt_pk_bf16_f32 v37, v186, v187
buffer_store_dwordx4 v[28:31], v14, s[12:15], s34 offen sc1
buffer_store_dwordx4 v[32:35], v14, s[12:15], s34 offen offset:1024 sc1
buffer_store_dwordx2 v[36:37], v13, s[12:15], s34 offen offset:2048 sc1
s_add_u32 s34, s40, 122880
v_pk_mul_f32 v[188:189], v[188:189], v[244:245] op_sel:[0,1]
v_pk_mul_f32 v[190:191], v[190:191], v[244:245] op_sel:[0,1]
v_cvt_pk_bf16_f32 v40, v188, v189
v_cvt_pk_bf16_f32 v41, v190, v191
v_pk_mul_f32 v[192:193], v[192:193], v[244:245] op_sel:[0,1]
v_pk_mul_f32 v[194:195], v[194:195], v[244:245] op_sel:[0,1]
v_cvt_pk_bf16_f32 v42, v192, v193
v_cvt_pk_bf16_f32 v43, v194, v195
v_pk_mul_f32 v[196:197], v[196:197], v[244:245] op_sel:[0,1]
v_pk_mul_f32 v[198:199], v[198:199], v[244:245] op_sel:[0,1]
v_cvt_pk_bf16_f32 v44, v196, v197
v_cvt_pk_bf16_f32 v45, v198, v199
v_pk_mul_f32 v[200:201], v[200:201], v[244:245] op_sel:[0,1]
v_pk_mul_f32 v[202:203], v[202:203], v[244:245] op_sel:[0,1]
v_cvt_pk_bf16_f32 v46, v200, v201
v_cvt_pk_bf16_f32 v47, v202, v203
v_pk_mul_f32 v[204:205], v[204:205], v[244:245] op_sel:[0,1]
v_pk_mul_f32 v[206:207], v[206:207], v[244:245] op_sel:[0,1]
v_cvt_pk_bf16_f32 v48, v204, v205
v_cvt_pk_bf16_f32 v49, v206, v207
buffer_store_dwordx4 v[40:43], v14, s[12:15], s34 offen sc1
buffer_store_dwordx4 v[44:47], v14, s[12:15], s34 offen offset:1024 sc1
buffer_store_dwordx2 v[48:49], v13, s[12:15], s34 offen offset:2048 sc1
v_sub_f32 v15, 1.0, v239
v_mul_f32 v148, v148, v243
v_mul_f32 v149, v149, v243
v_mul_f32 v150, v150, v243
v_mul_f32 v151, v151, v243
v_lshlrev_b32 v56, 16, v208
v_and_b32 v57, 0xffff0000, v208
v_lshlrev_b32 v58, 16, v218
v_and_b32 v59, 0xffff0000, v218
v_lshlrev_b32 v60, 16, v228
v_and_b32 v61, 0xffff0000, v228
v_mul_f32 v56, v56, v58
v_mul_f32 v57, v57, v59
v_fmac_f32 v148, v239, v56
v_fmac_f32 v149, v239, v57
v_fmac_f32 v148, v15, v60
v_fmac_f32 v149, v15, v61
v_lshlrev_b32 v56, 16, v209
v_and_b32 v57, 0xffff0000, v209
v_lshlrev_b32 v58, 16, v219
v_and_b32 v59, 0xffff0000, v219
v_lshlrev_b32 v60, 16, v229
v_and_b32 v61, 0xffff0000, v229
v_mul_f32 v56, v56, v58
v_mul_f32 v57, v57, v59
v_fmac_f32 v150, v239, v56
v_fmac_f32 v151, v239, v57
v_fmac_f32 v150, v15, v60
v_fmac_f32 v151, v15, v61
v_mul_f32 v152, v152, v243
v_mul_f32 v153, v153, v243
v_mul_f32 v154, v154, v243
v_mul_f32 v155, v155, v243
v_lshlrev_b32 v56, 16, v210
v_and_b32 v57, 0xffff0000, v210
v_lshlrev_b32 v58, 16, v220
v_and_b32 v59, 0xffff0000, v220
v_lshlrev_b32 v60, 16, v230
v_and_b32 v61, 0xffff0000, v230
v_mul_f32 v56, v56, v58
v_mul_f32 v57, v57, v59
v_fmac_f32 v152, v239, v56
v_fmac_f32 v153, v239, v57
v_fmac_f32 v152, v15, v60
v_fmac_f32 v153, v15, v61
v_lshlrev_b32 v56, 16, v211
v_and_b32 v57, 0xffff0000, v211
v_lshlrev_b32 v58, 16, v221
v_and_b32 v59, 0xffff0000, v221
v_lshlrev_b32 v60, 16, v231
v_and_b32 v61, 0xffff0000, v231
v_mul_f32 v56, v56, v58
v_mul_f32 v57, v57, v59
v_fmac_f32 v154, v239, v56
v_fmac_f32 v155, v239, v57
v_fmac_f32 v154, v15, v60
v_fmac_f32 v155, v15, v61
v_mul_f32 v156, v156, v243
v_mul_f32 v157, v157, v243
v_mul_f32 v158, v158, v243
v_mul_f32 v159, v159, v243
v_lshlrev_b32 v56, 16, v212
v_and_b32 v57, 0xffff0000, v212
v_lshlrev_b32 v58, 16, v222
v_and_b32 v59, 0xffff0000, v222
v_lshlrev_b32 v60, 16, v232
v_and_b32 v61, 0xffff0000, v232
v_mul_f32 v56, v56, v58
v_mul_f32 v57, v57, v59
v_fmac_f32 v156, v239, v56
v_fmac_f32 v157, v239, v57
v_fmac_f32 v156, v15, v60
v_fmac_f32 v157, v15, v61
v_lshlrev_b32 v56, 16, v213
v_and_b32 v57, 0xffff0000, v213
v_lshlrev_b32 v58, 16, v223
v_and_b32 v59, 0xffff0000, v223
v_lshlrev_b32 v60, 16, v233
v_and_b32 v61, 0xffff0000, v233
v_mul_f32 v56, v56, v58
v_mul_f32 v57, v57, v59
v_fmac_f32 v158, v239, v56
v_fmac_f32 v159, v239, v57
v_fmac_f32 v158, v15, v60
v_fmac_f32 v159, v15, v61
v_mul_f32 v160, v160, v243
v_mul_f32 v161, v161, v243
v_mul_f32 v162, v162, v243
v_mul_f32 v163, v163, v243
v_lshlrev_b32 v56, 16, v214
v_and_b32 v57, 0xffff0000, v214
v_lshlrev_b32 v58, 16, v224
v_and_b32 v59, 0xffff0000, v224
v_lshlrev_b32 v60, 16, v234
v_and_b32 v61, 0xffff0000, v234
v_mul_f32 v56, v56, v58
v_mul_f32 v57, v57, v59
v_fmac_f32 v160, v239, v56
v_fmac_f32 v161, v239, v57
v_fmac_f32 v160, v15, v60
v_fmac_f32 v161, v15, v61
v_lshlrev_b32 v56, 16, v215
v_and_b32 v57, 0xffff0000, v215
v_lshlrev_b32 v58, 16, v225
v_and_b32 v59, 0xffff0000, v225
v_lshlrev_b32 v60, 16, v235
v_and_b32 v61, 0xffff0000, v235
v_mul_f32 v56, v56, v58
v_mul_f32 v57, v57, v59
v_fmac_f32 v162, v239, v56
v_fmac_f32 v163, v239, v57
v_fmac_f32 v162, v15, v60
v_fmac_f32 v163, v15, v61
v_mul_f32 v164, v164, v243
v_mul_f32 v165, v165, v243
v_mul_f32 v166, v166, v243
v_mul_f32 v167, v167, v243
v_lshlrev_b32 v56, 16, v216
v_and_b32 v57, 0xffff0000, v216
v_lshlrev_b32 v58, 16, v226
v_and_b32 v59, 0xffff0000, v226
v_lshlrev_b32 v60, 16, v236
v_and_b32 v61, 0xffff0000, v236
v_mul_f32 v56, v56, v58
v_mul_f32 v57, v57, v59
v_fmac_f32 v164, v239, v56
v_fmac_f32 v165, v239, v57
v_fmac_f32 v164, v15, v60
v_fmac_f32 v165, v15, v61
v_lshlrev_b32 v56, 16, v217
v_and_b32 v57, 0xffff0000, v217
v_lshlrev_b32 v58, 16, v227
v_and_b32 v59, 0xffff0000, v227
v_lshlrev_b32 v60, 16, v237
v_and_b32 v61, 0xffff0000, v237
v_mul_f32 v56, v56, v58
v_mul_f32 v57, v57, v59
v_fmac_f32 v166, v239, v56
v_fmac_f32 v167, v239, v57
v_fmac_f32 v166, v15, v60
v_fmac_f32 v167, v15, v61
s_waitcnt vmcnt(0)
s_mov_b64 s[76:77], exec
s_mov_b64 exec, 1
v_mov_b32 v64, s90
v_mov_b32 v65, 4
s_add_u32 s34, s41, 0
buffer_store_dword v64, v65, s[12:15], s34 offen sc1
s_add_u32 s34, s41, 512
buffer_store_dword v64, v65, s[12:15], s34 offen sc1
s_add_u32 s34, s41, 768
buffer_store_dword v64, v65, s[12:15], s34 offen sc1
s_add_u32 s34, s41, 256
v_mov_b32 v65, 0
s_mov_b32 s36, 0
P2SCX_19P:
buffer_load_dwordx4 v[68:71], v65, s[12:15], s34 offen sc1
s_waitcnt vmcnt(0)
s_mov_b32 s35, 1
v_readfirstlane_b32 s37, v68
s_cmp_eq_u32 s37, s90
s_cselect_b32 s35, s35, 0
v_readfirstlane_b32 s37, v70
s_cmp_eq_u32 s37, s90
s_cselect_b32 s35, s35, 0
v_readfirstlane_b32 s37, v71
s_cmp_eq_u32 s37, s90
s_cselect_b32 s35, s35, 0
s_cmp_eq_u32 s35, 1
s_cbranch_scc1 P2SCX_19D
s_add_u32 s36, s36, 1
s_cmp_lt_u32 s36, 0x4000
s_cbranch_scc0 P2SCX_19D
s_branch P2SCX_19P
P2SCX_19D:
s_mov_b64 exec, s[76:77]
s_add_u32 s34, s33, 40960
buffer_load_dwordx4 v[16:19], v14, s[12:15], s34 offen sc1
buffer_load_dwordx4 v[20:23], v14, s[12:15], s34 offen offset:1024 sc1
buffer_load_dwordx2 v[24:25], v13, s[12:15], s34 offen offset:2048 sc1
s_add_u32 s34, s33, 61440
buffer_load_dwordx4 v[28:31], v14, s[12:15], s34 offen sc1
buffer_load_dwordx4 v[32:35], v14, s[12:15], s34 offen offset:1024 sc1
buffer_load_dwordx2 v[36:37], v13, s[12:15], s34 offen offset:2048 sc1
s_add_u32 s34, s33, 71680
buffer_load_dwordx4 v[40:43], v14, s[12:15], s34 offen sc1
buffer_load_dwordx4 v[44:47], v14, s[12:15], s34 offen offset:1024 sc1
buffer_load_dwordx2 v[48:49], v13, s[12:15], s34 offen offset:2048 sc1
s_waitcnt vmcnt(6)
v_lshlrev_b32 v56, 16, v16
v_and_b32 v57, 0xffff0000, v16
v_pk_add_f32 v[148:149], v[148:149], v[56:57]
v_lshlrev_b32 v56, 16, v17
v_and_b32 v57, 0xffff0000, v17
v_pk_add_f32 v[150:151], v[150:151], v[56:57]
v_lshlrev_b32 v56, 16, v18
v_and_b32 v57, 0xffff0000, v18
v_pk_add_f32 v[152:153], v[152:153], v[56:57]
v_lshlrev_b32 v56, 16, v19
v_and_b32 v57, 0xffff0000, v19
v_pk_add_f32 v[154:155], v[154:155], v[56:57]
v_lshlrev_b32 v56, 16, v20
v_and_b32 v57, 0xffff0000, v20
v_pk_add_f32 v[156:157], v[156:157], v[56:57]
v_lshlrev_b32 v56, 16, v21
v_and_b32 v57, 0xffff0000, v21
v_pk_add_f32 v[158:159], v[158:159], v[56:57]
v_lshlrev_b32 v56, 16, v22
v_and_b32 v57, 0xffff0000, v22
v_pk_add_f32 v[160:161], v[160:161], v[56:57]
v_lshlrev_b32 v56, 16, v23
v_and_b32 v57, 0xffff0000, v23
v_pk_add_f32 v[162:163], v[162:163], v[56:57]
v_lshlrev_b32 v56, 16, v24
v_and_b32 v57, 0xffff0000, v24
v_pk_add_f32 v[164:165], v[164:165], v[56:57]
v_lshlrev_b32 v56, 16, v25
v_and_b32 v57, 0xffff0000, v25
v_pk_add_f32 v[166:167], v[166:167], v[56:57]
s_waitcnt vmcnt(3)
v_lshlrev_b32 v56, 16, v28
v_and_b32 v57, 0xffff0000, v28
v_pk_add_f32 v[148:149], v[148:149], v[56:57]
v_lshlrev_b32 v56, 16, v29
v_and_b32 v57, 0xffff0000, v29
v_pk_add_f32 v[150:151], v[150:151], v[56:57]
v_lshlrev_b32 v56, 16, v30
v_and_b32 v57, 0xffff0000, v30
v_pk_add_f32 v[152:153], v[152:153], v[56:57]
v_lshlrev_b32 v56, 16, v31
v_and_b32 v57, 0xffff0000, v31
v_pk_add_f32 v[154:155], v[154:155], v[56:57]
v_lshlrev_b32 v56, 16, v32
v_and_b32 v57, 0xffff0000, v32
v_pk_add_f32 v[156:157], v[156:157], v[56:57]
v_lshlrev_b32 v56, 16, v33
v_and_b32 v57, 0xffff0000, v33
v_pk_add_f32 v[158:159], v[158:159], v[56:57]
v_lshlrev_b32 v56, 16, v34
v_and_b32 v57, 0xffff0000, v34
v_pk_add_f32 v[160:161], v[160:161], v[56:57]
v_lshlrev_b32 v56, 16, v35
v_and_b32 v57, 0xffff0000, v35
v_pk_add_f32 v[162:163], v[162:163], v[56:57]
v_lshlrev_b32 v56, 16, v36
v_and_b32 v57, 0xffff0000, v36
v_pk_add_f32 v[164:165], v[164:165], v[56:57]
v_lshlrev_b32 v56, 16, v37
v_and_b32 v57, 0xffff0000, v37
v_pk_add_f32 v[166:167], v[166:167], v[56:57]
s_waitcnt vmcnt(0)
v_lshlrev_b32 v56, 16, v40
v_and_b32 v57, 0xffff0000, v40
v_pk_add_f32 v[148:149], v[148:149], v[56:57]
v_lshlrev_b32 v56, 16, v41
v_and_b32 v57, 0xffff0000, v41
v_pk_add_f32 v[150:151], v[150:151], v[56:57]
v_lshlrev_b32 v56, 16, v42
v_and_b32 v57, 0xffff0000, v42
v_pk_add_f32 v[152:153], v[152:153], v[56:57]
v_lshlrev_b32 v56, 16, v43
v_and_b32 v57, 0xffff0000, v43
v_pk_add_f32 v[154:155], v[154:155], v[56:57]
v_lshlrev_b32 v56, 16, v44
v_and_b32 v57, 0xffff0000, v44
v_pk_add_f32 v[156:157], v[156:157], v[56:57]
v_lshlrev_b32 v56, 16, v45
v_and_b32 v57, 0xffff0000, v45
v_pk_add_f32 v[158:159], v[158:159], v[56:57]
v_lshlrev_b32 v56, 16, v46
v_and_b32 v57, 0xffff0000, v46
v_pk_add_f32 v[160:161], v[160:161], v[56:57]
v_lshlrev_b32 v56, 16, v47
v_and_b32 v57, 0xffff0000, v47
v_pk_add_f32 v[162:163], v[162:163], v[56:57]
v_lshlrev_b32 v56, 16, v48
v_and_b32 v57, 0xffff0000, v48
v_pk_add_f32 v[164:165], v[164:165], v[56:57]
v_lshlrev_b32 v56, 16, v49
v_and_b32 v57, 0xffff0000, v49
v_pk_add_f32 v[166:167], v[166:167], v[56:57]
buffer_store_dwordx4 v[148:151], v246, s[16:19], 0 offen offset:0 sc1
buffer_store_dwordx4 v[152:155], v246, s[16:19], 0 offen offset:64 sc1
buffer_store_dwordx4 v[156:159], v246, s[16:19], 0 offen offset:128 sc1
buffer_store_dwordx4 v[160:163], v246, s[16:19], 0 offen offset:192 sc1
buffer_store_dwordx4 v[164:167], v246, s[16:19], 0 offen offset:256 sc1
s_branch P2SC_END
P2SC_S0:
s_add_u32 s34, s40, 40960
v_pk_mul_f32 v[148:149], v[148:149], v[242:243] op_sel:[0,1]
v_pk_mul_f32 v[150:151], v[150:151], v[242:243] op_sel:[0,1]
v_cvt_pk_bf16_f32 v16, v148, v149
v_cvt_pk_bf16_f32 v17, v150, v151
v_pk_mul_f32 v[152:153], v[152:153], v[242:243] op_sel:[0,1]
v_pk_mul_f32 v[154:155], v[154:155], v[242:243] op_sel:[0,1]
v_cvt_pk_bf16_f32 v18, v152, v153
v_cvt_pk_bf16_f32 v19, v154, v155
v_pk_mul_f32 v[156:157], v[156:157], v[242:243] op_sel:[0,1]
v_pk_mul_f32 v[158:159], v[158:159], v[242:243] op_sel:[0,1]
v_cvt_pk_bf16_f32 v20, v156, v157
v_cvt_pk_bf16_f32 v21, v158, v159
v_pk_mul_f32 v[160:161], v[160:161], v[242:243] op_sel:[0,1]
v_pk_mul_f32 v[162:163], v[162:163], v[242:243] op_sel:[0,1]
v_cvt_pk_bf16_f32 v22, v160, v161
v_cvt_pk_bf16_f32 v23, v162, v163
v_pk_mul_f32 v[164:165], v[164:165], v[242:243] op_sel:[0,1]
v_pk_mul_f32 v[166:167], v[166:167], v[242:243] op_sel:[0,1]
v_cvt_pk_bf16_f32 v24, v164, v165
v_cvt_pk_bf16_f32 v25, v166, v167
buffer_store_dwordx4 v[16:19], v14, s[12:15], s34 offen sc1
buffer_store_dwordx4 v[20:23], v14, s[12:15], s34 offen offset:1024 sc1
buffer_store_dwordx2 v[24:25], v13, s[12:15], s34 offen offset:2048 sc1
s_add_u32 s34, s40, 81920
v_pk_mul_f32 v[168:169], v[168:169], v[244:245] op_sel_hi:[1,0]
v_pk_mul_f32 v[170:171], v[170:171], v[244:245] op_sel_hi:[1,0]
v_cvt_pk_bf16_f32 v28, v168, v169
v_cvt_pk_bf16_f32 v29, v170, v171
v_pk_mul_f32 v[172:173], v[172:173], v[244:245] op_sel_hi:[1,0]
v_pk_mul_f32 v[174:175], v[174:175], v[244:245] op_sel_hi:[1,0]
v_cvt_pk_bf16_f32 v30, v172, v173
v_cvt_pk_bf16_f32 v31, v174, v175
v_pk_mul_f32 v[176:177], v[176:177], v[244:245] op_sel_hi:[1,0]
v_pk_mul_f32 v[178:179], v[178:179], v[244:245] op_sel_hi:[1,0]
v_cvt_pk_bf16_f32 v32, v176, v177
v_cvt_pk_bf16_f32 v33, v178, v179
v_pk_mul_f32 v[180:181], v[180:181], v[244:245] op_sel_hi:[1,0]
v_pk_mul_f32 v[182:183], v[182:183], v[244:245] op_sel_hi:[1,0]
v_cvt_pk_bf16_f32 v34, v180, v181
v_cvt_pk_bf16_f32 v35, v182, v183
v_pk_mul_f32 v[184:185], v[184:185], v[244:245] op_sel_hi:[1,0]
v_pk_mul_f32 v[186:187], v[186:187], v[244:245] op_sel_hi:[1,0]
v_cvt_pk_bf16_f32 v36, v184, v185
v_cvt_pk_bf16_f32 v37, v186, v187
buffer_store_dwordx4 v[28:31], v14, s[12:15], s34 offen sc1
buffer_store_dwordx4 v[32:35], v14, s[12:15], s34 offen offset:1024 sc1
buffer_store_dwordx2 v[36:37], v13, s[12:15], s34 offen offset:2048 sc1
s_add_u32 s34, s40, 122880
v_pk_mul_f32 v[188:189], v[188:189], v[244:245] op_sel:[0,1]
v_pk_mul_f32 v[190:191], v[190:191], v[244:245] op_sel:[0,1]
v_cvt_pk_bf16_f32 v40, v188, v189
v_cvt_pk_bf16_f32 v41, v190, v191
v_pk_mul_f32 v[192:193], v[192:193], v[244:245] op_sel:[0,1]
v_pk_mul_f32 v[194:195], v[194:195], v[244:245] op_sel:[0,1]
v_cvt_pk_bf16_f32 v42, v192, v193
v_cvt_pk_bf16_f32 v43, v194, v195
v_pk_mul_f32 v[196:197], v[196:197], v[244:245] op_sel:[0,1]
v_pk_mul_f32 v[198:199], v[198:199], v[244:245] op_sel:[0,1]
v_cvt_pk_bf16_f32 v44, v196, v197
v_cvt_pk_bf16_f32 v45, v198, v199
v_pk_mul_f32 v[200:201], v[200:201], v[244:245] op_sel:[0,1]
v_pk_mul_f32 v[202:203], v[202:203], v[244:245] op_sel:[0,1]
v_cvt_pk_bf16_f32 v46, v200, v201
v_cvt_pk_bf16_f32 v47, v202, v203
v_pk_mul_f32 v[204:205], v[204:205], v[244:245] op_sel:[0,1]
v_pk_mul_f32 v[206:207], v[206:207], v[244:245] op_sel:[0,1]
v_cvt_pk_bf16_f32 v48, v204, v205
v_cvt_pk_bf16_f32 v49, v206, v207
buffer_store_dwordx4 v[40:43], v14, s[12:15], s34 offen sc1
buffer_store_dwordx4 v[44:47], v14, s[12:15], s34 offen offset:1024 sc1
buffer_store_dwordx2 v[48:49], v13, s[12:15], s34 offen offset:2048 sc1
v_sub_f32 v15, 1.0, v238
v_mul_f32 v128, v128, v242
v_mul_f32 v129, v129, v242
v_mul_f32 v130, v130, v242
v_mul_f32 v131, v131, v242
v_lshlrev_b32 v56, 16, v208
v_and_b32 v57, 0xffff0000, v208
v_lshlrev_b32 v58, 16, v218
v_and_b32 v59, 0xffff0000, v218
v_lshlrev_b32 v60, 16, v228
v_and_b32 v61, 0xffff0000, v228
v_mul_f32 v56, v56, v58
v_mul_f32 v57, v57, v59
v_fmac_f32 v128, v238, v56
v_fmac_f32 v129, v238, v57
v_fmac_f32 v128, v15, v60
v_fmac_f32 v129, v15, v61
v_lshlrev_b32 v56, 16, v209
v_and_b32 v57, 0xffff0000, v209
v_lshlrev_b32 v58, 16, v219
v_and_b32 v59, 0xffff0000, v219
v_lshlrev_b32 v60, 16, v229
v_and_b32 v61, 0xffff0000, v229
v_mul_f32 v56, v56, v58
v_mul_f32 v57, v57, v59
v_fmac_f32 v130, v238, v56
v_fmac_f32 v131, v238, v57
v_fmac_f32 v130, v15, v60
v_fmac_f32 v131, v15, v61
v_mul_f32 v132, v132, v242
v_mul_f32 v133, v133, v242
v_mul_f32 v134, v134, v242
v_mul_f32 v135, v135, v242
v_lshlrev_b32 v56, 16, v210
v_and_b32 v57, 0xffff0000, v210
v_lshlrev_b32 v58, 16, v220
v_and_b32 v59, 0xffff0000, v220
v_lshlrev_b32 v60, 16, v230
v_and_b32 v61, 0xffff0000, v230
v_mul_f32 v56, v56, v58
v_mul_f32 v57, v57, v59
v_fmac_f32 v132, v238, v56
v_fmac_f32 v133, v238, v57
v_fmac_f32 v132, v15, v60
v_fmac_f32 v133, v15, v61
v_lshlrev_b32 v56, 16, v211
v_and_b32 v57, 0xffff0000, v211
v_lshlrev_b32 v58, 16, v221
v_and_b32 v59, 0xffff0000, v221
v_lshlrev_b32 v60, 16, v231
v_and_b32 v61, 0xffff0000, v231
v_mul_f32 v56, v56, v58
v_mul_f32 v57, v57, v59
v_fmac_f32 v134, v238, v56
v_fmac_f32 v135, v238, v57
v_fmac_f32 v134, v15, v60
v_fmac_f32 v135, v15, v61
v_mul_f32 v136, v136, v242
v_mul_f32 v137, v137, v242
v_mul_f32 v138, v138, v242
v_mul_f32 v139, v139, v242
v_lshlrev_b32 v56, 16, v212
v_and_b32 v57, 0xffff0000, v212
v_lshlrev_b32 v58, 16, v222
v_and_b32 v59, 0xffff0000, v222
v_lshlrev_b32 v60, 16, v232
v_and_b32 v61, 0xffff0000, v232
v_mul_f32 v56, v56, v58
v_mul_f32 v57, v57, v59
v_fmac_f32 v136, v238, v56
v_fmac_f32 v137, v238, v57
v_fmac_f32 v136, v15, v60
v_fmac_f32 v137, v15, v61
v_lshlrev_b32 v56, 16, v213
v_and_b32 v57, 0xffff0000, v213
v_lshlrev_b32 v58, 16, v223
v_and_b32 v59, 0xffff0000, v223
v_lshlrev_b32 v60, 16, v233
v_and_b32 v61, 0xffff0000, v233
v_mul_f32 v56, v56, v58
v_mul_f32 v57, v57, v59
v_fmac_f32 v138, v238, v56
v_fmac_f32 v139, v238, v57
v_fmac_f32 v138, v15, v60
v_fmac_f32 v139, v15, v61
v_mul_f32 v140, v140, v242
v_mul_f32 v141, v141, v242
v_mul_f32 v142, v142, v242
v_mul_f32 v143, v143, v242
v_lshlrev_b32 v56, 16, v214
v_and_b32 v57, 0xffff0000, v214
v_lshlrev_b32 v58, 16, v224
v_and_b32 v59, 0xffff0000, v224
v_lshlrev_b32 v60, 16, v234
v_and_b32 v61, 0xffff0000, v234
v_mul_f32 v56, v56, v58
v_mul_f32 v57, v57, v59
v_fmac_f32 v140, v238, v56
v_fmac_f32 v141, v238, v57
v_fmac_f32 v140, v15, v60
v_fmac_f32 v141, v15, v61
v_lshlrev_b32 v56, 16, v215
v_and_b32 v57, 0xffff0000, v215
v_lshlrev_b32 v58, 16, v225
v_and_b32 v59, 0xffff0000, v225
v_lshlrev_b32 v60, 16, v235
v_and_b32 v61, 0xffff0000, v235
v_mul_f32 v56, v56, v58
v_mul_f32 v57, v57, v59
v_fmac_f32 v142, v238, v56
v_fmac_f32 v143, v238, v57
v_fmac_f32 v142, v15, v60
v_fmac_f32 v143, v15, v61
v_mul_f32 v144, v144, v242
v_mul_f32 v145, v145, v242
v_mul_f32 v146, v146, v242
v_mul_f32 v147, v147, v242
v_lshlrev_b32 v56, 16, v216
v_and_b32 v57, 0xffff0000, v216
v_lshlrev_b32 v58, 16, v226
v_and_b32 v59, 0xffff0000, v226
v_lshlrev_b32 v60, 16, v236
v_and_b32 v61, 0xffff0000, v236
v_mul_f32 v56, v56, v58
v_mul_f32 v57, v57, v59
v_fmac_f32 v144, v238, v56
v_fmac_f32 v145, v238, v57
v_fmac_f32 v144, v15, v60
v_fmac_f32 v145, v15, v61
v_lshlrev_b32 v56, 16, v217
v_and_b32 v57, 0xffff0000, v217
v_lshlrev_b32 v58, 16, v227
v_and_b32 v59, 0xffff0000, v227
v_lshlrev_b32 v60, 16, v237
v_and_b32 v61, 0xffff0000, v237
v_mul_f32 v56, v56, v58
v_mul_f32 v57, v57, v59
v_fmac_f32 v146, v238, v56
v_fmac_f32 v147, v238, v57
v_fmac_f32 v146, v15, v60
v_fmac_f32 v147, v15, v61
s_waitcnt vmcnt(0)
s_mov_b64 s[76:77], exec
s_mov_b64 exec, 1
v_mov_b32 v64, s90
v_mov_b32 v65, 0
s_add_u32 s34, s41, 256
buffer_store_dword v64, v65, s[12:15], s34 offen sc1
s_add_u32 s34, s41, 512
buffer_store_dword v64, v65, s[12:15], s34 offen sc1
s_add_u32 s34, s41, 768
buffer_store_dword v64, v65, s[12:15], s34 offen sc1
s_add_u32 s34, s41, 0
v_mov_b32 v65, 0
s_mov_b32 s36, 0
P2SCX_20P:
buffer_load_dwordx4 v[68:71], v65, s[12:15], s34 offen sc1
s_waitcnt vmcnt(0)
s_mov_b32 s35, 1
v_readfirstlane_b32 s37, v69
s_cmp_eq_u32 s37, s90
s_cselect_b32 s35, s35, 0
v_readfirstlane_b32 s37, v70
s_cmp_eq_u32 s37, s90
s_cselect_b32 s35, s35, 0
v_readfirstlane_b32 s37, v71
s_cmp_eq_u32 s37, s90
s_cselect_b32 s35, s35, 0
s_cmp_eq_u32 s35, 1
s_cbranch_scc1 P2SCX_20D
s_add_u32 s36, s36, 1
s_cmp_lt_u32 s36, 0x4000
s_cbranch_scc0 P2SCX_20D
s_branch P2SCX_20P
P2SCX_20D:
s_mov_b64 exec, s[76:77]
s_add_u32 s34, s33, 10240
buffer_load_dwordx4 v[16:19], v14, s[12:15], s34 offen sc1
buffer_load_dwordx4 v[20:23], v14, s[12:15], s34 offen offset:1024 sc1
buffer_load_dwordx2 v[24:25], v13, s[12:15], s34 offen offset:2048 sc1
s_add_u32 s34, s33, 20480
buffer_load_dwordx4 v[28:31], v14, s[12:15], s34 offen sc1
buffer_load_dwordx4 v[32:35], v14, s[12:15], s34 offen offset:1024 sc1
buffer_load_dwordx2 v[36:37], v13, s[12:15], s34 offen offset:2048 sc1
s_add_u32 s34, s33, 30720
buffer_load_dwordx4 v[40:43], v14, s[12:15], s34 offen sc1
buffer_load_dwordx4 v[44:47], v14, s[12:15], s34 offen offset:1024 sc1
buffer_load_dwordx2 v[48:49], v13, s[12:15], s34 offen offset:2048 sc1
s_waitcnt vmcnt(6)
v_lshlrev_b32 v56, 16, v16
v_and_b32 v57, 0xffff0000, v16
v_pk_add_f32 v[128:129], v[128:129], v[56:57]
v_lshlrev_b32 v56, 16, v17
v_and_b32 v57, 0xffff0000, v17
v_pk_add_f32 v[130:131], v[130:131], v[56:57]
v_lshlrev_b32 v56, 16, v18
v_and_b32 v57, 0xffff0000, v18
v_pk_add_f32 v[132:133], v[132:133], v[56:57]
v_lshlrev_b32 v56, 16, v19
v_and_b32 v57, 0xffff0000, v19
v_pk_add_f32 v[134:135], v[134:135], v[56:57]
v_lshlrev_b32 v56, 16, v20
v_and_b32 v57, 0xffff0000, v20
v_pk_add_f32 v[136:137], v[136:137], v[56:57]
v_lshlrev_b32 v56, 16, v21
v_and_b32 v57, 0xffff0000, v21
v_pk_add_f32 v[138:139], v[138:139], v[56:57]
v_lshlrev_b32 v56, 16, v22
v_and_b32 v57, 0xffff0000, v22
v_pk_add_f32 v[140:141], v[140:141], v[56:57]
v_lshlrev_b32 v56, 16, v23
v_and_b32 v57, 0xffff0000, v23
v_pk_add_f32 v[142:143], v[142:143], v[56:57]
v_lshlrev_b32 v56, 16, v24
v_and_b32 v57, 0xffff0000, v24
v_pk_add_f32 v[144:145], v[144:145], v[56:57]
v_lshlrev_b32 v56, 16, v25
v_and_b32 v57, 0xffff0000, v25
v_pk_add_f32 v[146:147], v[146:147], v[56:57]
s_waitcnt vmcnt(3)
v_lshlrev_b32 v56, 16, v28
v_and_b32 v57, 0xffff0000, v28
v_pk_add_f32 v[128:129], v[128:129], v[56:57]
v_lshlrev_b32 v56, 16, v29
v_and_b32 v57, 0xffff0000, v29
v_pk_add_f32 v[130:131], v[130:131], v[56:57]
v_lshlrev_b32 v56, 16, v30
v_and_b32 v57, 0xffff0000, v30
v_pk_add_f32 v[132:133], v[132:133], v[56:57]
v_lshlrev_b32 v56, 16, v31
v_and_b32 v57, 0xffff0000, v31
v_pk_add_f32 v[134:135], v[134:135], v[56:57]
v_lshlrev_b32 v56, 16, v32
v_and_b32 v57, 0xffff0000, v32
v_pk_add_f32 v[136:137], v[136:137], v[56:57]
v_lshlrev_b32 v56, 16, v33
v_and_b32 v57, 0xffff0000, v33
v_pk_add_f32 v[138:139], v[138:139], v[56:57]
v_lshlrev_b32 v56, 16, v34
v_and_b32 v57, 0xffff0000, v34
v_pk_add_f32 v[140:141], v[140:141], v[56:57]
v_lshlrev_b32 v56, 16, v35
v_and_b32 v57, 0xffff0000, v35
v_pk_add_f32 v[142:143], v[142:143], v[56:57]
v_lshlrev_b32 v56, 16, v36
v_and_b32 v57, 0xffff0000, v36
v_pk_add_f32 v[144:145], v[144:145], v[56:57]
v_lshlrev_b32 v56, 16, v37
v_and_b32 v57, 0xffff0000, v37
v_pk_add_f32 v[146:147], v[146:147], v[56:57]
s_waitcnt vmcnt(0)
v_lshlrev_b32 v56, 16, v40
v_and_b32 v57, 0xffff0000, v40
v_pk_add_f32 v[128:129], v[128:129], v[56:57]
v_lshlrev_b32 v56, 16, v41
v_and_b32 v57, 0xffff0000, v41
v_pk_add_f32 v[130:131], v[130:131], v[56:57]
v_lshlrev_b32 v56, 16, v42
v_and_b32 v57, 0xffff0000, v42
v_pk_add_f32 v[132:133], v[132:133], v[56:57]
v_lshlrev_b32 v56, 16, v43
v_and_b32 v57, 0xffff0000, v43
v_pk_add_f32 v[134:135], v[134:135], v[56:57]
v_lshlrev_b32 v56, 16, v44
v_and_b32 v57, 0xffff0000, v44
v_pk_add_f32 v[136:137], v[136:137], v[56:57]
v_lshlrev_b32 v56, 16, v45
v_and_b32 v57, 0xffff0000, v45
v_pk_add_f32 v[138:139], v[138:139], v[56:57]
v_lshlrev_b32 v56, 16, v46
v_and_b32 v57, 0xffff0000, v46
v_pk_add_f32 v[140:141], v[140:141], v[56:57]
v_lshlrev_b32 v56, 16, v47
v_and_b32 v57, 0xffff0000, v47
v_pk_add_f32 v[142:143], v[142:143], v[56:57]
v_lshlrev_b32 v56, 16, v48
v_and_b32 v57, 0xffff0000, v48
v_pk_add_f32 v[144:145], v[144:145], v[56:57]
v_lshlrev_b32 v56, 16, v49
v_and_b32 v57, 0xffff0000, v49
v_pk_add_f32 v[146:147], v[146:147], v[56:57]
buffer_store_dwordx4 v[128:131], v246, s[16:19], 0 offen offset:0 sc1
buffer_store_dwordx4 v[132:135], v246, s[16:19], 0 offen offset:64 sc1
buffer_store_dwordx4 v[136:139], v246, s[16:19], 0 offen offset:128 sc1
buffer_store_dwordx4 v[140:143], v246, s[16:19], 0 offen offset:192 sc1
buffer_store_dwordx4 v[144:147], v246, s[16:19], 0 offen offset:256 sc1
P2SC_END:
s_branch FIN
R_FFN_C:
s_lshr_b32 s30, s20, 1
s_and_b32 s31, s20, 1
v_lshrrev_b32 v1, 4, v0
v_and_b32 v2, 15, v0
s_lshl_b32 s32, s30, 13
v_lshrrev_b32 v3, 1, v2
v_xor_b32 v3, v1, v3
v_lshlrev_b32 v3, 4, v3
v_lshl_add_u32 v3, v2, 7, v3
v_add_u32 v4, s32, v3
v_xor_b32 v5, 64, v4
v_bfe_u32 v13, v0, 2, 2
v_and_b32 v14, 3, v0
v_lshl_add_u32 v15, v1, 3, v13
v_lshlrev_b32 v15, 7, v15
v_lshl_add_u32 v15, v14, 3, v15
v_lshrrev_b32 v13, 1, v13
v_and_b32 v14, 1, v1
v_lshl_or_b32 v13, v14, 1, v13
s_mul_i32 s32, s31, 224
s_add_u32 s32, s32, s28
s_add_u32 s33, s32, 0
s_lshr_b32 s34, s33, 7
s_lshl_b32 s34, s34, 13
s_add_u32 s34, s34, 16384
s_bfe_u32 s35, s33, 0x20005
v_xor_b32 v14, s35, v13
v_lshl_add_u32 v14, v14, 5, v15
v_add_u32 v6, s34, v14
s_add_u32 s33, s32, 32
s_lshr_b32 s34, s33, 7
s_lshl_b32 s34, s34, 13
s_add_u32 s34, s34, 16384
s_bfe_u32 s35, s33, 0x20005
v_xor_b32 v14, s35, v13
v_lshl_add_u32 v14, v14, 5, v15
v_add_u32 v7, s34, v14
s_add_u32 s33, s32, 64
s_lshr_b32 s34, s33, 7
s_lshl_b32 s34, s34, 13
s_add_u32 s34, s34, 16384
s_bfe_u32 s35, s33, 0x20005
v_xor_b32 v14, s35, v13
v_lshl_add_u32 v14, v14, 5, v15
v_add_u32 v8, s34, v14
s_add_u32 s33, s32, 96
s_lshr_b32 s34, s33, 7
s_lshl_b32 s34, s34, 13
s_add_u32 s34, s34, 16384
s_bfe_u32 s35, s33, 0x20005
v_xor_b32 v14, s35, v13
v_lshl_add_u32 v14, v14, 5, v15
v_add_u32 v9, s34, v14
s_add_u32 s33, s32, 128
s_lshr_b32 s34, s33, 7
s_lshl_b32 s34, s34, 13
s_add_u32 s34, s34, 16384
s_bfe_u32 s35, s33, 0x20005
v_xor_b32 v14, s35, v13
v_lshl_add_u32 v14, v14, 5, v15
v_add_u32 v10, s34, v14
s_add_u32 s33, s32, 160
s_lshr_b32 s34, s33, 7
s_lshl_b32 s34, s34, 13
s_add_u32 s34, s34, 16384
s_bfe_u32 s35, s33, 0x20005
v_xor_b32 v14, s35, v13
v_lshl_add_u32 v14, v14, 5, v15
v_add_u32 v11, s34, v14
s_add_u32 s33, s32, 192
s_lshr_b32 s34, s33, 7
s_lshl_b32 s34, s34, 13
s_add_u32 s34, s34, 16384
s_bfe_u32 s35, s33, 0x20005
v_xor_b32 v14, s35, v13
v_lshl_add_u32 v14, v14, 5, v15
v_add_u32 v12, s34, v14
s_lshl_b32 s32, s30, 12
v_lshlrev_b32 v13, 4, v0
v_add_u32 v13, s32, v13
s_waitcnt vmcnt(0)
v_lshlrev_b32 v104, 16, v60
v_and_b32 v105, 0xffff0000, v60
v_lshlrev_b32 v106, 16, v61
v_and_b32 v107, 0xffff0000, v61
v_lshlrev_b32 v108, 16, v62
v_and_b32 v109, 0xffff0000, v62
v_lshlrev_b32 v110, 16, v63
v_and_b32 v111, 0xffff0000, v63
v_lshlrev_b32 v112, 16, v64
v_and_b32 v113, 0xffff0000, v64
v_lshlrev_b32 v114, 16, v65
v_and_b32 v115, 0xffff0000, v65
v_lshlrev_b32 v116, 16, v66
v_and_b32 v117, 0xffff0000, v66
v_lshlrev_b32 v118, 16, v67
v_and_b32 v119, 0xffff0000, v67
v_lshlrev_b32 v120, 16, v68
v_and_b32 v121, 0xffff0000, v68
v_lshlrev_b32 v122, 16, v69
v_and_b32 v123, 0xffff0000, v69
v_lshlrev_b32 v124, 16, v70
v_and_b32 v125, 0xffff0000, v70
v_lshlrev_b32 v126, 16, v71
v_and_b32 v127, 0xffff0000, v71
v_lshlrev_b32 v128, 16, v72
v_and_b32 v129, 0xffff0000, v72
v_lshlrev_b32 v130, 16, v73
v_and_b32 v131, 0xffff0000, v73
s_cmp_eq_u32 s20, 3
s_cbranch_scc0 T2_21
v_lshlrev_b32 v240, 7, v0
s_mov_b32 s56, s72
s_and_b32 s57, s73, 0xffff
s_mov_b32 s58, 2211840
s_mov_b32 s59, 0x20000
s_mul_i32 s33, s2, 8640
buffer_load_dword v254, v240, s[56:59], s33 offen
s_add_u32 s33, s33, 8192
v_cmp_gt_u32 vcc, 4, v0
s_and_saveexec_b64 s[76:77], vcc
buffer_load_dword v254, v240, s[56:59], s33 offen
s_mov_b64 exec, s[76:77]
s_mul_i32 s33, s2, 3200
v_cmp_gt_u32 vcc, 25, v0
s_and_saveexec_b64 s[76:77], vcc
s_mov_b32 s56, s74
s_and_b32 s57, s75, 0xffff
s_mov_b32 s58, 819200
s_mov_b32 s59, 0x20000
buffer_load_dword v254, v240, s[56:59], s33 offen
s_mov_b32 s56, s78
s_and_b32 s57, s79, 0xffff
s_mov_b32 s58, 819200
s_mov_b32 s59, 0x20000
buffer_load_dword v254, v240, s[56:59], s33 offen
s_mov_b64 exec, s[76:77]
T2_21:
s_lshl_b32 s33, s21, 2
s_bfe_u32 s32, s22, 0x20002
s_add_u32 s33, s33, s32
s_lshl_b32 s33, s33, 7
s_add_u32 s33, s33, 16318464
v_mov_b32 v250, s33
v_and_b32 v249, 3, v0
v_lshl_add_u32 v249, v249, 3, v250
s_cmp_eq_u32 s20, 1
s_cbranch_scc0 XS_22
s_load_dword s90, s[86:87], 0
s_getreg_b32 s32, hwreg(HW_REG_XCC_ID, 0, 4)
s_and_b32 s33, s22, 3
s_lshl_b32 s33, s33, 3
s_waitcnt lgkmcnt(0)
s_add_u32 s90, s90, 1
v_mov_b32 v248, 159744
v_mov_b32 v246, s90
v_mov_b32 v247, s32
ds_write_b32 v248, v246
ds_write_b32 v248, v247 offset:8
v_add_u32 v248, s33, v250
s_mov_b64 s[76:77], exec
s_mov_b64 exec, 1
buffer_store_dwordx2 v[246:247], v248, s[12:15], 0 offen sc1
s_mov_b64 exec, s[76:77]
s_waitcnt lgkmcnt(0)
XS_22:
s_barrier
s_mov_b32 s36, 49152
s_mov_b32 s39, 49152
s_mov_b32 s29, 4294868992
s_mov_b32 s37, 0
ds_read_b64_tr_b16 v[32:33], v6 offset:0
ds_read_b64_tr_b16 v[34:35], v6 offset:512
ds_read_b128 v[16:19], v4 offset:0
ds_read_b64_tr_b16 v[36:37], v7 offset:0
ds_read_b64_tr_b16 v[38:39], v7 offset:512
ds_read_b128 v[20:23], v4 offset:2048
ds_read_b64_tr_b16 v[40:41], v8 offset:0
ds_read_b64_tr_b16 v[42:43], v8 offset:512
ds_read_b128 v[24:27], v4 offset:4096
ds_read_b64_tr_b16 v[44:45], v9 offset:0
ds_read_b64_tr_b16 v[46:47], v9 offset:512
ds_read_b128 v[28:31], v4 offset:6144
ds_read_b64_tr_b16 v[48:49], v10 offset:0
ds_read_b64_tr_b16 v[50:51], v10 offset:512
ds_read_b64_tr_b16 v[52:53], v11 offset:0
ds_read_b64_tr_b16 v[54:55], v11 offset:512
ds_read_b64_tr_b16 v[56:57], v12 offset:0
ds_read_b64_tr_b16 v[58:59], v12 offset:512
s_mov_b32 s38, 9
.p2align 3
s_waitcnt lgkmcnt(0)
s_nop 0
v_mfma_f32_16x16x32_bf16 v[132:135], v[32:35], v[16:19], v[104:107]
ds_read_b64_tr_b16 v[76:77], v6 offset:4096
v_mfma_f32_16x16x32_bf16 v[160:163], v[32:35], v[20:23], v[104:107]
ds_read_b64_tr_b16 v[78:79], v6 offset:4608
v_mfma_f32_16x16x32_bf16 v[188:191], v[32:35], v[24:27], v[104:107]
ds_read_b128 v[60:63], v5 offset:0
v_mfma_f32_16x16x32_bf16 v[216:219], v[32:35], v[28:31], v[104:107]
ds_read_b64_tr_b16 v[80:81], v7 offset:4096
v_mfma_f32_16x16x32_bf16 v[136:139], v[36:39], v[16:19], v[108:111]
ds_read_b64_tr_b16 v[82:83], v7 offset:4608
v_mfma_f32_16x16x32_bf16 v[164:167], v[36:39], v[20:23], v[108:111]
ds_read_b128 v[64:67], v5 offset:2048
v_mfma_f32_16x16x32_bf16 v[192:195], v[36:39], v[24:27], v[108:111]
ds_read_b64_tr_b16 v[84:85], v8 offset:4096
v_mfma_f32_16x16x32_bf16 v[220:223], v[36:39], v[28:31], v[108:111]
ds_read_b64_tr_b16 v[86:87], v8 offset:4608
v_mfma_f32_16x16x32_bf16 v[140:143], v[40:43], v[16:19], v[112:115]
ds_read_b128 v[68:71], v5 offset:4096
v_mfma_f32_16x16x32_bf16 v[168:171], v[40:43], v[20:23], v[112:115]
ds_read_b64_tr_b16 v[88:89], v9 offset:4096
v_mfma_f32_16x16x32_bf16 v[196:199], v[40:43], v[24:27], v[112:115]
ds_read_b64_tr_b16 v[90:91], v9 offset:4608
v_mfma_f32_16x16x32_bf16 v[224:227], v[40:43], v[28:31], v[112:115]
ds_read_b128 v[72:75], v5 offset:6144
v_mfma_f32_16x16x32_bf16 v[144:147], v[44:47], v[16:19], v[116:119]
ds_read_b64_tr_b16 v[92:93], v10 offset:4096
v_mfma_f32_16x16x32_bf16 v[172:175], v[44:47], v[20:23], v[116:119]
ds_read_b64_tr_b16 v[94:95], v10 offset:4608
v_mfma_f32_16x16x32_bf16 v[200:203], v[44:47], v[24:27], v[116:119]
ds_read_b64_tr_b16 v[96:97], v11 offset:4096
v_mfma_f32_16x16x32_bf16 v[228:231], v[44:47], v[28:31], v[116:119]
ds_read_b64_tr_b16 v[98:99], v11 offset:4608
v_mfma_f32_16x16x32_bf16 v[148:151], v[48:51], v[16:19], v[120:123]
ds_read_b64_tr_b16 v[100:101], v12 offset:4096
v_mfma_f32_16x16x32_bf16 v[176:179], v[48:51], v[20:23], v[120:123]
ds_read_b64_tr_b16 v[102:103], v12 offset:4608
v_mfma_f32_16x16x32_bf16 v[204:207], v[48:51], v[24:27], v[120:123]
v_add_u32_e64 v4, s36, v4
v_mfma_f32_16x16x32_bf16 v[232:235], v[48:51], v[28:31], v[120:123]
v_add_u32_e64 v5, s36, v5
v_mfma_f32_16x16x32_bf16 v[152:155], v[52:55], v[16:19], v[124:127]
v_add_u32_e64 v6, s36, v6
v_mfma_f32_16x16x32_bf16 v[180:183], v[52:55], v[20:23], v[124:127]
v_add_u32_e64 v7, s36, v7
v_mfma_f32_16x16x32_bf16 v[208:211], v[52:55], v[24:27], v[124:127]
v_add_u32_e64 v8, s36, v8
v_mfma_f32_16x16x32_bf16 v[236:239], v[52:55], v[28:31], v[124:127]
v_add_u32_e64 v9, s36, v9
v_mfma_f32_16x16x32_bf16 v[156:159], v[56:59], v[16:19], v[128:131]
v_add_u32_e64 v10, s36, v10
v_mfma_f32_16x16x32_bf16 v[184:187], v[56:59], v[20:23], v[128:131]
v_add_u32_e64 v11, s36, v11
v_mfma_f32_16x16x32_bf16 v[212:215], v[56:59], v[24:27], v[128:131]
v_add_u32_e64 v12, s36, v12
v_mfma_f32_16x16x32_bf16 v[240:243], v[56:59], v[28:31], v[128:131]
s_waitcnt lgkmcnt(0)
s_barrier
v_mfma_f32_16x16x32_bf16 v[132:135], v[76:79], v[60:63], v[132:135]
ds_read_b64_tr_b16 v[32:33], v6 offset:0
v_mfma_f32_16x16x32_bf16 v[160:163], v[76:79], v[64:67], v[160:163]
ds_read_b64_tr_b16 v[34:35], v6 offset:512
v_mfma_f32_16x16x32_bf16 v[188:191], v[76:79], v[68:71], v[188:191]
ds_read_b128 v[16:19], v4 offset:0
v_mfma_f32_16x16x32_bf16 v[216:219], v[76:79], v[72:75], v[216:219]
ds_read_b64_tr_b16 v[36:37], v7 offset:0
v_mfma_f32_16x16x32_bf16 v[136:139], v[80:83], v[60:63], v[136:139]
ds_read_b64_tr_b16 v[38:39], v7 offset:512
v_mfma_f32_16x16x32_bf16 v[164:167], v[80:83], v[64:67], v[164:167]
ds_read_b128 v[20:23], v4 offset:2048
v_mfma_f32_16x16x32_bf16 v[192:195], v[80:83], v[68:71], v[192:195]
ds_read_b64_tr_b16 v[40:41], v8 offset:0
v_mfma_f32_16x16x32_bf16 v[220:223], v[80:83], v[72:75], v[220:223]
ds_read_b64_tr_b16 v[42:43], v8 offset:512
v_mfma_f32_16x16x32_bf16 v[140:143], v[84:87], v[60:63], v[140:143]
ds_read_b128 v[24:27], v4 offset:4096
v_mfma_f32_16x16x32_bf16 v[168:171], v[84:87], v[64:67], v[168:171]
ds_read_b64_tr_b16 v[44:45], v9 offset:0
v_mfma_f32_16x16x32_bf16 v[196:199], v[84:87], v[68:71], v[196:199]
ds_read_b64_tr_b16 v[46:47], v9 offset:512
v_mfma_f32_16x16x32_bf16 v[224:227], v[84:87], v[72:75], v[224:227]
ds_read_b128 v[28:31], v4 offset:6144
v_mfma_f32_16x16x32_bf16 v[144:147], v[88:91], v[60:63], v[144:147]
ds_read_b64_tr_b16 v[48:49], v10 offset:0
v_mfma_f32_16x16x32_bf16 v[172:175], v[88:91], v[64:67], v[172:175]
ds_read_b64_tr_b16 v[50:51], v10 offset:512
v_mfma_f32_16x16x32_bf16 v[200:203], v[88:91], v[68:71], v[200:203]
ds_read_b64_tr_b16 v[52:53], v11 offset:0
v_mfma_f32_16x16x32_bf16 v[228:231], v[88:91], v[72:75], v[228:231]
ds_read_b64_tr_b16 v[54:55], v11 offset:512
v_mfma_f32_16x16x32_bf16 v[148:151], v[92:95], v[60:63], v[148:151]
ds_read_b64_tr_b16 v[56:57], v12 offset:0
v_mfma_f32_16x16x32_bf16 v[176:179], v[92:95], v[64:67], v[176:179]
ds_read_b64_tr_b16 v[58:59], v12 offset:512
v_mfma_f32_16x16x32_bf16 v[204:207], v[92:95], v[68:71], v[204:207]
s_add_u32 s37, s37, 1
s_cmp_eq_u32 s37, 2
v_mfma_f32_16x16x32_bf16 v[232:235], v[92:95], v[72:75], v[232:235]
s_cselect_b32 s36, s29, s39
s_cmp_eq_u32 s37, 3
v_mfma_f32_16x16x32_bf16 v[152:155], v[96:99], v[60:63], v[152:155]
s_cselect_b32 s37, 0, s37
s_sub_u32 s38, s38, 1
v_mfma_f32_16x16x32_bf16 v[180:183], v[96:99], v[64:67], v[180:183]
v_mfma_f32_16x16x32_bf16 v[208:211], v[96:99], v[68:71], v[208:211]
v_mfma_f32_16x16x32_bf16 v[236:239], v[96:99], v[72:75], v[236:239]
v_mfma_f32_16x16x32_bf16 v[156:159], v[100:103], v[60:63], v[156:159]
v_mfma_f32_16x16x32_bf16 v[184:187], v[100:103], v[64:67], v[184:187]
v_mfma_f32_16x16x32_bf16 v[212:215], v[100:103], v[68:71], v[212:215]
v_mfma_f32_16x16x32_bf16 v[240:243], v[100:103], v[72:75], v[240:243]
.p2align 6
FFN_LOOP:
s_waitcnt lgkmcnt(0)
s_cmp_eq_u32 s38, 4
s_cbranch_scc0 FFN_NX
s_nop 0
buffer_load_dwordx2 v[252:253], v249, s[12:15], 0 offen sc1
FFN_NX:
v_mfma_f32_16x16x32_bf16 v[132:135], v[32:35], v[16:19], v[132:135]
ds_read_b64_tr_b16 v[76:77], v6 offset:4096
v_mfma_f32_16x16x32_bf16 v[160:163], v[32:35], v[20:23], v[160:163]
ds_read_b64_tr_b16 v[78:79], v6 offset:4608
v_mfma_f32_16x16x32_bf16 v[188:191], v[32:35], v[24:27], v[188:191]
ds_read_b128 v[60:63], v5 offset:0
v_mfma_f32_16x16x32_bf16 v[216:219], v[32:35], v[28:31], v[216:219]
ds_read_b64_tr_b16 v[80:81], v7 offset:4096
v_mfma_f32_16x16x32_bf16 v[136:139], v[36:39], v[16:19], v[136:139]
ds_read_b64_tr_b16 v[82:83], v7 offset:4608
v_mfma_f32_16x16x32_bf16 v[164:167], v[36:39], v[20:23], v[164:167]
ds_read_b128 v[64:67], v5 offset:2048
v_mfma_f32_16x16x32_bf16 v[192:195], v[36:39], v[24:27], v[192:195]
ds_read_b64_tr_b16 v[84:85], v8 offset:4096
v_mfma_f32_16x16x32_bf16 v[220:223], v[36:39], v[28:31], v[220:223]
ds_read_b64_tr_b16 v[86:87], v8 offset:4608
v_mfma_f32_16x16x32_bf16 v[140:143], v[40:43], v[16:19], v[140:143]
ds_read_b128 v[68:71], v5 offset:4096
v_mfma_f32_16x16x32_bf16 v[168:171], v[40:43], v[20:23], v[168:171]
ds_read_b64_tr_b16 v[88:89], v9 offset:4096
v_mfma_f32_16x16x32_bf16 v[196:199], v[40:43], v[24:27], v[196:199]
ds_read_b64_tr_b16 v[90:91], v9 offset:4608
v_mfma_f32_16x16x32_bf16 v[224:227], v[40:43], v[28:31], v[224:227]
ds_read_b128 v[72:75], v5 offset:6144
v_mfma_f32_16x16x32_bf16 v[144:147], v[44:47], v[16:19], v[144:147]
ds_read_b64_tr_b16 v[92:93], v10 offset:4096
v_mfma_f32_16x16x32_bf16 v[172:175], v[44:47], v[20:23], v[172:175]
ds_read_b64_tr_b16 v[94:95], v10 offset:4608
v_mfma_f32_16x16x32_bf16 v[200:203], v[44:47], v[24:27], v[200:203]
ds_read_b64_tr_b16 v[96:97], v11 offset:4096
v_mfma_f32_16x16x32_bf16 v[228:231], v[44:47], v[28:31], v[228:231]
ds_read_b64_tr_b16 v[98:99], v11 offset:4608
v_mfma_f32_16x16x32_bf16 v[148:151], v[48:51], v[16:19], v[148:151]
ds_read_b64_tr_b16 v[100:101], v12 offset:4096
v_mfma_f32_16x16x32_bf16 v[176:179], v[48:51], v[20:23], v[176:179]
ds_read_b64_tr_b16 v[102:103], v12 offset:4608
v_mfma_f32_16x16x32_bf16 v[204:207], v[48:51], v[24:27], v[204:207]
v_add_u32_e64 v4, s36, v4
v_mfma_f32_16x16x32_bf16 v[232:235], v[48:51], v[28:31], v[232:235]
v_add_u32_e64 v5, s36, v5
v_mfma_f32_16x16x32_bf16 v[152:155], v[52:55], v[16:19], v[152:155]
v_add_u32_e64 v6, s36, v6
v_mfma_f32_16x16x32_bf16 v[180:183], v[52:55], v[20:23], v[180:183]
v_add_u32_e64 v7, s36, v7
v_mfma_f32_16x16x32_bf16 v[208:211], v[52:55], v[24:27], v[208:211]
v_add_u32_e64 v8, s36, v8
v_mfma_f32_16x16x32_bf16 v[236:239], v[52:55], v[28:31], v[236:239]
v_add_u32_e64 v9, s36, v9
v_mfma_f32_16x16x32_bf16 v[156:159], v[56:59], v[16:19], v[156:159]
v_add_u32_e64 v10, s36, v10
v_mfma_f32_16x16x32_bf16 v[184:187], v[56:59], v[20:23], v[184:187]
v_add_u32_e64 v11, s36, v11
v_mfma_f32_16x16x32_bf16 v[212:215], v[56:59], v[24:27], v[212:215]
v_add_u32_e64 v12, s36, v12
v_mfma_f32_16x16x32_bf16 v[240:243], v[56:59], v[28:31], v[240:243]
s_waitcnt lgkmcnt(0)
s_barrier
v_mfma_f32_16x16x32_bf16 v[132:135], v[76:79], v[60:63], v[132:135]
ds_read_b64_tr_b16 v[32:33], v6 offset:0
v_mfma_f32_16x16x32_bf16 v[160:163], v[76:79], v[64:67], v[160:163]
ds_read_b64_tr_b16 v[34:35], v6 offset:512
v_mfma_f32_16x16x32_bf16 v[188:191], v[76:79], v[68:71], v[188:191]
ds_read_b128 v[16:19], v4 offset:0
v_mfma_f32_16x16x32_bf16 v[216:219], v[76:79], v[72:75], v[216:219]
ds_read_b64_tr_b16 v[36:37], v7 offset:0
v_mfma_f32_16x16x32_bf16 v[136:139], v[80:83], v[60:63], v[136:139]
ds_read_b64_tr_b16 v[38:39], v7 offset:512
v_mfma_f32_16x16x32_bf16 v[164:167], v[80:83], v[64:67], v[164:167]
ds_read_b128 v[20:23], v4 offset:2048
v_mfma_f32_16x16x32_bf16 v[192:195], v[80:83], v[68:71], v[192:195]
ds_read_b64_tr_b16 v[40:41], v8 offset:0
v_mfma_f32_16x16x32_bf16 v[220:223], v[80:83], v[72:75], v[220:223]
ds_read_b64_tr_b16 v[42:43], v8 offset:512
v_mfma_f32_16x16x32_bf16 v[140:143], v[84:87], v[60:63], v[140:143]
ds_read_b128 v[24:27], v4 offset:4096
v_mfma_f32_16x16x32_bf16 v[168:171], v[84:87], v[64:67], v[168:171]
ds_read_b64_tr_b16 v[44:45], v9 offset:0
v_mfma_f32_16x16x32_bf16 v[196:199], v[84:87], v[68:71], v[196:199]
ds_read_b64_tr_b16 v[46:47], v9 offset:512
v_mfma_f32_16x16x32_bf16 v[224:227], v[84:87], v[72:75], v[224:227]
ds_read_b128 v[28:31], v4 offset:6144
v_mfma_f32_16x16x32_bf16 v[144:147], v[88:91], v[60:63], v[144:147]
ds_read_b64_tr_b16 v[48:49], v10 offset:0
v_mfma_f32_16x16x32_bf16 v[172:175], v[88:91], v[64:67], v[172:175]
ds_read_b64_tr_b16 v[50:51], v10 offset:512
v_mfma_f32_16x16x32_bf16 v[200:203], v[88:91], v[68:71], v[200:203]
ds_read_b64_tr_b16 v[52:53], v11 offset:0
v_mfma_f32_16x16x32_bf16 v[228:231], v[88:91], v[72:75], v[228:231]
ds_read_b64_tr_b16 v[54:55], v11 offset:512
v_mfma_f32_16x16x32_bf16 v[148:151], v[92:95], v[60:63], v[148:151]
ds_read_b64_tr_b16 v[56:57], v12 offset:0
v_mfma_f32_16x16x32_bf16 v[176:179], v[92:95], v[64:67], v[176:179]
ds_read_b64_tr_b16 v[58:59], v12 offset:512
v_mfma_f32_16x16x32_bf16 v[204:207], v[92:95], v[68:71], v[204:207]
s_add_u32 s37, s37, 1
s_cmp_eq_u32 s37, 2
v_mfma_f32_16x16x32_bf16 v[232:235], v[92:95], v[72:75], v[232:235]
s_cselect_b32 s36, s29, s39
s_cmp_eq_u32 s37, 3
v_mfma_f32_16x16x32_bf16 v[152:155], v[96:99], v[60:63], v[152:155]
s_cselect_b32 s37, 0, s37
s_sub_u32 s38, s38, 1
v_mfma_f32_16x16x32_bf16 v[180:183], v[96:99], v[64:67], v[180:183]
v_mfma_f32_16x16x32_bf16 v[208:211], v[96:99], v[68:71], v[208:211]
v_mfma_f32_16x16x32_bf16 v[236:239], v[96:99], v[72:75], v[236:239]
v_mfma_f32_16x16x32_bf16 v[156:159], v[100:103], v[60:63], v[156:159]
v_mfma_f32_16x16x32_bf16 v[184:187], v[100:103], v[64:67], v[184:187]
v_mfma_f32_16x16x32_bf16 v[212:215], v[100:103], v[68:71], v[212:215]
v_mfma_f32_16x16x32_bf16 v[240:243], v[100:103], v[72:75], v[240:243]
s_cmp_lg_u32 s38, 0
s_cbranch_scc1 FFN_LOOP
s_waitcnt lgkmcnt(0)
s_nop 0
v_mfma_f32_16x16x32_bf16 v[132:135], v[32:35], v[16:19], v[132:135]
ds_read_b64_tr_b16 v[76:77], v6 offset:4096
v_mfma_f32_16x16x32_bf16 v[160:163], v[32:35], v[20:23], v[160:163]
ds_read_b64_tr_b16 v[78:79], v6 offset:4608
v_mfma_f32_16x16x32_bf16 v[188:191], v[32:35], v[24:27], v[188:191]
ds_read_b128 v[60:63], v5 offset:0
v_mfma_f32_16x16x32_bf16 v[216:219], v[32:35], v[28:31], v[216:219]
ds_read_b64_tr_b16 v[80:81], v7 offset:4096
v_mfma_f32_16x16x32_bf16 v[136:139], v[36:39], v[16:19], v[136:139]
ds_read_b64_tr_b16 v[82:83], v7 offset:4608
v_mfma_f32_16x16x32_bf16 v[164:167], v[36:39], v[20:23], v[164:167]
ds_read_b128 v[64:67], v5 offset:2048
v_mfma_f32_16x16x32_bf16 v[192:195], v[36:39], v[24:27], v[192:195]
ds_read_b64_tr_b16 v[84:85], v8 offset:4096
v_mfma_f32_16x16x32_bf16 v[220:223], v[36:39], v[28:31], v[220:223]
ds_read_b64_tr_b16 v[86:87], v8 offset:4608
v_mfma_f32_16x16x32_bf16 v[140:143], v[40:43], v[16:19], v[140:143]
ds_read_b128 v[68:71], v5 offset:4096
v_mfma_f32_16x16x32_bf16 v[168:171], v[40:43], v[20:23], v[168:171]
ds_read_b64_tr_b16 v[88:89], v9 offset:4096
v_mfma_f32_16x16x32_bf16 v[196:199], v[40:43], v[24:27], v[196:199]
ds_read_b64_tr_b16 v[90:91], v9 offset:4608
v_mfma_f32_16x16x32_bf16 v[224:227], v[40:43], v[28:31], v[224:227]
ds_read_b128 v[72:75], v5 offset:6144
v_mfma_f32_16x16x32_bf16 v[144:147], v[44:47], v[16:19], v[144:147]
ds_read_b64_tr_b16 v[92:93], v10 offset:4096
v_mfma_f32_16x16x32_bf16 v[172:175], v[44:47], v[20:23], v[172:175]
ds_read_b64_tr_b16 v[94:95], v10 offset:4608
v_mfma_f32_16x16x32_bf16 v[200:203], v[44:47], v[24:27], v[200:203]
ds_read_b64_tr_b16 v[96:97], v11 offset:4096
v_mfma_f32_16x16x32_bf16 v[228:231], v[44:47], v[28:31], v[228:231]
ds_read_b64_tr_b16 v[98:99], v11 offset:4608
v_mfma_f32_16x16x32_bf16 v[148:151], v[48:51], v[16:19], v[148:151]
ds_read_b64_tr_b16 v[100:101], v12 offset:4096
v_mfma_f32_16x16x32_bf16 v[176:179], v[48:51], v[20:23], v[176:179]
ds_read_b64_tr_b16 v[102:103], v12 offset:4608
v_mfma_f32_16x16x32_bf16 v[204:207], v[48:51], v[24:27], v[204:207]
v_mfma_f32_16x16x32_bf16 v[232:235], v[48:51], v[28:31], v[232:235]
v_mfma_f32_16x16x32_bf16 v[152:155], v[52:55], v[16:19], v[152:155]
v_mfma_f32_16x16x32_bf16 v[180:183], v[52:55], v[20:23], v[180:183]
v_mfma_f32_16x16x32_bf16 v[208:211], v[52:55], v[24:27], v[208:211]
v_mfma_f32_16x16x32_bf16 v[236:239], v[52:55], v[28:31], v[236:239]
v_mfma_f32_16x16x32_bf16 v[156:159], v[56:59], v[16:19], v[156:159]
v_mfma_f32_16x16x32_bf16 v[184:187], v[56:59], v[20:23], v[184:187]
v_mfma_f32_16x16x32_bf16 v[212:215], v[56:59], v[24:27], v[212:215]
v_mfma_f32_16x16x32_bf16 v[240:243], v[56:59], v[28:31], v[240:243]
s_waitcnt lgkmcnt(0)
s_nop 0
v_mfma_f32_16x16x32_bf16 v[132:135], v[76:79], v[60:63], v[132:135]
v_mfma_f32_16x16x32_bf16 v[160:163], v[76:79], v[64:67], v[160:163]
v_mfma_f32_16x16x32_bf16 v[188:191], v[76:79], v[68:71], v[188:191]
v_mfma_f32_16x16x32_bf16 v[216:219], v[76:79], v[72:75], v[216:219]
v_mfma_f32_16x16x32_bf16 v[136:139], v[80:83], v[60:63], v[136:139]
v_mfma_f32_16x16x32_bf16 v[164:167], v[80:83], v[64:67], v[164:167]
v_mfma_f32_16x16x32_bf16 v[192:195], v[80:83], v[68:71], v[192:195]
v_mfma_f32_16x16x32_bf16 v[220:223], v[80:83], v[72:75], v[220:223]
v_mfma_f32_16x16x32_bf16 v[140:143], v[84:87], v[60:63], v[140:143]
v_mfma_f32_16x16x32_bf16 v[168:171], v[84:87], v[64:67], v[168:171]
v_mfma_f32_16x16x32_bf16 v[196:199], v[84:87], v[68:71], v[196:199]
v_mfma_f32_16x16x32_bf16 v[224:227], v[84:87], v[72:75], v[224:227]
v_mfma_f32_16x16x32_bf16 v[144:147], v[88:91], v[60:63], v[144:147]
v_mfma_f32_16x16x32_bf16 v[172:175], v[88:91], v[64:67], v[172:175]
v_mfma_f32_16x16x32_bf16 v[200:203], v[88:91], v[68:71], v[200:203]
v_mfma_f32_16x16x32_bf16 v[228:231], v[88:91], v[72:75], v[228:231]
v_mfma_f32_16x16x32_bf16 v[148:151], v[92:95], v[60:63], v[148:151]
v_mfma_f32_16x16x32_bf16 v[176:179], v[92:95], v[64:67], v[176:179]
v_mfma_f32_16x16x32_bf16 v[204:207], v[92:95], v[68:71], v[204:207]
v_mfma_f32_16x16x32_bf16 v[232:235], v[92:95], v[72:75], v[232:235]
v_mfma_f32_16x16x32_bf16 v[152:155], v[96:99], v[60:63], v[152:155]
v_mfma_f32_16x16x32_bf16 v[180:183], v[96:99], v[64:67], v[180:183]
v_mfma_f32_16x16x32_bf16 v[208:211], v[96:99], v[68:71], v[208:211]
v_mfma_f32_16x16x32_bf16 v[236:239], v[96:99], v[72:75], v[236:239]
v_mfma_f32_16x16x32_bf16 v[156:159], v[100:103], v[60:63], v[156:159]
v_mfma_f32_16x16x32_bf16 v[184:187], v[100:103], v[64:67], v[184:187]
v_mfma_f32_16x16x32_bf16 v[212:215], v[100:103], v[68:71], v[212:215]
v_mfma_f32_16x16x32_bf16 v[240:243], v[100:103], v[72:75], v[240:243]
v_mov_b32 v248, 159744
ds_read_b32 v251, v248
ds_read_b32 v250, v248 offset:8
s_waitcnt lgkmcnt(0)
v_readfirstlane_b32 s90, v251
v_readfirstlane_b32 s32, v250
s_mov_b32 s36, 0
XC_23_T:
s_waitcnt vmcnt(0)
v_cmp_eq_u32 vcc, s90, v252
s_nop 1
s_cmp_eq_u64 vcc, -1
s_cbranch_scc1 XC_23_OK
s_add_u32 s36, s36, 1
s_cmp_lt_u32 s36, 0x4000
s_cbranch_scc0 XC_23_OK
buffer_load_dwordx2 v[252:253], v249, s[12:15], 0 offen sc1
s_branch XC_23_T
XC_23_OK:
v_cmp_eq_u32 vcc, s32, v253
s_nop 1
s_cmp_eq_u64 vcc, -1
s_cselect_b32 s91, 1, 0
s_cmp_eq_u32 s20, 0
s_cbranch_scc0 XC_23_E
v_mov_b32 v251, s91
ds_write_b32 v248, v251 offset:4
s_waitcnt lgkmcnt(0)
XC_23_E:
s_mul_i32 s38, s21, 54
s_lshr_b32 s34, s24, 5
s_add_u32 s38, s38, s34
s_lshl_b32 s38, s38, 13
s_mov_b32 s27, s24
s_and_b32 s23, s22, 3
s_lshr_b32 s24, s22, 2
s_cmp_eq_u32 s24, 2
s_cselect_b32 s25, 14, 13
v_lshrrev_b32 v250, 4, v0
v_and_b32 v251, 15, v0
v_bfe_u32 v252, v0, 2, 2
v_and_b32 v253, 3, v0
s_lshl_b32 s32, s30, 12
v_lshlrev_b32 v4, 4, v0
v_add_u32 v4, s32, v4
v_lshl_add_u32 v248, v250, 2, v252
v_lshrrev_b32 v249, 1, v248
v_and_b32 v249, 3, v249
v_lshlrev_b32 v248, 7, v248
v_lshl_add_u32 v248, v253, 3, v248
s_and_b32 s35, s23, 1
s_lshl_b32 s35, s35, 6
s_mul_i32 s32, s31, 160
s_add_u32 s35, s35, s32
s_add_u32 s33, s35, 0
s_lshr_b32 s34, s33, 7
s_lshl_b32 s34, s34, 13
s_add_u32 s34, s34, 16384
s_bfe_u32 s33, s33, 0x20005
v_xor_b32 v253, s33, v249
v_lshl_add_u32 v253, v253, 5, v248
v_add_u32 v8, s34, v253
s_add_u32 s33, s35, 32
s_lshr_b32 s34, s33, 7
s_lshl_b32 s34, s34, 13
s_add_u32 s34, s34, 16384
s_bfe_u32 s33, s33, 0x20005
v_xor_b32 v253, s33, v249
v_lshl_add_u32 v253, v253, 5, v248
v_add_u32 v9, s34, v253
s_add_u32 s33, s35, 64
s_lshr_b32 s34, s33, 7
s_lshl_b32 s34, s34, 13
s_add_u32 s34, s34, 16384
s_bfe_u32 s33, s33, 0x20005
v_xor_b32 v253, s33, v249
v_lshl_add_u32 v253, v253, 5, v248
v_add_u32 v10, s34, v253
s_add_u32 s33, s35, 96
s_lshr_b32 s34, s33, 7
s_lshl_b32 s34, s34, 13
s_add_u32 s34, s34, 16384
s_bfe_u32 s33, s33, 0x20005
v_xor_b32 v253, s33, v249
v_lshl_add_u32 v253, v253, 5, v248
v_add_u32 v11, s34, v253
s_add_u32 s33, s35, 128
s_lshr_b32 s34, s33, 7
s_lshl_b32 s34, s34, 13
s_add_u32 s34, s34, 16384
s_bfe_u32 s33, s33, 0x20005
v_xor_b32 v253, s33, v249
v_lshl_add_u32 v253, v253, 5, v248
v_add_u32 v12, s34, v253
s_lshl_b32 s32, s21, 7
s_lshl_b32 s33, s30, 6
s_add_u32 s32, s32, s33
s_lshl_b32 s33, s24, 4
s_add_u32 s32, s32, s33
v_add_u32 v248, s32, v251
s_mul_i32 s33, s23, 160
s_mul_i32 s34, s31, 80
s_add_u32 s33, s33, s34
v_lshl_add_u32 v249, v250, 2, s33
v_mul_u32_u24 v247, 640, v248
v_add_u32 v247, v247, v249
v_lshlrev_b32 v246, 2, v247
v_lshlrev_b32 v247, 1, v247
v_lshlrev_b32 v248, 1, v249
v_lshlrev_b32 v249, 2, v251
s_lshl_b32 s32, s21, 2
s_add_u32 s32, s32, s24
s_lshl_b32 s32, s32, 9
s_add_u32 s32, s32, 14680064
s_lshl_b32 s33, s30, 8
s_add_u32 s46, s32, s33
s_mov_b32 s16, s48
s_and_b32 s17, s49, 0xffff
s_mov_b32 s18, 5242880
s_mov_b32 s19, 0x20000
s_mov_b32 s60, s50
s_and_b32 s61, s51, 0xffff
s_mov_b32 s62, 1280
s_mov_b32 s63, 0x20000
s_mov_b32 s64, s52
s_and_b32 s65, s53, 0xffff
s_mov_b32 s66, 1280
s_mov_b32 s67, 0x20000
s_mov_b32 s33, s38
s_barrier
s_lshl_b32 s32, s91, 1
s_or_b32 s32, s32, s31
s_cmp_eq_u32 s32, 2
s_cbranch_scc1 FE_F0
s_cmp_eq_u32 s32, 3
s_cbranch_scc1 FE_F1
s_cmp_eq_u32 s32, 0
s_cbranch_scc1 FE_S0
s_add_u32 s34, s33, 32768
v_max_f32 v136, 0, v136
v_max_f32 v137, 0, v137
v_max_f32 v138, 0, v138
v_max_f32 v139, 0, v139
v_pk_mul_f32 v[136:137], v[136:137], v[136:137]
v_pk_mul_f32 v[138:139], v[138:139], v[138:139]
v_cvt_pk_bf16_f32 v16, v136, v137
v_cvt_pk_bf16_f32 v17, v138, v139
v_max_f32 v140, 0, v140
v_max_f32 v141, 0, v141
v_max_f32 v142, 0, v142
v_max_f32 v143, 0, v143
v_pk_mul_f32 v[140:141], v[140:141], v[140:141]
v_pk_mul_f32 v[142:143], v[142:143], v[142:143]
v_cvt_pk_bf16_f32 v18, v140, v141
v_cvt_pk_bf16_f32 v19, v142, v143
buffer_store_dwordx4 v[16:19], v13, s[12:15], s34 offen offset:0 sc1
v_max_f32 v164, 0, v164
v_max_f32 v165, 0, v165
v_max_f32 v166, 0, v166
v_max_f32 v167, 0, v167
v_pk_mul_f32 v[164:165], v[164:165], v[164:165]
v_pk_mul_f32 v[166:167], v[166:167], v[166:167]
v_cvt_pk_bf16_f32 v20, v164, v165
v_cvt_pk_bf16_f32 v21, v166, v167
v_max_f32 v168, 0, v168
v_max_f32 v169, 0, v169
v_max_f32 v170, 0, v170
v_max_f32 v171, 0, v171
v_pk_mul_f32 v[168:169], v[168:169], v[168:169]
v_pk_mul_f32 v[170:171], v[170:171], v[170:171]
v_cvt_pk_bf16_f32 v22, v168, v169
v_cvt_pk_bf16_f32 v23, v170, v171
buffer_store_dwordx4 v[20:23], v13, s[12:15], s34 offen offset:1024 sc1
v_max_f32 v192, 0, v192
v_max_f32 v193, 0, v193
v_max_f32 v194, 0, v194
v_max_f32 v195, 0, v195
v_pk_mul_f32 v[192:193], v[192:193], v[192:193]
v_pk_mul_f32 v[194:195], v[194:195], v[194:195]
v_cvt_pk_bf16_f32 v24, v192, v193
v_cvt_pk_bf16_f32 v25, v194, v195
v_max_f32 v196, 0, v196
v_max_f32 v197, 0, v197
v_max_f32 v198, 0, v198
v_max_f32 v199, 0, v199
v_pk_mul_f32 v[196:197], v[196:197], v[196:197]
v_pk_mul_f32 v[198:199], v[198:199], v[198:199]
v_cvt_pk_bf16_f32 v26, v196, v197
v_cvt_pk_bf16_f32 v27, v198, v199
buffer_store_dwordx4 v[24:27], v13, s[12:15], s34 offen offset:2048 sc1
v_max_f32 v220, 0, v220
v_max_f32 v221, 0, v221
v_max_f32 v222, 0, v222
v_max_f32 v223, 0, v223
v_pk_mul_f32 v[220:221], v[220:221], v[220:221]
v_pk_mul_f32 v[222:223], v[222:223], v[222:223]
v_cvt_pk_bf16_f32 v28, v220, v221
v_cvt_pk_bf16_f32 v29, v222, v223
v_max_f32 v224, 0, v224
v_max_f32 v225, 0, v225
v_max_f32 v226, 0, v226
v_max_f32 v227, 0, v227
v_pk_mul_f32 v[224:225], v[224:225], v[224:225]
v_pk_mul_f32 v[226:227], v[226:227], v[226:227]
v_cvt_pk_bf16_f32 v30, v224, v225
v_cvt_pk_bf16_f32 v31, v226, v227
buffer_store_dwordx4 v[28:31], v13, s[12:15], s34 offen offset:3072 sc1
s_add_u32 s34, s33, 40960
v_max_f32 v144, 0, v144
v_max_f32 v145, 0, v145
v_max_f32 v146, 0, v146
v_max_f32 v147, 0, v147
v_pk_mul_f32 v[144:145], v[144:145], v[144:145]
v_pk_mul_f32 v[146:147], v[146:147], v[146:147]
v_cvt_pk_bf16_f32 v32, v144, v145
v_cvt_pk_bf16_f32 v33, v146, v147
v_max_f32 v148, 0, v148
v_max_f32 v149, 0, v149
v_max_f32 v150, 0, v150
v_max_f32 v151, 0, v151
v_pk_mul_f32 v[148:149], v[148:149], v[148:149]
v_pk_mul_f32 v[150:151], v[150:151], v[150:151]
v_cvt_pk_bf16_f32 v34, v148, v149
v_cvt_pk_bf16_f32 v35, v150, v151
buffer_store_dwordx4 v[32:35], v13, s[12:15], s34 offen offset:0 sc1
v_max_f32 v172, 0, v172
v_max_f32 v173, 0, v173
v_max_f32 v174, 0, v174
v_max_f32 v175, 0, v175
v_pk_mul_f32 v[172:173], v[172:173], v[172:173]
v_pk_mul_f32 v[174:175], v[174:175], v[174:175]
v_cvt_pk_bf16_f32 v36, v172, v173
v_cvt_pk_bf16_f32 v37, v174, v175
v_max_f32 v176, 0, v176
v_max_f32 v177, 0, v177
v_max_f32 v178, 0, v178
v_max_f32 v179, 0, v179
v_pk_mul_f32 v[176:177], v[176:177], v[176:177]
v_pk_mul_f32 v[178:179], v[178:179], v[178:179]
v_cvt_pk_bf16_f32 v38, v176, v177
v_cvt_pk_bf16_f32 v39, v178, v179
buffer_store_dwordx4 v[36:39], v13, s[12:15], s34 offen offset:1024 sc1
v_max_f32 v200, 0, v200
v_max_f32 v201, 0, v201
v_max_f32 v202, 0, v202
v_max_f32 v203, 0, v203
v_pk_mul_f32 v[200:201], v[200:201], v[200:201]
v_pk_mul_f32 v[202:203], v[202:203], v[202:203]
v_cvt_pk_bf16_f32 v40, v200, v201
v_cvt_pk_bf16_f32 v41, v202, v203
v_max_f32 v204, 0, v204
v_max_f32 v205, 0, v205
v_max_f32 v206, 0, v206
v_max_f32 v207, 0, v207
v_pk_mul_f32 v[204:205], v[204:205], v[204:205]
v_pk_mul_f32 v[206:207], v[206:207], v[206:207]
v_cvt_pk_bf16_f32 v42, v204, v205
v_cvt_pk_bf16_f32 v43, v206, v207
buffer_store_dwordx4 v[40:43], v13, s[12:15], s34 offen offset:2048 sc1
v_max_f32 v228, 0, v228
v_max_f32 v229, 0, v229
v_max_f32 v230, 0, v230
v_max_f32 v231, 0, v231
v_pk_mul_f32 v[228:229], v[228:229], v[228:229]
v_pk_mul_f32 v[230:231], v[230:231], v[230:231]
v_cvt_pk_bf16_f32 v44, v228, v229
v_cvt_pk_bf16_f32 v45, v230, v231
v_max_f32 v232, 0, v232
v_max_f32 v233, 0, v233
v_max_f32 v234, 0, v234
v_max_f32 v235, 0, v235
v_pk_mul_f32 v[232:233], v[232:233], v[232:233]
v_pk_mul_f32 v[234:235], v[234:235], v[234:235]
v_cvt_pk_bf16_f32 v46, v232, v233
v_cvt_pk_bf16_f32 v47, v234, v235
buffer_store_dwordx4 v[44:47], v13, s[12:15], s34 offen offset:3072 sc1
s_add_u32 s34, s33, 49152
v_max_f32 v152, 0, v152
v_max_f32 v153, 0, v153
v_max_f32 v154, 0, v154
v_max_f32 v155, 0, v155
v_pk_mul_f32 v[152:153], v[152:153], v[152:153]
v_pk_mul_f32 v[154:155], v[154:155], v[154:155]
v_cvt_pk_bf16_f32 v16, v152, v153
v_cvt_pk_bf16_f32 v17, v154, v155
v_max_f32 v156, 0, v156
v_max_f32 v157, 0, v157
v_max_f32 v158, 0, v158
v_max_f32 v159, 0, v159
v_pk_mul_f32 v[156:157], v[156:157], v[156:157]
v_pk_mul_f32 v[158:159], v[158:159], v[158:159]
v_cvt_pk_bf16_f32 v18, v156, v157
v_cvt_pk_bf16_f32 v19, v158, v159
buffer_store_dwordx4 v[16:19], v13, s[12:15], s34 offen offset:0 sc1
v_max_f32 v180, 0, v180
v_max_f32 v181, 0, v181
v_max_f32 v182, 0, v182
v_max_f32 v183, 0, v183
v_pk_mul_f32 v[180:181], v[180:181], v[180:181]
v_pk_mul_f32 v[182:183], v[182:183], v[182:183]
v_cvt_pk_bf16_f32 v20, v180, v181
v_cvt_pk_bf16_f32 v21, v182, v183
v_max_f32 v184, 0, v184
v_max_f32 v185, 0, v185
v_max_f32 v186, 0, v186
v_max_f32 v187, 0, v187
v_pk_mul_f32 v[184:185], v[184:185], v[184:185]
v_pk_mul_f32 v[186:187], v[186:187], v[186:187]
v_cvt_pk_bf16_f32 v22, v184, v185
v_cvt_pk_bf16_f32 v23, v186, v187
buffer_store_dwordx4 v[20:23], v13, s[12:15], s34 offen offset:1024 sc1
v_max_f32 v208, 0, v208
v_max_f32 v209, 0, v209
v_max_f32 v210, 0, v210
v_max_f32 v211, 0, v211
v_pk_mul_f32 v[208:209], v[208:209], v[208:209]
v_pk_mul_f32 v[210:211], v[210:211], v[210:211]
v_cvt_pk_bf16_f32 v24, v208, v209
v_cvt_pk_bf16_f32 v25, v210, v211
v_max_f32 v212, 0, v212
v_max_f32 v213, 0, v213
v_max_f32 v214, 0, v214
v_max_f32 v215, 0, v215
v_pk_mul_f32 v[212:213], v[212:213], v[212:213]
v_pk_mul_f32 v[214:215], v[214:215], v[214:215]
v_cvt_pk_bf16_f32 v26, v212, v213
v_cvt_pk_bf16_f32 v27, v214, v215
buffer_store_dwordx4 v[24:27], v13, s[12:15], s34 offen offset:2048 sc1
v_max_f32 v236, 0, v236
v_max_f32 v237, 0, v237
v_max_f32 v238, 0, v238
v_max_f32 v239, 0, v239
v_pk_mul_f32 v[236:237], v[236:237], v[236:237]
v_pk_mul_f32 v[238:239], v[238:239], v[238:239]
v_cvt_pk_bf16_f32 v28, v236, v237
v_cvt_pk_bf16_f32 v29, v238, v239
v_max_f32 v240, 0, v240
v_max_f32 v241, 0, v241
v_max_f32 v242, 0, v242
v_max_f32 v243, 0, v243
v_pk_mul_f32 v[240:241], v[240:241], v[240:241]
v_pk_mul_f32 v[242:243], v[242:243], v[242:243]
v_cvt_pk_bf16_f32 v30, v240, v241
v_cvt_pk_bf16_f32 v31, v242, v243
buffer_store_dwordx4 v[28:31], v13, s[12:15], s34 offen offset:3072 sc1
s_add_u32 s34, s33, 24576
v_max_f32 v132, 0, v132
v_max_f32 v133, 0, v133
v_max_f32 v134, 0, v134
v_max_f32 v135, 0, v135
v_pk_mul_f32 v[132:133], v[132:133], v[132:133]
v_pk_mul_f32 v[134:135], v[134:135], v[134:135]
v_cvt_pk_bf16_f32 v32, v132, v133
v_cvt_pk_bf16_f32 v33, v134, v135
buffer_store_dwordx2 v[32:33], v13, s[12:15], s34 offen offset:8 sc1
v_max_f32 v160, 0, v160
v_max_f32 v161, 0, v161
v_max_f32 v162, 0, v162
v_max_f32 v163, 0, v163
v_pk_mul_f32 v[160:161], v[160:161], v[160:161]
v_pk_mul_f32 v[162:163], v[162:163], v[162:163]
v_cvt_pk_bf16_f32 v36, v160, v161
v_cvt_pk_bf16_f32 v37, v162, v163
buffer_store_dwordx2 v[36:37], v13, s[12:15], s34 offen offset:1032 sc1
v_max_f32 v188, 0, v188
v_max_f32 v189, 0, v189
v_max_f32 v190, 0, v190
v_max_f32 v191, 0, v191
v_pk_mul_f32 v[188:189], v[188:189], v[188:189]
v_pk_mul_f32 v[190:191], v[190:191], v[190:191]
v_cvt_pk_bf16_f32 v40, v188, v189
v_cvt_pk_bf16_f32 v41, v190, v191
buffer_store_dwordx2 v[40:41], v13, s[12:15], s34 offen offset:2056 sc1
v_max_f32 v216, 0, v216
v_max_f32 v217, 0, v217
v_max_f32 v218, 0, v218
v_max_f32 v219, 0, v219
v_pk_mul_f32 v[216:217], v[216:217], v[216:217]
v_pk_mul_f32 v[218:219], v[218:219], v[218:219]
v_cvt_pk_bf16_f32 v44, v216, v217
v_cvt_pk_bf16_f32 v45, v218, v219
buffer_store_dwordx2 v[44:45], v13, s[12:15], s34 offen offset:3080 sc1
s_branch FE_END
FE_S0:
s_add_u32 s34, s33, 0
v_max_f32 v132, 0, v132
v_max_f32 v133, 0, v133
v_max_f32 v134, 0, v134
v_max_f32 v135, 0, v135
v_pk_mul_f32 v[132:133], v[132:133], v[132:133]
v_pk_mul_f32 v[134:135], v[134:135], v[134:135]
v_cvt_pk_bf16_f32 v16, v132, v133
v_cvt_pk_bf16_f32 v17, v134, v135
v_max_f32 v136, 0, v136
v_max_f32 v137, 0, v137
v_max_f32 v138, 0, v138
v_max_f32 v139, 0, v139
v_pk_mul_f32 v[136:137], v[136:137], v[136:137]
v_pk_mul_f32 v[138:139], v[138:139], v[138:139]
v_cvt_pk_bf16_f32 v18, v136, v137
v_cvt_pk_bf16_f32 v19, v138, v139
buffer_store_dwordx4 v[16:19], v13, s[12:15], s34 offen offset:0 sc1
v_max_f32 v160, 0, v160
v_max_f32 v161, 0, v161
v_max_f32 v162, 0, v162
v_max_f32 v163, 0, v163
v_pk_mul_f32 v[160:161], v[160:161], v[160:161]
v_pk_mul_f32 v[162:163], v[162:163], v[162:163]
v_cvt_pk_bf16_f32 v20, v160, v161
v_cvt_pk_bf16_f32 v21, v162, v163
v_max_f32 v164, 0, v164
v_max_f32 v165, 0, v165
v_max_f32 v166, 0, v166
v_max_f32 v167, 0, v167
v_pk_mul_f32 v[164:165], v[164:165], v[164:165]
v_pk_mul_f32 v[166:167], v[166:167], v[166:167]
v_cvt_pk_bf16_f32 v22, v164, v165
v_cvt_pk_bf16_f32 v23, v166, v167
buffer_store_dwordx4 v[20:23], v13, s[12:15], s34 offen offset:1024 sc1
v_max_f32 v188, 0, v188
v_max_f32 v189, 0, v189
v_max_f32 v190, 0, v190
v_max_f32 v191, 0, v191
v_pk_mul_f32 v[188:189], v[188:189], v[188:189]
v_pk_mul_f32 v[190:191], v[190:191], v[190:191]
v_cvt_pk_bf16_f32 v24, v188, v189
v_cvt_pk_bf16_f32 v25, v190, v191
v_max_f32 v192, 0, v192
v_max_f32 v193, 0, v193
v_max_f32 v194, 0, v194
v_max_f32 v195, 0, v195
v_pk_mul_f32 v[192:193], v[192:193], v[192:193]
v_pk_mul_f32 v[194:195], v[194:195], v[194:195]
v_cvt_pk_bf16_f32 v26, v192, v193
v_cvt_pk_bf16_f32 v27, v194, v195
buffer_store_dwordx4 v[24:27], v13, s[12:15], s34 offen offset:2048 sc1
v_max_f32 v216, 0, v216
v_max_f32 v217, 0, v217
v_max_f32 v218, 0, v218
v_max_f32 v219, 0, v219
v_pk_mul_f32 v[216:217], v[216:217], v[216:217]
v_pk_mul_f32 v[218:219], v[218:219], v[218:219]
v_cvt_pk_bf16_f32 v28, v216, v217
v_cvt_pk_bf16_f32 v29, v218, v219
v_max_f32 v220, 0, v220
v_max_f32 v221, 0, v221
v_max_f32 v222, 0, v222
v_max_f32 v223, 0, v223
v_pk_mul_f32 v[220:221], v[220:221], v[220:221]
v_pk_mul_f32 v[222:223], v[222:223], v[222:223]
v_cvt_pk_bf16_f32 v30, v220, v221
v_cvt_pk_bf16_f32 v31, v222, v223
buffer_store_dwordx4 v[28:31], v13, s[12:15], s34 offen offset:3072 sc1
s_add_u32 s34, s33, 8192
v_max_f32 v140, 0, v140
v_max_f32 v141, 0, v141
v_max_f32 v142, 0, v142
v_max_f32 v143, 0, v143
v_pk_mul_f32 v[140:141], v[140:141], v[140:141]
v_pk_mul_f32 v[142:143], v[142:143], v[142:143]
v_cvt_pk_bf16_f32 v32, v140, v141
v_cvt_pk_bf16_f32 v33, v142, v143
v_max_f32 v144, 0, v144
v_max_f32 v145, 0, v145
v_max_f32 v146, 0, v146
v_max_f32 v147, 0, v147
v_pk_mul_f32 v[144:145], v[144:145], v[144:145]
v_pk_mul_f32 v[146:147], v[146:147], v[146:147]
v_cvt_pk_bf16_f32 v34, v144, v145
v_cvt_pk_bf16_f32 v35, v146, v147
buffer_store_dwordx4 v[32:35], v13, s[12:15], s34 offen offset:0 sc1
v_max_f32 v168, 0, v168
v_max_f32 v169, 0, v169
v_max_f32 v170, 0, v170
v_max_f32 v171, 0, v171
v_pk_mul_f32 v[168:169], v[168:169], v[168:169]
v_pk_mul_f32 v[170:171], v[170:171], v[170:171]
v_cvt_pk_bf16_f32 v36, v168, v169
v_cvt_pk_bf16_f32 v37, v170, v171
v_max_f32 v172, 0, v172
v_max_f32 v173, 0, v173
v_max_f32 v174, 0, v174
v_max_f32 v175, 0, v175
v_pk_mul_f32 v[172:173], v[172:173], v[172:173]
v_pk_mul_f32 v[174:175], v[174:175], v[174:175]
v_cvt_pk_bf16_f32 v38, v172, v173
v_cvt_pk_bf16_f32 v39, v174, v175
buffer_store_dwordx4 v[36:39], v13, s[12:15], s34 offen offset:1024 sc1
v_max_f32 v196, 0, v196
v_max_f32 v197, 0, v197
v_max_f32 v198, 0, v198
v_max_f32 v199, 0, v199
v_pk_mul_f32 v[196:197], v[196:197], v[196:197]
v_pk_mul_f32 v[198:199], v[198:199], v[198:199]
v_cvt_pk_bf16_f32 v40, v196, v197
v_cvt_pk_bf16_f32 v41, v198, v199
v_max_f32 v200, 0, v200
v_max_f32 v201, 0, v201
v_max_f32 v202, 0, v202
v_max_f32 v203, 0, v203
v_pk_mul_f32 v[200:201], v[200:201], v[200:201]
v_pk_mul_f32 v[202:203], v[202:203], v[202:203]
v_cvt_pk_bf16_f32 v42, v200, v201
v_cvt_pk_bf16_f32 v43, v202, v203
buffer_store_dwordx4 v[40:43], v13, s[12:15], s34 offen offset:2048 sc1
v_max_f32 v224, 0, v224
v_max_f32 v225, 0, v225
v_max_f32 v226, 0, v226
v_max_f32 v227, 0, v227
v_pk_mul_f32 v[224:225], v[224:225], v[224:225]
v_pk_mul_f32 v[226:227], v[226:227], v[226:227]
v_cvt_pk_bf16_f32 v44, v224, v225
v_cvt_pk_bf16_f32 v45, v226, v227
v_max_f32 v228, 0, v228
v_max_f32 v229, 0, v229
v_max_f32 v230, 0, v230
v_max_f32 v231, 0, v231
v_pk_mul_f32 v[228:229], v[228:229], v[228:229]
v_pk_mul_f32 v[230:231], v[230:231], v[230:231]
v_cvt_pk_bf16_f32 v46, v228, v229
v_cvt_pk_bf16_f32 v47, v230, v231
buffer_store_dwordx4 v[44:47], v13, s[12:15], s34 offen offset:3072 sc1
s_add_u32 s34, s33, 16384
v_max_f32 v148, 0, v148
v_max_f32 v149, 0, v149
v_max_f32 v150, 0, v150
v_max_f32 v151, 0, v151
v_pk_mul_f32 v[148:149], v[148:149], v[148:149]
v_pk_mul_f32 v[150:151], v[150:151], v[150:151]
v_cvt_pk_bf16_f32 v16, v148, v149
v_cvt_pk_bf16_f32 v17, v150, v151
v_max_f32 v152, 0, v152
v_max_f32 v153, 0, v153
v_max_f32 v154, 0, v154
v_max_f32 v155, 0, v155
v_pk_mul_f32 v[152:153], v[152:153], v[152:153]
v_pk_mul_f32 v[154:155], v[154:155], v[154:155]
v_cvt_pk_bf16_f32 v18, v152, v153
v_cvt_pk_bf16_f32 v19, v154, v155
buffer_store_dwordx4 v[16:19], v13, s[12:15], s34 offen offset:0 sc1
v_max_f32 v176, 0, v176
v_max_f32 v177, 0, v177
v_max_f32 v178, 0, v178
v_max_f32 v179, 0, v179
v_pk_mul_f32 v[176:177], v[176:177], v[176:177]
v_pk_mul_f32 v[178:179], v[178:179], v[178:179]
v_cvt_pk_bf16_f32 v20, v176, v177
v_cvt_pk_bf16_f32 v21, v178, v179
v_max_f32 v180, 0, v180
v_max_f32 v181, 0, v181
v_max_f32 v182, 0, v182
v_max_f32 v183, 0, v183
v_pk_mul_f32 v[180:181], v[180:181], v[180:181]
v_pk_mul_f32 v[182:183], v[182:183], v[182:183]
v_cvt_pk_bf16_f32 v22, v180, v181
v_cvt_pk_bf16_f32 v23, v182, v183
buffer_store_dwordx4 v[20:23], v13, s[12:15], s34 offen offset:1024 sc1
v_max_f32 v204, 0, v204
v_max_f32 v205, 0, v205
v_max_f32 v206, 0, v206
v_max_f32 v207, 0, v207
v_pk_mul_f32 v[204:205], v[204:205], v[204:205]
v_pk_mul_f32 v[206:207], v[206:207], v[206:207]
v_cvt_pk_bf16_f32 v24, v204, v205
v_cvt_pk_bf16_f32 v25, v206, v207
v_max_f32 v208, 0, v208
v_max_f32 v209, 0, v209
v_max_f32 v210, 0, v210
v_max_f32 v211, 0, v211
v_pk_mul_f32 v[208:209], v[208:209], v[208:209]
v_pk_mul_f32 v[210:211], v[210:211], v[210:211]
v_cvt_pk_bf16_f32 v26, v208, v209
v_cvt_pk_bf16_f32 v27, v210, v211
buffer_store_dwordx4 v[24:27], v13, s[12:15], s34 offen offset:2048 sc1
v_max_f32 v232, 0, v232
v_max_f32 v233, 0, v233
v_max_f32 v234, 0, v234
v_max_f32 v235, 0, v235
v_pk_mul_f32 v[232:233], v[232:233], v[232:233]
v_pk_mul_f32 v[234:235], v[234:235], v[234:235]
v_cvt_pk_bf16_f32 v28, v232, v233
v_cvt_pk_bf16_f32 v29, v234, v235
v_max_f32 v236, 0, v236
v_max_f32 v237, 0, v237
v_max_f32 v238, 0, v238
v_max_f32 v239, 0, v239
v_pk_mul_f32 v[236:237], v[236:237], v[236:237]
v_pk_mul_f32 v[238:239], v[238:239], v[238:239]
v_cvt_pk_bf16_f32 v30, v236, v237
v_cvt_pk_bf16_f32 v31, v238, v239
buffer_store_dwordx4 v[28:31], v13, s[12:15], s34 offen offset:3072 sc1
s_add_u32 s34, s33, 24576
v_max_f32 v156, 0, v156
v_max_f32 v157, 0, v157
v_max_f32 v158, 0, v158
v_max_f32 v159, 0, v159
v_pk_mul_f32 v[156:157], v[156:157], v[156:157]
v_pk_mul_f32 v[158:159], v[158:159], v[158:159]
v_cvt_pk_bf16_f32 v32, v156, v157
v_cvt_pk_bf16_f32 v33, v158, v159
buffer_store_dwordx2 v[32:33], v13, s[12:15], s34 offen offset:0 sc1
v_max_f32 v184, 0, v184
v_max_f32 v185, 0, v185
v_max_f32 v186, 0, v186
v_max_f32 v187, 0, v187
v_pk_mul_f32 v[184:185], v[184:185], v[184:185]
v_pk_mul_f32 v[186:187], v[186:187], v[186:187]
v_cvt_pk_bf16_f32 v36, v184, v185
v_cvt_pk_bf16_f32 v37, v186, v187
buffer_store_dwordx2 v[36:37], v13, s[12:15], s34 offen offset:1024 sc1
v_max_f32 v212, 0, v212
v_max_f32 v213, 0, v213
v_max_f32 v214, 0, v214
v_max_f32 v215, 0, v215
v_pk_mul_f32 v[212:213], v[212:213], v[212:213]
v_pk_mul_f32 v[214:215], v[214:215], v[214:215]
v_cvt_pk_bf16_f32 v40, v212, v213
v_cvt_pk_bf16_f32 v41, v214, v215
buffer_store_dwordx2 v[40:41], v13, s[12:15], s34 offen offset:2048 sc1
v_max_f32 v240, 0, v240
v_max_f32 v241, 0, v241
v_max_f32 v242, 0, v242
v_max_f32 v243, 0, v243
v_pk_mul_f32 v[240:241], v[240:241], v[240:241]
v_pk_mul_f32 v[242:243], v[242:243], v[242:243]
v_cvt_pk_bf16_f32 v44, v240, v241
v_cvt_pk_bf16_f32 v45, v242, v243
buffer_store_dwordx2 v[44:45], v13, s[12:15], s34 offen offset:3072 sc1
s_branch FE_END
FE_F1:
s_add_u32 s34, s33, 32768
v_max_f32 v136, 0, v136
v_max_f32 v137, 0, v137
v_max_f32 v138, 0, v138
v_max_f32 v139, 0, v139
v_pk_mul_f32 v[136:137], v[136:137], v[136:137]
v_pk_mul_f32 v[138:139], v[138:139], v[138:139]
v_cvt_pk_bf16_f32 v16, v136, v137
v_cvt_pk_bf16_f32 v17, v138, v139
v_max_f32 v140, 0, v140
v_max_f32 v141, 0, v141
v_max_f32 v142, 0, v142
v_max_f32 v143, 0, v143
v_pk_mul_f32 v[140:141], v[140:141], v[140:141]
v_pk_mul_f32 v[142:143], v[142:143], v[142:143]
v_cvt_pk_bf16_f32 v18, v140, v141
v_cvt_pk_bf16_f32 v19, v142, v143
buffer_store_dwordx4 v[16:19], v13, s[12:15], s34 offen offset:0
v_max_f32 v164, 0, v164
v_max_f32 v165, 0, v165
v_max_f32 v166, 0, v166
v_max_f32 v167, 0, v167
v_pk_mul_f32 v[164:165], v[164:165], v[164:165]
v_pk_mul_f32 v[166:167], v[166:167], v[166:167]
v_cvt_pk_bf16_f32 v20, v164, v165
v_cvt_pk_bf16_f32 v21, v166, v167
v_max_f32 v168, 0, v168
v_max_f32 v169, 0, v169
v_max_f32 v170, 0, v170
v_max_f32 v171, 0, v171
v_pk_mul_f32 v[168:169], v[168:169], v[168:169]
v_pk_mul_f32 v[170:171], v[170:171], v[170:171]
v_cvt_pk_bf16_f32 v22, v168, v169
v_cvt_pk_bf16_f32 v23, v170, v171
buffer_store_dwordx4 v[20:23], v13, s[12:15], s34 offen offset:1024
v_max_f32 v192, 0, v192
v_max_f32 v193, 0, v193
v_max_f32 v194, 0, v194
v_max_f32 v195, 0, v195
v_pk_mul_f32 v[192:193], v[192:193], v[192:193]
v_pk_mul_f32 v[194:195], v[194:195], v[194:195]
v_cvt_pk_bf16_f32 v24, v192, v193
v_cvt_pk_bf16_f32 v25, v194, v195
v_max_f32 v196, 0, v196
v_max_f32 v197, 0, v197
v_max_f32 v198, 0, v198
v_max_f32 v199, 0, v199
v_pk_mul_f32 v[196:197], v[196:197], v[196:197]
v_pk_mul_f32 v[198:199], v[198:199], v[198:199]
v_cvt_pk_bf16_f32 v26, v196, v197
v_cvt_pk_bf16_f32 v27, v198, v199
buffer_store_dwordx4 v[24:27], v13, s[12:15], s34 offen offset:2048
v_max_f32 v220, 0, v220
v_max_f32 v221, 0, v221
v_max_f32 v222, 0, v222
v_max_f32 v223, 0, v223
v_pk_mul_f32 v[220:221], v[220:221], v[220:221]
v_pk_mul_f32 v[222:223], v[222:223], v[222:223]
v_cvt_pk_bf16_f32 v28, v220, v221
v_cvt_pk_bf16_f32 v29, v222, v223
v_max_f32 v224, 0, v224
v_max_f32 v225, 0, v225
v_max_f32 v226, 0, v226
v_max_f32 v227, 0, v227
v_pk_mul_f32 v[224:225], v[224:225], v[224:225]
v_pk_mul_f32 v[226:227], v[226:227], v[226:227]
v_cvt_pk_bf16_f32 v30, v224, v225
v_cvt_pk_bf16_f32 v31, v226, v227
buffer_store_dwordx4 v[28:31], v13, s[12:15], s34 offen offset:3072
s_add_u32 s34, s33, 40960
v_max_f32 v144, 0, v144
v_max_f32 v145, 0, v145
v_max_f32 v146, 0, v146
v_max_f32 v147, 0, v147
v_pk_mul_f32 v[144:145], v[144:145], v[144:145]
v_pk_mul_f32 v[146:147], v[146:147], v[146:147]
v_cvt_pk_bf16_f32 v32, v144, v145
v_cvt_pk_bf16_f32 v33, v146, v147
v_max_f32 v148, 0, v148
v_max_f32 v149, 0, v149
v_max_f32 v150, 0, v150
v_max_f32 v151, 0, v151
v_pk_mul_f32 v[148:149], v[148:149], v[148:149]
v_pk_mul_f32 v[150:151], v[150:151], v[150:151]
v_cvt_pk_bf16_f32 v34, v148, v149
v_cvt_pk_bf16_f32 v35, v150, v151
buffer_store_dwordx4 v[32:35], v13, s[12:15], s34 offen offset:0
v_max_f32 v172, 0, v172
v_max_f32 v173, 0, v173
v_max_f32 v174, 0, v174
v_max_f32 v175, 0, v175
v_pk_mul_f32 v[172:173], v[172:173], v[172:173]
v_pk_mul_f32 v[174:175], v[174:175], v[174:175]
v_cvt_pk_bf16_f32 v36, v172, v173
v_cvt_pk_bf16_f32 v37, v174, v175
v_max_f32 v176, 0, v176
v_max_f32 v177, 0, v177
v_max_f32 v178, 0, v178
v_max_f32 v179, 0, v179
v_pk_mul_f32 v[176:177], v[176:177], v[176:177]
v_pk_mul_f32 v[178:179], v[178:179], v[178:179]
v_cvt_pk_bf16_f32 v38, v176, v177
v_cvt_pk_bf16_f32 v39, v178, v179
buffer_store_dwordx4 v[36:39], v13, s[12:15], s34 offen offset:1024
v_max_f32 v200, 0, v200
v_max_f32 v201, 0, v201
v_max_f32 v202, 0, v202
v_max_f32 v203, 0, v203
v_pk_mul_f32 v[200:201], v[200:201], v[200:201]
v_pk_mul_f32 v[202:203], v[202:203], v[202:203]
v_cvt_pk_bf16_f32 v40, v200, v201
v_cvt_pk_bf16_f32 v41, v202, v203
v_max_f32 v204, 0, v204
v_max_f32 v205, 0, v205
v_max_f32 v206, 0, v206
v_max_f32 v207, 0, v207
v_pk_mul_f32 v[204:205], v[204:205], v[204:205]
v_pk_mul_f32 v[206:207], v[206:207], v[206:207]
v_cvt_pk_bf16_f32 v42, v204, v205
v_cvt_pk_bf16_f32 v43, v206, v207
buffer_store_dwordx4 v[40:43], v13, s[12:15], s34 offen offset:2048
v_max_f32 v228, 0, v228
v_max_f32 v229, 0, v229
v_max_f32 v230, 0, v230
v_max_f32 v231, 0, v231
v_pk_mul_f32 v[228:229], v[228:229], v[228:229]
v_pk_mul_f32 v[230:231], v[230:231], v[230:231]
v_cvt_pk_bf16_f32 v44, v228, v229
v_cvt_pk_bf16_f32 v45, v230, v231
v_max_f32 v232, 0, v232
v_max_f32 v233, 0, v233
v_max_f32 v234, 0, v234
v_max_f32 v235, 0, v235
v_pk_mul_f32 v[232:233], v[232:233], v[232:233]
v_pk_mul_f32 v[234:235], v[234:235], v[234:235]
v_cvt_pk_bf16_f32 v46, v232, v233
v_cvt_pk_bf16_f32 v47, v234, v235
buffer_store_dwordx4 v[44:47], v13, s[12:15], s34 offen offset:3072
s_add_u32 s34, s33, 49152
v_max_f32 v152, 0, v152
v_max_f32 v153, 0, v153
v_max_f32 v154, 0, v154
v_max_f32 v155, 0, v155
v_pk_mul_f32 v[152:153], v[152:153], v[152:153]
v_pk_mul_f32 v[154:155], v[154:155], v[154:155]
v_cvt_pk_bf16_f32 v16, v152, v153
v_cvt_pk_bf16_f32 v17, v154, v155
v_max_f32 v156, 0, v156
v_max_f32 v157, 0, v157
v_max_f32 v158, 0, v158
v_max_f32 v159, 0, v159
v_pk_mul_f32 v[156:157], v[156:157], v[156:157]
v_pk_mul_f32 v[158:159], v[158:159], v[158:159]
v_cvt_pk_bf16_f32 v18, v156, v157
v_cvt_pk_bf16_f32 v19, v158, v159
buffer_store_dwordx4 v[16:19], v13, s[12:15], s34 offen offset:0
v_max_f32 v180, 0, v180
v_max_f32 v181, 0, v181
v_max_f32 v182, 0, v182
v_max_f32 v183, 0, v183
v_pk_mul_f32 v[180:181], v[180:181], v[180:181]
v_pk_mul_f32 v[182:183], v[182:183], v[182:183]
v_cvt_pk_bf16_f32 v20, v180, v181
v_cvt_pk_bf16_f32 v21, v182, v183
v_max_f32 v184, 0, v184
v_max_f32 v185, 0, v185
v_max_f32 v186, 0, v186
v_max_f32 v187, 0, v187
v_pk_mul_f32 v[184:185], v[184:185], v[184:185]
v_pk_mul_f32 v[186:187], v[186:187], v[186:187]
v_cvt_pk_bf16_f32 v22, v184, v185
v_cvt_pk_bf16_f32 v23, v186, v187
buffer_store_dwordx4 v[20:23], v13, s[12:15], s34 offen offset:1024
v_max_f32 v208, 0, v208
v_max_f32 v209, 0, v209
v_max_f32 v210, 0, v210
v_max_f32 v211, 0, v211
v_pk_mul_f32 v[208:209], v[208:209], v[208:209]
v_pk_mul_f32 v[210:211], v[210:211], v[210:211]
v_cvt_pk_bf16_f32 v24, v208, v209
v_cvt_pk_bf16_f32 v25, v210, v211
v_max_f32 v212, 0, v212
v_max_f32 v213, 0, v213
v_max_f32 v214, 0, v214
v_max_f32 v215, 0, v215
v_pk_mul_f32 v[212:213], v[212:213], v[212:213]
v_pk_mul_f32 v[214:215], v[214:215], v[214:215]
v_cvt_pk_bf16_f32 v26, v212, v213
v_cvt_pk_bf16_f32 v27, v214, v215
buffer_store_dwordx4 v[24:27], v13, s[12:15], s34 offen offset:2048
v_max_f32 v236, 0, v236
v_max_f32 v237, 0, v237
v_max_f32 v238, 0, v238
v_max_f32 v239, 0, v239
v_pk_mul_f32 v[236:237], v[236:237], v[236:237]
v_pk_mul_f32 v[238:239], v[238:239], v[238:239]
v_cvt_pk_bf16_f32 v28, v236, v237
v_cvt_pk_bf16_f32 v29, v238, v239
v_max_f32 v240, 0, v240
v_max_f32 v241, 0, v241
v_max_f32 v242, 0, v242
v_max_f32 v243, 0, v243
v_pk_mul_f32 v[240:241], v[240:241], v[240:241]
v_pk_mul_f32 v[242:243], v[242:243], v[242:243]
v_cvt_pk_bf16_f32 v30, v240, v241
v_cvt_pk_bf16_f32 v31, v242, v243
buffer_store_dwordx4 v[28:31], v13, s[12:15], s34 offen offset:3072
s_add_u32 s34, s33, 24576
v_max_f32 v132, 0, v132
v_max_f32 v133, 0, v133
v_max_f32 v134, 0, v134
v_max_f32 v135, 0, v135
v_pk_mul_f32 v[132:133], v[132:133], v[132:133]
v_pk_mul_f32 v[134:135], v[134:135], v[134:135]
v_cvt_pk_bf16_f32 v32, v132, v133
v_cvt_pk_bf16_f32 v33, v134, v135
buffer_store_dwordx2 v[32:33], v13, s[12:15], s34 offen offset:8
v_max_f32 v160, 0, v160
v_max_f32 v161, 0, v161
v_max_f32 v162, 0, v162
v_max_f32 v163, 0, v163
v_pk_mul_f32 v[160:161], v[160:161], v[160:161]
v_pk_mul_f32 v[162:163], v[162:163], v[162:163]
v_cvt_pk_bf16_f32 v36, v160, v161
v_cvt_pk_bf16_f32 v37, v162, v163
buffer_store_dwordx2 v[36:37], v13, s[12:15], s34 offen offset:1032
v_max_f32 v188, 0, v188
v_max_f32 v189, 0, v189
v_max_f32 v190, 0, v190
v_max_f32 v191, 0, v191
v_pk_mul_f32 v[188:189], v[188:189], v[188:189]
v_pk_mul_f32 v[190:191], v[190:191], v[190:191]
v_cvt_pk_bf16_f32 v40, v188, v189
v_cvt_pk_bf16_f32 v41, v190, v191
buffer_store_dwordx2 v[40:41], v13, s[12:15], s34 offen offset:2056
v_max_f32 v216, 0, v216
v_max_f32 v217, 0, v217
v_max_f32 v218, 0, v218
v_max_f32 v219, 0, v219
v_pk_mul_f32 v[216:217], v[216:217], v[216:217]
v_pk_mul_f32 v[218:219], v[218:219], v[218:219]
v_cvt_pk_bf16_f32 v44, v216, v217
v_cvt_pk_bf16_f32 v45, v218, v219
buffer_store_dwordx2 v[44:45], v13, s[12:15], s34 offen offset:3080
s_branch FE_END
FE_F0:
s_add_u32 s34, s33, 0
v_max_f32 v132, 0, v132
v_max_f32 v133, 0, v133
v_max_f32 v134, 0, v134
v_max_f32 v135, 0, v135
v_pk_mul_f32 v[132:133], v[132:133], v[132:133]
v_pk_mul_f32 v[134:135], v[134:135], v[134:135]
v_cvt_pk_bf16_f32 v16, v132, v133
v_cvt_pk_bf16_f32 v17, v134, v135
v_max_f32 v136, 0, v136
v_max_f32 v137, 0, v137
v_max_f32 v138, 0, v138
v_max_f32 v139, 0, v139
v_pk_mul_f32 v[136:137], v[136:137], v[136:137]
v_pk_mul_f32 v[138:139], v[138:139], v[138:139]
v_cvt_pk_bf16_f32 v18, v136, v137
v_cvt_pk_bf16_f32 v19, v138, v139
buffer_store_dwordx4 v[16:19], v13, s[12:15], s34 offen offset:0
v_max_f32 v160, 0, v160
v_max_f32 v161, 0, v161
v_max_f32 v162, 0, v162
v_max_f32 v163, 0, v163
v_pk_mul_f32 v[160:161], v[160:161], v[160:161]
v_pk_mul_f32 v[162:163], v[162:163], v[162:163]
v_cvt_pk_bf16_f32 v20, v160, v161
v_cvt_pk_bf16_f32 v21, v162, v163
v_max_f32 v164, 0, v164
v_max_f32 v165, 0, v165
v_max_f32 v166, 0, v166
v_max_f32 v167, 0, v167
v_pk_mul_f32 v[164:165], v[164:165], v[164:165]
v_pk_mul_f32 v[166:167], v[166:167], v[166:167]
v_cvt_pk_bf16_f32 v22, v164, v165
v_cvt_pk_bf16_f32 v23, v166, v167
buffer_store_dwordx4 v[20:23], v13, s[12:15], s34 offen offset:1024
v_max_f32 v188, 0, v188
v_max_f32 v189, 0, v189
v_max_f32 v190, 0, v190
v_max_f32 v191, 0, v191
v_pk_mul_f32 v[188:189], v[188:189], v[188:189]
v_pk_mul_f32 v[190:191], v[190:191], v[190:191]
v_cvt_pk_bf16_f32 v24, v188, v189
v_cvt_pk_bf16_f32 v25, v190, v191
v_max_f32 v192, 0, v192
v_max_f32 v193, 0, v193
v_max_f32 v194, 0, v194
v_max_f32 v195, 0, v195
v_pk_mul_f32 v[192:193], v[192:193], v[192:193]
v_pk_mul_f32 v[194:195], v[194:195], v[194:195]
v_cvt_pk_bf16_f32 v26, v192, v193
v_cvt_pk_bf16_f32 v27, v194, v195
buffer_store_dwordx4 v[24:27], v13, s[12:15], s34 offen offset:2048
v_max_f32 v216, 0, v216
v_max_f32 v217, 0, v217
v_max_f32 v218, 0, v218
v_max_f32 v219, 0, v219
v_pk_mul_f32 v[216:217], v[216:217], v[216:217]
v_pk_mul_f32 v[218:219], v[218:219], v[218:219]
v_cvt_pk_bf16_f32 v28, v216, v217
v_cvt_pk_bf16_f32 v29, v218, v219
v_max_f32 v220, 0, v220
v_max_f32 v221, 0, v221
v_max_f32 v222, 0, v222
v_max_f32 v223, 0, v223
v_pk_mul_f32 v[220:221], v[220:221], v[220:221]
v_pk_mul_f32 v[222:223], v[222:223], v[222:223]
v_cvt_pk_bf16_f32 v30, v220, v221
v_cvt_pk_bf16_f32 v31, v222, v223
buffer_store_dwordx4 v[28:31], v13, s[12:15], s34 offen offset:3072
s_add_u32 s34, s33, 8192
v_max_f32 v140, 0, v140
v_max_f32 v141, 0, v141
v_max_f32 v142, 0, v142
v_max_f32 v143, 0, v143
v_pk_mul_f32 v[140:141], v[140:141], v[140:141]
v_pk_mul_f32 v[142:143], v[142:143], v[142:143]
v_cvt_pk_bf16_f32 v32, v140, v141
v_cvt_pk_bf16_f32 v33, v142, v143
v_max_f32 v144, 0, v144
v_max_f32 v145, 0, v145
v_max_f32 v146, 0, v146
v_max_f32 v147, 0, v147
v_pk_mul_f32 v[144:145], v[144:145], v[144:145]
v_pk_mul_f32 v[146:147], v[146:147], v[146:147]
v_cvt_pk_bf16_f32 v34, v144, v145
v_cvt_pk_bf16_f32 v35, v146, v147
buffer_store_dwordx4 v[32:35], v13, s[12:15], s34 offen offset:0
v_max_f32 v168, 0, v168
v_max_f32 v169, 0, v169
v_max_f32 v170, 0, v170
v_max_f32 v171, 0, v171
v_pk_mul_f32 v[168:169], v[168:169], v[168:169]
v_pk_mul_f32 v[170:171], v[170:171], v[170:171]
v_cvt_pk_bf16_f32 v36, v168, v169
v_cvt_pk_bf16_f32 v37, v170, v171
v_max_f32 v172, 0, v172
v_max_f32 v173, 0, v173
v_max_f32 v174, 0, v174
v_max_f32 v175, 0, v175
v_pk_mul_f32 v[172:173], v[172:173], v[172:173]
v_pk_mul_f32 v[174:175], v[174:175], v[174:175]
v_cvt_pk_bf16_f32 v38, v172, v173
v_cvt_pk_bf16_f32 v39, v174, v175
buffer_store_dwordx4 v[36:39], v13, s[12:15], s34 offen offset:1024
v_max_f32 v196, 0, v196
v_max_f32 v197, 0, v197
v_max_f32 v198, 0, v198
v_max_f32 v199, 0, v199
v_pk_mul_f32 v[196:197], v[196:197], v[196:197]
v_pk_mul_f32 v[198:199], v[198:199], v[198:199]
v_cvt_pk_bf16_f32 v40, v196, v197
v_cvt_pk_bf16_f32 v41, v198, v199
v_max_f32 v200, 0, v200
v_max_f32 v201, 0, v201
v_max_f32 v202, 0, v202
v_max_f32 v203, 0, v203
v_pk_mul_f32 v[200:201], v[200:201], v[200:201]
v_pk_mul_f32 v[202:203], v[202:203], v[202:203]
v_cvt_pk_bf16_f32 v42, v200, v201
v_cvt_pk_bf16_f32 v43, v202, v203
buffer_store_dwordx4 v[40:43], v13, s[12:15], s34 offen offset:2048
v_max_f32 v224, 0, v224
v_max_f32 v225, 0, v225
v_max_f32 v226, 0, v226
v_max_f32 v227, 0, v227
v_pk_mul_f32 v[224:225], v[224:225], v[224:225]
v_pk_mul_f32 v[226:227], v[226:227], v[226:227]
v_cvt_pk_bf16_f32 v44, v224, v225
v_cvt_pk_bf16_f32 v45, v226, v227
v_max_f32 v228, 0, v228
v_max_f32 v229, 0, v229
v_max_f32 v230, 0, v230
v_max_f32 v231, 0, v231
v_pk_mul_f32 v[228:229], v[228:229], v[228:229]
v_pk_mul_f32 v[230:231], v[230:231], v[230:231]
v_cvt_pk_bf16_f32 v46, v228, v229
v_cvt_pk_bf16_f32 v47, v230, v231
buffer_store_dwordx4 v[44:47], v13, s[12:15], s34 offen offset:3072
s_add_u32 s34, s33, 16384
v_max_f32 v148, 0, v148
v_max_f32 v149, 0, v149
v_max_f32 v150, 0, v150
v_max_f32 v151, 0, v151
v_pk_mul_f32 v[148:149], v[148:149], v[148:149]
v_pk_mul_f32 v[150:151], v[150:151], v[150:151]
v_cvt_pk_bf16_f32 v16, v148, v149
v_cvt_pk_bf16_f32 v17, v150, v151
v_max_f32 v152, 0, v152
v_max_f32 v153, 0, v153
v_max_f32 v154, 0, v154
v_max_f32 v155, 0, v155
v_pk_mul_f32 v[152:153], v[152:153], v[152:153]
v_pk_mul_f32 v[154:155], v[154:155], v[154:155]
v_cvt_pk_bf16_f32 v18, v152, v153
v_cvt_pk_bf16_f32 v19, v154, v155
buffer_store_dwordx4 v[16:19], v13, s[12:15], s34 offen offset:0
v_max_f32 v176, 0, v176
v_max_f32 v177, 0, v177
v_max_f32 v178, 0, v178
v_max_f32 v179, 0, v179
v_pk_mul_f32 v[176:177], v[176:177], v[176:177]
v_pk_mul_f32 v[178:179], v[178:179], v[178:179]
v_cvt_pk_bf16_f32 v20, v176, v177
v_cvt_pk_bf16_f32 v21, v178, v179
v_max_f32 v180, 0, v180
v_max_f32 v181, 0, v181
v_max_f32 v182, 0, v182
v_max_f32 v183, 0, v183
v_pk_mul_f32 v[180:181], v[180:181], v[180:181]
v_pk_mul_f32 v[182:183], v[182:183], v[182:183]
v_cvt_pk_bf16_f32 v22, v180, v181
v_cvt_pk_bf16_f32 v23, v182, v183
buffer_store_dwordx4 v[20:23], v13, s[12:15], s34 offen offset:1024
v_max_f32 v204, 0, v204
v_max_f32 v205, 0, v205
v_max_f32 v206, 0, v206
v_max_f32 v207, 0, v207
v_pk_mul_f32 v[204:205], v[204:205], v[204:205]
v_pk_mul_f32 v[206:207], v[206:207], v[206:207]
v_cvt_pk_bf16_f32 v24, v204, v205
v_cvt_pk_bf16_f32 v25, v206, v207
v_max_f32 v208, 0, v208
v_max_f32 v209, 0, v209
v_max_f32 v210, 0, v210
v_max_f32 v211, 0, v211
v_pk_mul_f32 v[208:209], v[208:209], v[208:209]
v_pk_mul_f32 v[210:211], v[210:211], v[210:211]
v_cvt_pk_bf16_f32 v26, v208, v209
v_cvt_pk_bf16_f32 v27, v210, v211
buffer_store_dwordx4 v[24:27], v13, s[12:15], s34 offen offset:2048
v_max_f32 v232, 0, v232
v_max_f32 v233, 0, v233
v_max_f32 v234, 0, v234
v_max_f32 v235, 0, v235
v_pk_mul_f32 v[232:233], v[232:233], v[232:233]
v_pk_mul_f32 v[234:235], v[234:235], v[234:235]
v_cvt_pk_bf16_f32 v28, v232, v233
v_cvt_pk_bf16_f32 v29, v234, v235
v_max_f32 v236, 0, v236
v_max_f32 v237, 0, v237
v_max_f32 v238, 0, v238
v_max_f32 v239, 0, v239
v_pk_mul_f32 v[236:237], v[236:237], v[236:237]
v_pk_mul_f32 v[238:239], v[238:239], v[238:239]
v_cvt_pk_bf16_f32 v30, v236, v237
v_cvt_pk_bf16_f32 v31, v238, v239
buffer_store_dwordx4 v[28:31], v13, s[12:15], s34 offen offset:3072
s_add_u32 s34, s33, 24576
v_max_f32 v156, 0, v156
v_max_f32 v157, 0, v157
v_max_f32 v158, 0, v158
v_max_f32 v159, 0, v159
v_pk_mul_f32 v[156:157], v[156:157], v[156:157]
v_pk_mul_f32 v[158:159], v[158:159], v[158:159]
v_cvt_pk_bf16_f32 v32, v156, v157
v_cvt_pk_bf16_f32 v33, v158, v159
buffer_store_dwordx2 v[32:33], v13, s[12:15], s34 offen offset:0
v_max_f32 v184, 0, v184
v_max_f32 v185, 0, v185
v_max_f32 v186, 0, v186
v_max_f32 v187, 0, v187
v_pk_mul_f32 v[184:185], v[184:185], v[184:185]
v_pk_mul_f32 v[186:187], v[186:187], v[186:187]
v_cvt_pk_bf16_f32 v36, v184, v185
v_cvt_pk_bf16_f32 v37, v186, v187
buffer_store_dwordx2 v[36:37], v13, s[12:15], s34 offen offset:1024
v_max_f32 v212, 0, v212
v_max_f32 v213, 0, v213
v_max_f32 v214, 0, v214
v_max_f32 v215, 0, v215
v_pk_mul_f32 v[212:213], v[212:213], v[212:213]
v_pk_mul_f32 v[214:215], v[214:215], v[214:215]
v_cvt_pk_bf16_f32 v40, v212, v213
v_cvt_pk_bf16_f32 v41, v214, v215
buffer_store_dwordx2 v[40:41], v13, s[12:15], s34 offen offset:2048
v_max_f32 v240, 0, v240
v_max_f32 v241, 0, v241
v_max_f32 v242, 0, v242
v_max_f32 v243, 0, v243
v_pk_mul_f32 v[240:241], v[240:241], v[240:241]
v_pk_mul_f32 v[242:243], v[242:243], v[242:243]
v_cvt_pk_bf16_f32 v44, v240, v241
v_cvt_pk_bf16_f32 v45, v242, v243
buffer_store_dwordx2 v[44:45], v13, s[12:15], s34 offen offset:3072
FE_END:
s_waitcnt vmcnt(0)
s_barrier
s_barrier
buffer_load_dword v238, v249, s[12:15], s46 offen offset:0 sc1
buffer_load_dword v239, v249, s[12:15], s46 offen offset:64 sc1
buffer_load_dword v240, v249, s[12:15], s46 offen offset:128 sc1
buffer_load_dword v241, v249, s[12:15], s46 offen offset:192 sc1
buffer_load_dwordx2 v[208:209], v247, s[4:7], 0 offen offset:0
buffer_load_dwordx2 v[218:219], v248, s[60:63], 0 offen offset:0
buffer_load_dwordx2 v[228:229], v248, s[64:67], 0 offen offset:0
buffer_load_dwordx2 v[210:211], v247, s[4:7], 0 offen offset:32
buffer_load_dwordx2 v[220:221], v248, s[60:63], 0 offen offset:32
buffer_load_dwordx2 v[230:231], v248, s[64:67], 0 offen offset:32
buffer_load_dwordx2 v[212:213], v247, s[4:7], 0 offen offset:64
buffer_load_dwordx2 v[222:223], v248, s[60:63], 0 offen offset:64
buffer_load_dwordx2 v[232:233], v248, s[64:67], 0 offen offset:64
buffer_load_dwordx2 v[214:215], v247, s[4:7], 0 offen offset:96
buffer_load_dwordx2 v[224:225], v248, s[60:63], 0 offen offset:96
buffer_load_dwordx2 v[234:235], v248, s[64:67], 0 offen offset:96
buffer_load_dwordx2 v[216:217], v247, s[4:7], 0 offen offset:128
buffer_load_dwordx2 v[226:227], v248, s[60:63], 0 offen offset:128
buffer_load_dwordx2 v[236:237], v248, s[64:67], 0 offen offset:128
s_mov_b32 s36, 40960
s_mov_b32 s39, 40960
s_mov_b32 s29, 4294885376
s_mov_b32 s37, 0
ds_read_b64_tr_b16 v[32:33], v8 offset:0
ds_read_b64_tr_b16 v[34:35], v8 offset:2048
ds_read_b128 v[16:19], v4 offset:0
ds_read_b64_tr_b16 v[36:37], v9 offset:0
ds_read_b64_tr_b16 v[38:39], v9 offset:2048
ds_read_b128 v[20:23], v4 offset:1024
ds_read_b64_tr_b16 v[40:41], v10 offset:0
ds_read_b64_tr_b16 v[42:43], v10 offset:2048
ds_read_b128 v[24:27], v4 offset:2048
ds_read_b64_tr_b16 v[44:45], v11 offset:0
ds_read_b64_tr_b16 v[46:47], v11 offset:2048
ds_read_b128 v[28:31], v4 offset:3072
ds_read_b64_tr_b16 v[48:49], v12 offset:0
ds_read_b64_tr_b16 v[50:51], v12 offset:2048
s_sub_u32 s38, s25, 1
.p2align 3
s_waitcnt lgkmcnt(0)
s_nop 0
v_mfma_f32_16x16x32_bf16 v[128:131], v[32:35], v[16:19], 0
ds_read_b64_tr_b16 v[68:69], v8 offset:4096
v_mfma_f32_16x16x32_bf16 v[148:151], v[32:35], v[20:23], 0
ds_read_b64_tr_b16 v[70:71], v8 offset:6144
v_mfma_f32_16x16x32_bf16 v[168:171], v[32:35], v[24:27], 0
ds_read_b128 v[52:55], v4 offset:8192
v_mfma_f32_16x16x32_bf16 v[188:191], v[32:35], v[28:31], 0
ds_read_b64_tr_b16 v[72:73], v9 offset:4096
v_mfma_f32_16x16x32_bf16 v[132:135], v[36:39], v[16:19], 0
ds_read_b64_tr_b16 v[74:75], v9 offset:6144
v_mfma_f32_16x16x32_bf16 v[152:155], v[36:39], v[20:23], 0
ds_read_b128 v[56:59], v4 offset:9216
v_mfma_f32_16x16x32_bf16 v[172:175], v[36:39], v[24:27], 0
ds_read_b64_tr_b16 v[76:77], v10 offset:4096
v_mfma_f32_16x16x32_bf16 v[192:195], v[36:39], v[28:31], 0
ds_read_b64_tr_b16 v[78:79], v10 offset:6144
v_mfma_f32_16x16x32_bf16 v[136:139], v[40:43], v[16:19], 0
ds_read_b128 v[60:63], v4 offset:10240
v_mfma_f32_16x16x32_bf16 v[156:159], v[40:43], v[20:23], 0
ds_read_b64_tr_b16 v[80:81], v11 offset:4096
v_mfma_f32_16x16x32_bf16 v[176:179], v[40:43], v[24:27], 0
ds_read_b64_tr_b16 v[82:83], v11 offset:6144
v_mfma_f32_16x16x32_bf16 v[196:199], v[40:43], v[28:31], 0
ds_read_b128 v[64:67], v4 offset:11264
v_mfma_f32_16x16x32_bf16 v[140:143], v[44:47], v[16:19], 0
ds_read_b64_tr_b16 v[84:85], v12 offset:4096
v_mfma_f32_16x16x32_bf16 v[160:163], v[44:47], v[20:23], 0
ds_read_b64_tr_b16 v[86:87], v12 offset:6144
v_mfma_f32_16x16x32_bf16 v[180:183], v[44:47], v[24:27], 0
v_add_u32_e64 v4, s36, v4
v_mfma_f32_16x16x32_bf16 v[200:203], v[44:47], v[28:31], 0
v_add_u32_e64 v8, s36, v8
v_mfma_f32_16x16x32_bf16 v[144:147], v[48:51], v[16:19], 0
v_add_u32_e64 v9, s36, v9
v_mfma_f32_16x16x32_bf16 v[164:167], v[48:51], v[20:23], 0
v_add_u32_e64 v10, s36, v10
v_mfma_f32_16x16x32_bf16 v[184:187], v[48:51], v[24:27], 0
v_add_u32_e64 v11, s36, v11
v_mfma_f32_16x16x32_bf16 v[204:207], v[48:51], v[28:31], 0
v_add_u32_e64 v12, s36, v12
s_waitcnt lgkmcnt(0)
s_barrier
v_mfma_f32_16x16x32_bf16 v[128:131], v[68:71], v[52:55], v[128:131]
ds_read_b64_tr_b16 v[32:33], v8 offset:0
v_mfma_f32_16x16x32_bf16 v[148:151], v[68:71], v[56:59], v[148:151]
ds_read_b64_tr_b16 v[34:35], v8 offset:2048
v_mfma_f32_16x16x32_bf16 v[168:171], v[68:71], v[60:63], v[168:171]
ds_read_b128 v[16:19], v4 offset:0
v_mfma_f32_16x16x32_bf16 v[188:191], v[68:71], v[64:67], v[188:191]
ds_read_b64_tr_b16 v[36:37], v9 offset:0
v_mfma_f32_16x16x32_bf16 v[132:135], v[72:75], v[52:55], v[132:135]
ds_read_b64_tr_b16 v[38:39], v9 offset:2048
v_mfma_f32_16x16x32_bf16 v[152:155], v[72:75], v[56:59], v[152:155]
ds_read_b128 v[20:23], v4 offset:1024
v_mfma_f32_16x16x32_bf16 v[172:175], v[72:75], v[60:63], v[172:175]
ds_read_b64_tr_b16 v[40:41], v10 offset:0
v_mfma_f32_16x16x32_bf16 v[192:195], v[72:75], v[64:67], v[192:195]
ds_read_b64_tr_b16 v[42:43], v10 offset:2048
v_mfma_f32_16x16x32_bf16 v[136:139], v[76:79], v[52:55], v[136:139]
ds_read_b128 v[24:27], v4 offset:2048
v_mfma_f32_16x16x32_bf16 v[156:159], v[76:79], v[56:59], v[156:159]
ds_read_b64_tr_b16 v[44:45], v11 offset:0
v_mfma_f32_16x16x32_bf16 v[176:179], v[76:79], v[60:63], v[176:179]
ds_read_b64_tr_b16 v[46:47], v11 offset:2048
v_mfma_f32_16x16x32_bf16 v[196:199], v[76:79], v[64:67], v[196:199]
ds_read_b128 v[28:31], v4 offset:3072
v_mfma_f32_16x16x32_bf16 v[140:143], v[80:83], v[52:55], v[140:143]
ds_read_b64_tr_b16 v[48:49], v12 offset:0
v_mfma_f32_16x16x32_bf16 v[160:163], v[80:83], v[56:59], v[160:163]
ds_read_b64_tr_b16 v[50:51], v12 offset:2048
v_mfma_f32_16x16x32_bf16 v[180:183], v[80:83], v[60:63], v[180:183]
s_add_u32 s37, s37, 1
s_cmp_eq_u32 s37, 2
v_mfma_f32_16x16x32_bf16 v[200:203], v[80:83], v[64:67], v[200:203]
s_cselect_b32 s36, s29, s39
s_cmp_eq_u32 s37, 3
v_mfma_f32_16x16x32_bf16 v[144:147], v[84:87], v[52:55], v[144:147]
s_cselect_b32 s37, 0, s37
s_sub_u32 s38, s38, 1
v_mfma_f32_16x16x32_bf16 v[164:167], v[84:87], v[56:59], v[164:167]
v_mfma_f32_16x16x32_bf16 v[184:187], v[84:87], v[60:63], v[184:187]
v_mfma_f32_16x16x32_bf16 v[204:207], v[84:87], v[64:67], v[204:207]
.p2align 6
P2FC_LOOP:
s_waitcnt lgkmcnt(0)
s_cmp_eq_u32 s38, 4
v_mfma_f32_16x16x32_bf16 v[128:131], v[32:35], v[16:19], v[128:131]
ds_read_b64_tr_b16 v[68:69], v8 offset:4096
v_mfma_f32_16x16x32_bf16 v[148:151], v[32:35], v[20:23], v[148:151]
ds_read_b64_tr_b16 v[70:71], v8 offset:6144
v_mfma_f32_16x16x32_bf16 v[168:171], v[32:35], v[24:27], v[168:171]
ds_read_b128 v[52:55], v4 offset:8192
v_mfma_f32_16x16x32_bf16 v[188:191], v[32:35], v[28:31], v[188:191]
ds_read_b64_tr_b16 v[72:73], v9 offset:4096
v_mfma_f32_16x16x32_bf16 v[132:135], v[36:39], v[16:19], v[132:135]
ds_read_b64_tr_b16 v[74:75], v9 offset:6144
v_mfma_f32_16x16x32_bf16 v[152:155], v[36:39], v[20:23], v[152:155]
ds_read_b128 v[56:59], v4 offset:9216
v_mfma_f32_16x16x32_bf16 v[172:175], v[36:39], v[24:27], v[172:175]
ds_read_b64_tr_b16 v[76:77], v10 offset:4096
v_mfma_f32_16x16x32_bf16 v[192:195], v[36:39], v[28:31], v[192:195]
ds_read_b64_tr_b16 v[78:79], v10 offset:6144
v_mfma_f32_16x16x32_bf16 v[136:139], v[40:43], v[16:19], v[136:139]
ds_read_b128 v[60:63], v4 offset:10240
v_mfma_f32_16x16x32_bf16 v[156:159], v[40:43], v[20:23], v[156:159]
ds_read_b64_tr_b16 v[80:81], v11 offset:4096
v_mfma_f32_16x16x32_bf16 v[176:179], v[40:43], v[24:27], v[176:179]
ds_read_b64_tr_b16 v[82:83], v11 offset:6144
v_mfma_f32_16x16x32_bf16 v[196:199], v[40:43], v[28:31], v[196:199]
ds_read_b128 v[64:67], v4 offset:11264
v_mfma_f32_16x16x32_bf16 v[140:143], v[44:47], v[16:19], v[140:143]
ds_read_b64_tr_b16 v[84:85], v12 offset:4096
v_mfma_f32_16x16x32_bf16 v[160:163], v[44:47], v[20:23], v[160:163]
ds_read_b64_tr_b16 v[86:87], v12 offset:6144
v_mfma_f32_16x16x32_bf16 v[180:183], v[44:47], v[24:27], v[180:183]
v_add_u32_e64 v4, s36, v4
v_mfma_f32_16x16x32_bf16 v[200:203], v[44:47], v[28:31], v[200:203]
v_add_u32_e64 v8, s36, v8
v_mfma_f32_16x16x32_bf16 v[144:147], v[48:51], v[16:19], v[144:147]
v_add_u32_e64 v9, s36, v9
v_mfma_f32_16x16x32_bf16 v[164:167], v[48:51], v[20:23], v[164:167]
v_add_u32_e64 v10, s36, v10
v_mfma_f32_16x16x32_bf16 v[184:187], v[48:51], v[24:27], v[184:187]
v_add_u32_e64 v11, s36, v11
v_mfma_f32_16x16x32_bf16 v[204:207], v[48:51], v[28:31], v[204:207]
v_add_u32_e64 v12, s36, v12
s_waitcnt lgkmcnt(0)
s_barrier
v_mfma_f32_16x16x32_bf16 v[128:131], v[68:71], v[52:55], v[128:131]
ds_read_b64_tr_b16 v[32:33], v8 offset:0
v_mfma_f32_16x16x32_bf16 v[148:151], v[68:71], v[56:59], v[148:151]
ds_read_b64_tr_b16 v[34:35], v8 offset:2048
v_mfma_f32_16x16x32_bf16 v[168:171], v[68:71], v[60:63], v[168:171]
ds_read_b128 v[16:19], v4 offset:0
v_mfma_f32_16x16x32_bf16 v[188:191], v[68:71], v[64:67], v[188:191]
ds_read_b64_tr_b16 v[36:37], v9 offset:0
v_mfma_f32_16x16x32_bf16 v[132:135], v[72:75], v[52:55], v[132:135]
ds_read_b64_tr_b16 v[38:39], v9 offset:2048
v_mfma_f32_16x16x32_bf16 v[152:155], v[72:75], v[56:59], v[152:155]
ds_read_b128 v[20:23], v4 offset:1024
v_mfma_f32_16x16x32_bf16 v[172:175], v[72:75], v[60:63], v[172:175]
ds_read_b64_tr_b16 v[40:41], v10 offset:0
v_mfma_f32_16x16x32_bf16 v[192:195], v[72:75], v[64:67], v[192:195]
ds_read_b64_tr_b16 v[42:43], v10 offset:2048
v_mfma_f32_16x16x32_bf16 v[136:139], v[76:79], v[52:55], v[136:139]
ds_read_b128 v[24:27], v4 offset:2048
v_mfma_f32_16x16x32_bf16 v[156:159], v[76:79], v[56:59], v[156:159]
ds_read_b64_tr_b16 v[44:45], v11 offset:0
v_mfma_f32_16x16x32_bf16 v[176:179], v[76:79], v[60:63], v[176:179]
ds_read_b64_tr_b16 v[46:47], v11 offset:2048
v_mfma_f32_16x16x32_bf16 v[196:199], v[76:79], v[64:67], v[196:199]
ds_read_b128 v[28:31], v4 offset:3072
v_mfma_f32_16x16x32_bf16 v[140:143], v[80:83], v[52:55], v[140:143]
ds_read_b64_tr_b16 v[48:49], v12 offset:0
v_mfma_f32_16x16x32_bf16 v[160:163], v[80:83], v[56:59], v[160:163]
ds_read_b64_tr_b16 v[50:51], v12 offset:2048
v_mfma_f32_16x16x32_bf16 v[180:183], v[80:83], v[60:63], v[180:183]
s_add_u32 s37, s37, 1
s_cmp_eq_u32 s37, 2
v_mfma_f32_16x16x32_bf16 v[200:203], v[80:83], v[64:67], v[200:203]
s_cselect_b32 s36, s29, s39
s_cmp_eq_u32 s37, 3
v_mfma_f32_16x16x32_bf16 v[144:147], v[84:87], v[52:55], v[144:147]
s_cselect_b32 s37, 0, s37
s_sub_u32 s38, s38, 1
v_mfma_f32_16x16x32_bf16 v[164:167], v[84:87], v[56:59], v[164:167]
v_mfma_f32_16x16x32_bf16 v[184:187], v[84:87], v[60:63], v[184:187]
v_mfma_f32_16x16x32_bf16 v[204:207], v[84:87], v[64:67], v[204:207]
s_cmp_lg_u32 s38, 0
s_cbranch_scc1 P2FC_LOOP
s_waitcnt lgkmcnt(0)
s_nop 0
v_mfma_f32_16x16x32_bf16 v[128:131], v[32:35], v[16:19], v[128:131]
ds_read_b64_tr_b16 v[68:69], v8 offset:4096
v_mfma_f32_16x16x32_bf16 v[148:151], v[32:35], v[20:23], v[148:151]
ds_read_b64_tr_b16 v[70:71], v8 offset:6144
v_mfma_f32_16x16x32_bf16 v[168:171], v[32:35], v[24:27], v[168:171]
ds_read_b128 v[52:55], v4 offset:8192
v_mfma_f32_16x16x32_bf16 v[188:191], v[32:35], v[28:31], v[188:191]
ds_read_b64_tr_b16 v[72:73], v9 offset:4096
v_mfma_f32_16x16x32_bf16 v[132:135], v[36:39], v[16:19], v[132:135]
ds_read_b64_tr_b16 v[74:75], v9 offset:6144
v_mfma_f32_16x16x32_bf16 v[152:155], v[36:39], v[20:23], v[152:155]
ds_read_b128 v[56:59], v4 offset:9216
v_mfma_f32_16x16x32_bf16 v[172:175], v[36:39], v[24:27], v[172:175]
ds_read_b64_tr_b16 v[76:77], v10 offset:4096
v_mfma_f32_16x16x32_bf16 v[192:195], v[36:39], v[28:31], v[192:195]
ds_read_b64_tr_b16 v[78:79], v10 offset:6144
v_mfma_f32_16x16x32_bf16 v[136:139], v[40:43], v[16:19], v[136:139]
ds_read_b128 v[60:63], v4 offset:10240
v_mfma_f32_16x16x32_bf16 v[156:159], v[40:43], v[20:23], v[156:159]
ds_read_b64_tr_b16 v[80:81], v11 offset:4096
v_mfma_f32_16x16x32_bf16 v[176:179], v[40:43], v[24:27], v[176:179]
ds_read_b64_tr_b16 v[82:83], v11 offset:6144
v_mfma_f32_16x16x32_bf16 v[196:199], v[40:43], v[28:31], v[196:199]
ds_read_b128 v[64:67], v4 offset:11264
v_mfma_f32_16x16x32_bf16 v[140:143], v[44:47], v[16:19], v[140:143]
ds_read_b64_tr_b16 v[84:85], v12 offset:4096
v_mfma_f32_16x16x32_bf16 v[160:163], v[44:47], v[20:23], v[160:163]
ds_read_b64_tr_b16 v[86:87], v12 offset:6144
v_mfma_f32_16x16x32_bf16 v[180:183], v[44:47], v[24:27], v[180:183]
v_mfma_f32_16x16x32_bf16 v[200:203], v[44:47], v[28:31], v[200:203]
v_mfma_f32_16x16x32_bf16 v[144:147], v[48:51], v[16:19], v[144:147]
v_mfma_f32_16x16x32_bf16 v[164:167], v[48:51], v[20:23], v[164:167]
v_mfma_f32_16x16x32_bf16 v[184:187], v[48:51], v[24:27], v[184:187]
v_mfma_f32_16x16x32_bf16 v[204:207], v[48:51], v[28:31], v[204:207]
s_waitcnt lgkmcnt(0)
s_nop 0
v_mfma_f32_16x16x32_bf16 v[128:131], v[68:71], v[52:55], v[128:131]
v_mfma_f32_16x16x32_bf16 v[148:151], v[68:71], v[56:59], v[148:151]
v_mfma_f32_16x16x32_bf16 v[168:171], v[68:71], v[60:63], v[168:171]
v_mfma_f32_16x16x32_bf16 v[188:191], v[68:71], v[64:67], v[188:191]
v_mfma_f32_16x16x32_bf16 v[132:135], v[72:75], v[52:55], v[132:135]
v_mfma_f32_16x16x32_bf16 v[152:155], v[72:75], v[56:59], v[152:155]
v_mfma_f32_16x16x32_bf16 v[172:175], v[72:75], v[60:63], v[172:175]
v_mfma_f32_16x16x32_bf16 v[192:195], v[72:75], v[64:67], v[192:195]
v_mfma_f32_16x16x32_bf16 v[136:139], v[76:79], v[52:55], v[136:139]
v_mfma_f32_16x16x32_bf16 v[156:159], v[76:79], v[56:59], v[156:159]
v_mfma_f32_16x16x32_bf16 v[176:179], v[76:79], v[60:63], v[176:179]
v_mfma_f32_16x16x32_bf16 v[196:199], v[76:79], v[64:67], v[196:199]
v_mfma_f32_16x16x32_bf16 v[140:143], v[80:83], v[52:55], v[140:143]
v_mfma_f32_16x16x32_bf16 v[160:163], v[80:83], v[56:59], v[160:163]
v_mfma_f32_16x16x32_bf16 v[180:183], v[80:83], v[60:63], v[180:183]
v_mfma_f32_16x16x32_bf16 v[200:203], v[80:83], v[64:67], v[200:203]
v_mfma_f32_16x16x32_bf16 v[144:147], v[84:87], v[52:55], v[144:147]
v_mfma_f32_16x16x32_bf16 v[164:167], v[84:87], v[56:59], v[164:167]
v_mfma_f32_16x16x32_bf16 v[184:187], v[84:87], v[60:63], v[184:187]
v_mfma_f32_16x16x32_bf16 v[204:207], v[84:87], v[64:67], v[204:207]
s_waitcnt vmcnt(0)
v_sub_f32 v242, 1.0, v238
v_sub_f32 v243, 1.0, v239
v_sub_f32 v244, 1.0, v240
v_sub_f32 v245, 1.0, v241
s_lshl_b32 s32, s21, 2
s_add_u32 s32, s32, s23
s_mul_i32 s33, s32, 163840
s_add_u32 s33, s33, 16777216
s_mul_i32 s34, s20, 2560
s_add_u32 s33, s33, s34
s_mul_i32 s34, s24, 10240
s_add_u32 s40, s33, s34
v_lshlrev_b32 v14, 4, v0
v_lshlrev_b32 v13, 3, v0
s_lshl_b32 s41, s32, 10
s_lshl_b32 s34, s20, 6
s_add_u32 s41, s41, s34
s_add_u32 s41, s41, 16384000
s_nop 7
s_cmp_eq_u32 s24, 2
s_cbranch_scc1 P2FC_S0
s_add_u32 s34, s40, 0
v_pk_mul_f32 v[128:129], v[128:129], v[242:243] op_sel_hi:[1,0]
v_pk_mul_f32 v[130:131], v[130:131], v[242:243] op_sel_hi:[1,0]
v_cvt_pk_bf16_f32 v16, v128, v129
v_cvt_pk_bf16_f32 v17, v130, v131
v_pk_mul_f32 v[132:133], v[132:133], v[242:243] op_sel_hi:[1,0]
v_pk_mul_f32 v[134:135], v[134:135], v[242:243] op_sel_hi:[1,0]
v_cvt_pk_bf16_f32 v18, v132, v133
v_cvt_pk_bf16_f32 v19, v134, v135
v_pk_mul_f32 v[136:137], v[136:137], v[242:243] op_sel_hi:[1,0]
v_pk_mul_f32 v[138:139], v[138:139], v[242:243] op_sel_hi:[1,0]
v_cvt_pk_bf16_f32 v20, v136, v137
v_cvt_pk_bf16_f32 v21, v138, v139
v_pk_mul_f32 v[140:141], v[140:141], v[242:243] op_sel_hi:[1,0]
v_pk_mul_f32 v[142:143], v[142:143], v[242:243] op_sel_hi:[1,0]
v_cvt_pk_bf16_f32 v22, v140, v141
v_cvt_pk_bf16_f32 v23, v142, v143
v_pk_mul_f32 v[144:145], v[144:145], v[242:243] op_sel_hi:[1,0]
v_pk_mul_f32 v[146:147], v[146:147], v[242:243] op_sel_hi:[1,0]
v_cvt_pk_bf16_f32 v24, v144, v145
v_cvt_pk_bf16_f32 v25, v146, v147
buffer_store_dwordx4 v[16:19], v14, s[12:15], s34 offen sc1
buffer_store_dwordx4 v[20:23], v14, s[12:15], s34 offen offset:1024 sc1
buffer_store_dwordx2 v[24:25], v13, s[12:15], s34 offen offset:2048 sc1
s_add_u32 s34, s40, 40960
v_pk_mul_f32 v[148:149], v[148:149], v[242:243] op_sel:[0,1]
v_pk_mul_f32 v[150:151], v[150:151], v[242:243] op_sel:[0,1]
v_cvt_pk_bf16_f32 v28, v148, v149
v_cvt_pk_bf16_f32 v29, v150, v151
v_pk_mul_f32 v[152:153], v[152:153], v[242:243] op_sel:[0,1]
v_pk_mul_f32 v[154:155], v[154:155], v[242:243] op_sel:[0,1]
v_cvt_pk_bf16_f32 v30, v152, v153
v_cvt_pk_bf16_f32 v31, v154, v155
v_pk_mul_f32 v[156:157], v[156:157], v[242:243] op_sel:[0,1]
v_pk_mul_f32 v[158:159], v[158:159], v[242:243] op_sel:[0,1]
v_cvt_pk_bf16_f32 v32, v156, v157
v_cvt_pk_bf16_f32 v33, v158, v159
v_pk_mul_f32 v[160:161], v[160:161], v[242:243] op_sel:[0,1]
v_pk_mul_f32 v[162:163], v[162:163], v[242:243] op_sel:[0,1]
v_cvt_pk_bf16_f32 v34, v160, v161
v_cvt_pk_bf16_f32 v35, v162, v163
v_pk_mul_f32 v[164:165], v[164:165], v[242:243] op_sel:[0,1]
v_pk_mul_f32 v[166:167], v[166:167], v[242:243] op_sel:[0,1]
v_cvt_pk_bf16_f32 v36, v164, v165
v_cvt_pk_bf16_f32 v37, v166, v167
buffer_store_dwordx4 v[28:31], v14, s[12:15], s34 offen sc1
buffer_store_dwordx4 v[32:35], v14, s[12:15], s34 offen offset:1024 sc1
buffer_store_dwordx2 v[36:37], v13, s[12:15], s34 offen offset:2048 sc1
s_add_u32 s34, s40, 81920
v_pk_mul_f32 v[168:169], v[168:169], v[244:245] op_sel_hi:[1,0]
v_pk_mul_f32 v[170:171], v[170:171], v[244:245] op_sel_hi:[1,0]
v_cvt_pk_bf16_f32 v40, v168, v169
v_cvt_pk_bf16_f32 v41, v170, v171
v_pk_mul_f32 v[172:173], v[172:173], v[244:245] op_sel_hi:[1,0]
v_pk_mul_f32 v[174:175], v[174:175], v[244:245] op_sel_hi:[1,0]
v_cvt_pk_bf16_f32 v42, v172, v173
v_cvt_pk_bf16_f32 v43, v174, v175
v_pk_mul_f32 v[176:177], v[176:177], v[244:245] op_sel_hi:[1,0]
v_pk_mul_f32 v[178:179], v[178:179], v[244:245] op_sel_hi:[1,0]
v_cvt_pk_bf16_f32 v44, v176, v177
v_cvt_pk_bf16_f32 v45, v178, v179
v_pk_mul_f32 v[180:181], v[180:181], v[244:245] op_sel_hi:[1,0]
v_pk_mul_f32 v[182:183], v[182:183], v[244:245] op_sel_hi:[1,0]
v_cvt_pk_bf16_f32 v46, v180, v181
v_cvt_pk_bf16_f32 v47, v182, v183
v_pk_mul_f32 v[184:185], v[184:185], v[244:245] op_sel_hi:[1,0]
v_pk_mul_f32 v[186:187], v[186:187], v[244:245] op_sel_hi:[1,0]
v_cvt_pk_bf16_f32 v48, v184, v185
v_cvt_pk_bf16_f32 v49, v186, v187
buffer_store_dwordx4 v[40:43], v14, s[12:15], s34 offen sc1
buffer_store_dwordx4 v[44:47], v14, s[12:15], s34 offen offset:1024 sc1
buffer_store_dwordx2 v[48:49], v13, s[12:15], s34 offen offset:2048 sc1
v_sub_f32 v15, 1.0, v241
v_mul_f32 v188, v188, v245
v_mul_f32 v189, v189, v245
v_mul_f32 v190, v190, v245
v_mul_f32 v191, v191, v245
v_lshlrev_b32 v56, 16, v208
v_and_b32 v57, 0xffff0000, v208
v_lshlrev_b32 v58, 16, v218
v_and_b32 v59, 0xffff0000, v218
v_lshlrev_b32 v60, 16, v228
v_and_b32 v61, 0xffff0000, v228
v_mul_f32 v56, v56, v58
v_mul_f32 v57, v57, v59
v_fmac_f32 v188, v241, v56
v_fmac_f32 v189, v241, v57
v_fmac_f32 v188, v15, v60
v_fmac_f32 v189, v15, v61
v_lshlrev_b32 v56, 16, v209
v_and_b32 v57, 0xffff0000, v209
v_lshlrev_b32 v58, 16, v219
v_and_b32 v59, 0xffff0000, v219
v_lshlrev_b32 v60, 16, v229
v_and_b32 v61, 0xffff0000, v229
v_mul_f32 v56, v56, v58
v_mul_f32 v57, v57, v59
v_fmac_f32 v190, v241, v56
v_fmac_f32 v191, v241, v57
v_fmac_f32 v190, v15, v60
v_fmac_f32 v191, v15, v61
v_mul_f32 v192, v192, v245
v_mul_f32 v193, v193, v245
v_mul_f32 v194, v194, v245
v_mul_f32 v195, v195, v245
v_lshlrev_b32 v56, 16, v210
v_and_b32 v57, 0xffff0000, v210
v_lshlrev_b32 v58, 16, v220
v_and_b32 v59, 0xffff0000, v220
v_lshlrev_b32 v60, 16, v230
v_and_b32 v61, 0xffff0000, v230
v_mul_f32 v56, v56, v58
v_mul_f32 v57, v57, v59
v_fmac_f32 v192, v241, v56
v_fmac_f32 v193, v241, v57
v_fmac_f32 v192, v15, v60
v_fmac_f32 v193, v15, v61
v_lshlrev_b32 v56, 16, v211
v_and_b32 v57, 0xffff0000, v211
v_lshlrev_b32 v58, 16, v221
v_and_b32 v59, 0xffff0000, v221
v_lshlrev_b32 v60, 16, v231
v_and_b32 v61, 0xffff0000, v231
v_mul_f32 v56, v56, v58
v_mul_f32 v57, v57, v59
v_fmac_f32 v194, v241, v56
v_fmac_f32 v195, v241, v57
v_fmac_f32 v194, v15, v60
v_fmac_f32 v195, v15, v61
v_mul_f32 v196, v196, v245
v_mul_f32 v197, v197, v245
v_mul_f32 v198, v198, v245
v_mul_f32 v199, v199, v245
v_lshlrev_b32 v56, 16, v212
v_and_b32 v57, 0xffff0000, v212
v_lshlrev_b32 v58, 16, v222
v_and_b32 v59, 0xffff0000, v222
v_lshlrev_b32 v60, 16, v232
v_and_b32 v61, 0xffff0000, v232
v_mul_f32 v56, v56, v58
v_mul_f32 v57, v57, v59
v_fmac_f32 v196, v241, v56
v_fmac_f32 v197, v241, v57
v_fmac_f32 v196, v15, v60
v_fmac_f32 v197, v15, v61
v_lshlrev_b32 v56, 16, v213
v_and_b32 v57, 0xffff0000, v213
v_lshlrev_b32 v58, 16, v223
v_and_b32 v59, 0xffff0000, v223
v_lshlrev_b32 v60, 16, v233
v_and_b32 v61, 0xffff0000, v233
v_mul_f32 v56, v56, v58
v_mul_f32 v57, v57, v59
v_fmac_f32 v198, v241, v56
v_fmac_f32 v199, v241, v57
v_fmac_f32 v198, v15, v60
v_fmac_f32 v199, v15, v61
v_mul_f32 v200, v200, v245
v_mul_f32 v201, v201, v245
v_mul_f32 v202, v202, v245
v_mul_f32 v203, v203, v245
v_lshlrev_b32 v56, 16, v214
v_and_b32 v57, 0xffff0000, v214
v_lshlrev_b32 v58, 16, v224
v_and_b32 v59, 0xffff0000, v224
v_lshlrev_b32 v60, 16, v234
v_and_b32 v61, 0xffff0000, v234
v_mul_f32 v56, v56, v58
v_mul_f32 v57, v57, v59
v_fmac_f32 v200, v241, v56
v_fmac_f32 v201, v241, v57
v_fmac_f32 v200, v15, v60
v_fmac_f32 v201, v15, v61
v_lshlrev_b32 v56, 16, v215
v_and_b32 v57, 0xffff0000, v215
v_lshlrev_b32 v58, 16, v225
v_and_b32 v59, 0xffff0000, v225
v_lshlrev_b32 v60, 16, v235
v_and_b32 v61, 0xffff0000, v235
v_mul_f32 v56, v56, v58
v_mul_f32 v57, v57, v59
v_fmac_f32 v202, v241, v56
v_fmac_f32 v203, v241, v57
v_fmac_f32 v202, v15, v60
v_fmac_f32 v203, v15, v61
v_mul_f32 v204, v204, v245
v_mul_f32 v205, v205, v245
v_mul_f32 v206, v206, v245
v_mul_f32 v207, v207, v245
v_lshlrev_b32 v56, 16, v216
v_and_b32 v57, 0xffff0000, v216
v_lshlrev_b32 v58, 16, v226
v_and_b32 v59, 0xffff0000, v226
v_lshlrev_b32 v60, 16, v236
v_and_b32 v61, 0xffff0000, v236
v_mul_f32 v56, v56, v58
v_mul_f32 v57, v57, v59
v_fmac_f32 v204, v241, v56
v_fmac_f32 v205, v241, v57
v_fmac_f32 v204, v15, v60
v_fmac_f32 v205, v15, v61
v_lshlrev_b32 v56, 16, v217
v_and_b32 v57, 0xffff0000, v217
v_lshlrev_b32 v58, 16, v227
v_and_b32 v59, 0xffff0000, v227
v_lshlrev_b32 v60, 16, v237
v_and_b32 v61, 0xffff0000, v237
v_mul_f32 v56, v56, v58
v_mul_f32 v57, v57, v59
v_fmac_f32 v206, v241, v56
v_fmac_f32 v207, v241, v57
v_fmac_f32 v206, v15, v60
v_fmac_f32 v207, v15, v61
s_waitcnt vmcnt(0)
s_mov_b64 s[76:77], exec
s_mov_b64 exec, 1
v_mov_b32 v64, s90
v_mov_b32 v65, 12
s_add_u32 s34, s41, 0
buffer_store_dword v64, v65, s[12:15], s34 offen sc1
s_add_u32 s34, s41, 256
buffer_store_dword v64, v65, s[12:15], s34 offen sc1
s_add_u32 s34, s41, 512
buffer_store_dword v64, v65, s[12:15], s34 offen sc1
s_add_u32 s34, s41, 768
v_mov_b32 v65, 0
s_mov_b32 s36, 0
P2FCX_24P:
buffer_load_dwordx4 v[68:71], v65, s[12:15], s34 offen sc1
s_waitcnt vmcnt(0)
s_mov_b32 s35, 1
v_readfirstlane_b32 s37, v68
s_cmp_eq_u32 s37, s90
s_cselect_b32 s35, s35, 0
v_readfirstlane_b32 s37, v69
s_cmp_eq_u32 s37, s90
s_cselect_b32 s35, s35, 0
v_readfirstlane_b32 s37, v70
s_cmp_eq_u32 s37, s90
s_cselect_b32 s35, s35, 0
s_cmp_eq_u32 s35, 1
s_cbranch_scc1 P2FCX_24D
s_add_u32 s36, s36, 1
s_cmp_lt_u32 s36, 0x4000
s_cbranch_scc0 P2FCX_24D
s_branch P2FCX_24P
P2FCX_24D:
s_mov_b64 exec, s[76:77]
s_add_u32 s34, s33, 122880
buffer_load_dwordx4 v[16:19], v14, s[12:15], s34 offen sc1
buffer_load_dwordx4 v[20:23], v14, s[12:15], s34 offen offset:1024 sc1
buffer_load_dwordx2 v[24:25], v13, s[12:15], s34 offen offset:2048 sc1
s_add_u32 s34, s33, 133120
buffer_load_dwordx4 v[28:31], v14, s[12:15], s34 offen sc1
buffer_load_dwordx4 v[32:35], v14, s[12:15], s34 offen offset:1024 sc1
buffer_load_dwordx2 v[36:37], v13, s[12:15], s34 offen offset:2048 sc1
s_add_u32 s34, s33, 143360
buffer_load_dwordx4 v[40:43], v14, s[12:15], s34 offen sc1
buffer_load_dwordx4 v[44:47], v14, s[12:15], s34 offen offset:1024 sc1
buffer_load_dwordx2 v[48:49], v13, s[12:15], s34 offen offset:2048 sc1
s_waitcnt vmcnt(6)
v_lshlrev_b32 v56, 16, v16
v_and_b32 v57, 0xffff0000, v16
v_pk_add_f32 v[188:189], v[188:189], v[56:57]
v_lshlrev_b32 v56, 16, v17
v_and_b32 v57, 0xffff0000, v17
v_pk_add_f32 v[190:191], v[190:191], v[56:57]
v_lshlrev_b32 v56, 16, v18
v_and_b32 v57, 0xffff0000, v18
v_pk_add_f32 v[192:193], v[192:193], v[56:57]
v_lshlrev_b32 v56, 16, v19
v_and_b32 v57, 0xffff0000, v19
v_pk_add_f32 v[194:195], v[194:195], v[56:57]
v_lshlrev_b32 v56, 16, v20
v_and_b32 v57, 0xffff0000, v20
v_pk_add_f32 v[196:197], v[196:197], v[56:57]
v_lshlrev_b32 v56, 16, v21
v_and_b32 v57, 0xffff0000, v21
v_pk_add_f32 v[198:199], v[198:199], v[56:57]
v_lshlrev_b32 v56, 16, v22
v_and_b32 v57, 0xffff0000, v22
v_pk_add_f32 v[200:201], v[200:201], v[56:57]
v_lshlrev_b32 v56, 16, v23
v_and_b32 v57, 0xffff0000, v23
v_pk_add_f32 v[202:203], v[202:203], v[56:57]
v_lshlrev_b32 v56, 16, v24
v_and_b32 v57, 0xffff0000, v24
v_pk_add_f32 v[204:205], v[204:205], v[56:57]
v_lshlrev_b32 v56, 16, v25
v_and_b32 v57, 0xffff0000, v25
v_pk_add_f32 v[206:207], v[206:207], v[56:57]
s_waitcnt vmcnt(3)
v_lshlrev_b32 v56, 16, v28
v_and_b32 v57, 0xffff0000, v28
v_pk_add_f32 v[188:189], v[188:189], v[56:57]
v_lshlrev_b32 v56, 16, v29
v_and_b32 v57, 0xffff0000, v29
v_pk_add_f32 v[190:191], v[190:191], v[56:57]
v_lshlrev_b32 v56, 16, v30
v_and_b32 v57, 0xffff0000, v30
v_pk_add_f32 v[192:193], v[192:193], v[56:57]
v_lshlrev_b32 v56, 16, v31
v_and_b32 v57, 0xffff0000, v31
v_pk_add_f32 v[194:195], v[194:195], v[56:57]
v_lshlrev_b32 v56, 16, v32
v_and_b32 v57, 0xffff0000, v32
v_pk_add_f32 v[196:197], v[196:197], v[56:57]
v_lshlrev_b32 v56, 16, v33
v_and_b32 v57, 0xffff0000, v33
v_pk_add_f32 v[198:199], v[198:199], v[56:57]
v_lshlrev_b32 v56, 16, v34
v_and_b32 v57, 0xffff0000, v34
v_pk_add_f32 v[200:201], v[200:201], v[56:57]
v_lshlrev_b32 v56, 16, v35
v_and_b32 v57, 0xffff0000, v35
v_pk_add_f32 v[202:203], v[202:203], v[56:57]
v_lshlrev_b32 v56, 16, v36
v_and_b32 v57, 0xffff0000, v36
v_pk_add_f32 v[204:205], v[204:205], v[56:57]
v_lshlrev_b32 v56, 16, v37
v_and_b32 v57, 0xffff0000, v37
v_pk_add_f32 v[206:207], v[206:207], v[56:57]
s_waitcnt vmcnt(0)
v_lshlrev_b32 v56, 16, v40
v_and_b32 v57, 0xffff0000, v40
v_pk_add_f32 v[188:189], v[188:189], v[56:57]
v_lshlrev_b32 v56, 16, v41
v_and_b32 v57, 0xffff0000, v41
v_pk_add_f32 v[190:191], v[190:191], v[56:57]
v_lshlrev_b32 v56, 16, v42
v_and_b32 v57, 0xffff0000, v42
v_pk_add_f32 v[192:193], v[192:193], v[56:57]
v_lshlrev_b32 v56, 16, v43
v_and_b32 v57, 0xffff0000, v43
v_pk_add_f32 v[194:195], v[194:195], v[56:57]
v_lshlrev_b32 v56, 16, v44
v_and_b32 v57, 0xffff0000, v44
v_pk_add_f32 v[196:197], v[196:197], v[56:57]
v_lshlrev_b32 v56, 16, v45
v_and_b32 v57, 0xffff0000, v45
v_pk_add_f32 v[198:199], v[198:199], v[56:57]
v_lshlrev_b32 v56, 16, v46
v_and_b32 v57, 0xffff0000, v46
v_pk_add_f32 v[200:201], v[200:201], v[56:57]
v_lshlrev_b32 v56, 16, v47
v_and_b32 v57, 0xffff0000, v47
v_pk_add_f32 v[202:203], v[202:203], v[56:57]
v_lshlrev_b32 v56, 16, v48
v_and_b32 v57, 0xffff0000, v48
v_pk_add_f32 v[204:205], v[204:205], v[56:57]
v_lshlrev_b32 v56, 16, v49
v_and_b32 v57, 0xffff0000, v49
v_pk_add_f32 v[206:207], v[206:207], v[56:57]
buffer_store_dwordx4 v[188:191], v246, s[16:19], 0 offen offset:0 sc1
buffer_store_dwordx4 v[192:195], v246, s[16:19], 0 offen offset:64 sc1
buffer_store_dwordx4 v[196:199], v246, s[16:19], 0 offen offset:128 sc1
buffer_store_dwordx4 v[200:203], v246, s[16:19], 0 offen offset:192 sc1
buffer_store_dwordx4 v[204:207], v246, s[16:19], 0 offen offset:256 sc1
s_branch P2FC_END
P2FC_S0:
s_add_u32 s34, s40, 0
v_pk_mul_f32 v[128:129], v[128:129], v[242:243] op_sel_hi:[1,0]
v_pk_mul_f32 v[130:131], v[130:131], v[242:243] op_sel_hi:[1,0]
v_cvt_pk_bf16_f32 v16, v128, v129
v_cvt_pk_bf16_f32 v17, v130, v131
v_pk_mul_f32 v[132:133], v[132:133], v[242:243] op_sel_hi:[1,0]
v_pk_mul_f32 v[134:135], v[134:135], v[242:243] op_sel_hi:[1,0]
v_cvt_pk_bf16_f32 v18, v132, v133
v_cvt_pk_bf16_f32 v19, v134, v135
v_pk_mul_f32 v[136:137], v[136:137], v[242:243] op_sel_hi:[1,0]
v_pk_mul_f32 v[138:139], v[138:139], v[242:243] op_sel_hi:[1,0]
v_cvt_pk_bf16_f32 v20, v136, v137
v_cvt_pk_bf16_f32 v21, v138, v139
v_pk_mul_f32 v[140:141], v[140:141], v[242:243] op_sel_hi:[1,0]
v_pk_mul_f32 v[142:143], v[142:143], v[242:243] op_sel_hi:[1,0]
v_cvt_pk_bf16_f32 v22, v140, v141
v_cvt_pk_bf16_f32 v23, v142, v143
v_pk_mul_f32 v[144:145], v[144:145], v[242:243] op_sel_hi:[1,0]
v_pk_mul_f32 v[146:147], v[146:147], v[242:243] op_sel_hi:[1,0]
v_cvt_pk_bf16_f32 v24, v144, v145
v_cvt_pk_bf16_f32 v25, v146, v147
buffer_store_dwordx4 v[16:19], v14, s[12:15], s34 offen sc1
buffer_store_dwordx4 v[20:23], v14, s[12:15], s34 offen offset:1024 sc1
buffer_store_dwordx2 v[24:25], v13, s[12:15], s34 offen offset:2048 sc1
s_add_u32 s34, s40, 40960
v_pk_mul_f32 v[148:149], v[148:149], v[242:243] op_sel:[0,1]
v_pk_mul_f32 v[150:151], v[150:151], v[242:243] op_sel:[0,1]
v_cvt_pk_bf16_f32 v28, v148, v149
v_cvt_pk_bf16_f32 v29, v150, v151
v_pk_mul_f32 v[152:153], v[152:153], v[242:243] op_sel:[0,1]
v_pk_mul_f32 v[154:155], v[154:155], v[242:243] op_sel:[0,1]
v_cvt_pk_bf16_f32 v30, v152, v153
v_cvt_pk_bf16_f32 v31, v154, v155
v_pk_mul_f32 v[156:157], v[156:157], v[242:243] op_sel:[0,1]
v_pk_mul_f32 v[158:159], v[158:159], v[242:243] op_sel:[0,1]
v_cvt_pk_bf16_f32 v32, v156, v157
v_cvt_pk_bf16_f32 v33, v158, v159
v_pk_mul_f32 v[160:161], v[160:161], v[242:243] op_sel:[0,1]
v_pk_mul_f32 v[162:163], v[162:163], v[242:243] op_sel:[0,1]
v_cvt_pk_bf16_f32 v34, v160, v161
v_cvt_pk_bf16_f32 v35, v162, v163
v_pk_mul_f32 v[164:165], v[164:165], v[242:243] op_sel:[0,1]
v_pk_mul_f32 v[166:167], v[166:167], v[242:243] op_sel:[0,1]
v_cvt_pk_bf16_f32 v36, v164, v165
v_cvt_pk_bf16_f32 v37, v166, v167
buffer_store_dwordx4 v[28:31], v14, s[12:15], s34 offen sc1
buffer_store_dwordx4 v[32:35], v14, s[12:15], s34 offen offset:1024 sc1
buffer_store_dwordx2 v[36:37], v13, s[12:15], s34 offen offset:2048 sc1
s_add_u32 s34, s40, 122880
v_pk_mul_f32 v[188:189], v[188:189], v[244:245] op_sel:[0,1]
v_pk_mul_f32 v[190:191], v[190:191], v[244:245] op_sel:[0,1]
v_cvt_pk_bf16_f32 v40, v188, v189
v_cvt_pk_bf16_f32 v41, v190, v191
v_pk_mul_f32 v[192:193], v[192:193], v[244:245] op_sel:[0,1]
v_pk_mul_f32 v[194:195], v[194:195], v[244:245] op_sel:[0,1]
v_cvt_pk_bf16_f32 v42, v192, v193
v_cvt_pk_bf16_f32 v43, v194, v195
v_pk_mul_f32 v[196:197], v[196:197], v[244:245] op_sel:[0,1]
v_pk_mul_f32 v[198:199], v[198:199], v[244:245] op_sel:[0,1]
v_cvt_pk_bf16_f32 v44, v196, v197
v_cvt_pk_bf16_f32 v45, v198, v199
v_pk_mul_f32 v[200:201], v[200:201], v[244:245] op_sel:[0,1]
v_pk_mul_f32 v[202:203], v[202:203], v[244:245] op_sel:[0,1]
v_cvt_pk_bf16_f32 v46, v200, v201
v_cvt_pk_bf16_f32 v47, v202, v203
v_pk_mul_f32 v[204:205], v[204:205], v[244:245] op_sel:[0,1]
v_pk_mul_f32 v[206:207], v[206:207], v[244:245] op_sel:[0,1]
v_cvt_pk_bf16_f32 v48, v204, v205
v_cvt_pk_bf16_f32 v49, v206, v207
buffer_store_dwordx4 v[40:43], v14, s[12:15], s34 offen sc1
buffer_store_dwordx4 v[44:47], v14, s[12:15], s34 offen offset:1024 sc1
buffer_store_dwordx2 v[48:49], v13, s[12:15], s34 offen offset:2048 sc1
v_sub_f32 v15, 1.0, v240
v_mul_f32 v168, v168, v244
v_mul_f32 v169, v169, v244
v_mul_f32 v170, v170, v244
v_mul_f32 v171, v171, v244
v_lshlrev_b32 v56, 16, v208
v_and_b32 v57, 0xffff0000, v208
v_lshlrev_b32 v58, 16, v218
v_and_b32 v59, 0xffff0000, v218
v_lshlrev_b32 v60, 16, v228
v_and_b32 v61, 0xffff0000, v228
v_mul_f32 v56, v56, v58
v_mul_f32 v57, v57, v59
v_fmac_f32 v168, v240, v56
v_fmac_f32 v169, v240, v57
v_fmac_f32 v168, v15, v60
v_fmac_f32 v169, v15, v61
v_lshlrev_b32 v56, 16, v209
v_and_b32 v57, 0xffff0000, v209
v_lshlrev_b32 v58, 16, v219
v_and_b32 v59, 0xffff0000, v219
v_lshlrev_b32 v60, 16, v229
v_and_b32 v61, 0xffff0000, v229
v_mul_f32 v56, v56, v58
v_mul_f32 v57, v57, v59
v_fmac_f32 v170, v240, v56
v_fmac_f32 v171, v240, v57
v_fmac_f32 v170, v15, v60
v_fmac_f32 v171, v15, v61
v_mul_f32 v172, v172, v244
v_mul_f32 v173, v173, v244
v_mul_f32 v174, v174, v244
v_mul_f32 v175, v175, v244
v_lshlrev_b32 v56, 16, v210
v_and_b32 v57, 0xffff0000, v210
v_lshlrev_b32 v58, 16, v220
v_and_b32 v59, 0xffff0000, v220
v_lshlrev_b32 v60, 16, v230
v_and_b32 v61, 0xffff0000, v230
v_mul_f32 v56, v56, v58
v_mul_f32 v57, v57, v59
v_fmac_f32 v172, v240, v56
v_fmac_f32 v173, v240, v57
v_fmac_f32 v172, v15, v60
v_fmac_f32 v173, v15, v61
v_lshlrev_b32 v56, 16, v211
v_and_b32 v57, 0xffff0000, v211
v_lshlrev_b32 v58, 16, v221
v_and_b32 v59, 0xffff0000, v221
v_lshlrev_b32 v60, 16, v231
v_and_b32 v61, 0xffff0000, v231
v_mul_f32 v56, v56, v58
v_mul_f32 v57, v57, v59
v_fmac_f32 v174, v240, v56
v_fmac_f32 v175, v240, v57
v_fmac_f32 v174, v15, v60
v_fmac_f32 v175, v15, v61
v_mul_f32 v176, v176, v244
v_mul_f32 v177, v177, v244
v_mul_f32 v178, v178, v244
v_mul_f32 v179, v179, v244
v_lshlrev_b32 v56, 16, v212
v_and_b32 v57, 0xffff0000, v212
v_lshlrev_b32 v58, 16, v222
v_and_b32 v59, 0xffff0000, v222
v_lshlrev_b32 v60, 16, v232
v_and_b32 v61, 0xffff0000, v232
v_mul_f32 v56, v56, v58
v_mul_f32 v57, v57, v59
v_fmac_f32 v176, v240, v56
v_fmac_f32 v177, v240, v57
v_fmac_f32 v176, v15, v60
v_fmac_f32 v177, v15, v61
v_lshlrev_b32 v56, 16, v213
v_and_b32 v57, 0xffff0000, v213
v_lshlrev_b32 v58, 16, v223
v_and_b32 v59, 0xffff0000, v223
v_lshlrev_b32 v60, 16, v233
v_and_b32 v61, 0xffff0000, v233
v_mul_f32 v56, v56, v58
v_mul_f32 v57, v57, v59
v_fmac_f32 v178, v240, v56
v_fmac_f32 v179, v240, v57
v_fmac_f32 v178, v15, v60
v_fmac_f32 v179, v15, v61
v_mul_f32 v180, v180, v244
v_mul_f32 v181, v181, v244
v_mul_f32 v182, v182, v244
v_mul_f32 v183, v183, v244
v_lshlrev_b32 v56, 16, v214
v_and_b32 v57, 0xffff0000, v214
v_lshlrev_b32 v58, 16, v224
v_and_b32 v59, 0xffff0000, v224
v_lshlrev_b32 v60, 16, v234
v_and_b32 v61, 0xffff0000, v234
v_mul_f32 v56, v56, v58
v_mul_f32 v57, v57, v59
v_fmac_f32 v180, v240, v56
v_fmac_f32 v181, v240, v57
v_fmac_f32 v180, v15, v60
v_fmac_f32 v181, v15, v61
v_lshlrev_b32 v56, 16, v215
v_and_b32 v57, 0xffff0000, v215
v_lshlrev_b32 v58, 16, v225
v_and_b32 v59, 0xffff0000, v225
v_lshlrev_b32 v60, 16, v235
v_and_b32 v61, 0xffff0000, v235
v_mul_f32 v56, v56, v58
v_mul_f32 v57, v57, v59
v_fmac_f32 v182, v240, v56
v_fmac_f32 v183, v240, v57
v_fmac_f32 v182, v15, v60
v_fmac_f32 v183, v15, v61
v_mul_f32 v184, v184, v244
v_mul_f32 v185, v185, v244
v_mul_f32 v186, v186, v244
v_mul_f32 v187, v187, v244
v_lshlrev_b32 v56, 16, v216
v_and_b32 v57, 0xffff0000, v216
v_lshlrev_b32 v58, 16, v226
v_and_b32 v59, 0xffff0000, v226
v_lshlrev_b32 v60, 16, v236
v_and_b32 v61, 0xffff0000, v236
v_mul_f32 v56, v56, v58
v_mul_f32 v57, v57, v59
v_fmac_f32 v184, v240, v56
v_fmac_f32 v185, v240, v57
v_fmac_f32 v184, v15, v60
v_fmac_f32 v185, v15, v61
v_lshlrev_b32 v56, 16, v217
v_and_b32 v57, 0xffff0000, v217
v_lshlrev_b32 v58, 16, v227
v_and_b32 v59, 0xffff0000, v227
v_lshlrev_b32 v60, 16, v237
v_and_b32 v61, 0xffff0000, v237
v_mul_f32 v56, v56, v58
v_mul_f32 v57, v57, v59
v_fmac_f32 v186, v240, v56
v_fmac_f32 v187, v240, v57
v_fmac_f32 v186, v15, v60
v_fmac_f32 v187, v15, v61
s_waitcnt vmcnt(0)
s_mov_b64 s[76:77], exec
s_mov_b64 exec, 1
v_mov_b32 v64, s90
v_mov_b32 v65, 8
s_add_u32 s34, s41, 0
buffer_store_dword v64, v65, s[12:15], s34 offen sc1
s_add_u32 s34, s41, 256
buffer_store_dword v64, v65, s[12:15], s34 offen sc1
s_add_u32 s34, s41, 768
buffer_store_dword v64, v65, s[12:15], s34 offen sc1
s_add_u32 s34, s41, 512
v_mov_b32 v65, 0
s_mov_b32 s36, 0
P2FCX_25P:
buffer_load_dwordx4 v[68:71], v65, s[12:15], s34 offen sc1
s_waitcnt vmcnt(0)
s_mov_b32 s35, 1
v_readfirstlane_b32 s37, v68
s_cmp_eq_u32 s37, s90
s_cselect_b32 s35, s35, 0
v_readfirstlane_b32 s37, v69
s_cmp_eq_u32 s37, s90
s_cselect_b32 s35, s35, 0
v_readfirstlane_b32 s37, v71
s_cmp_eq_u32 s37, s90
s_cselect_b32 s35, s35, 0
s_cmp_eq_u32 s35, 1
s_cbranch_scc1 P2FCX_25D
s_add_u32 s36, s36, 1
s_cmp_lt_u32 s36, 0x4000
s_cbranch_scc0 P2FCX_25D
s_branch P2FCX_25P
P2FCX_25D:
s_mov_b64 exec, s[76:77]
s_add_u32 s34, s33, 81920
buffer_load_dwordx4 v[16:19], v14, s[12:15], s34 offen sc1
buffer_load_dwordx4 v[20:23], v14, s[12:15], s34 offen offset:1024 sc1
buffer_load_dwordx2 v[24:25], v13, s[12:15], s34 offen offset:2048 sc1
s_add_u32 s34, s33, 92160
buffer_load_dwordx4 v[28:31], v14, s[12:15], s34 offen sc1
buffer_load_dwordx4 v[32:35], v14, s[12:15], s34 offen offset:1024 sc1
buffer_load_dwordx2 v[36:37], v13, s[12:15], s34 offen offset:2048 sc1
s_add_u32 s34, s33, 112640
buffer_load_dwordx4 v[40:43], v14, s[12:15], s34 offen sc1
buffer_load_dwordx4 v[44:47], v14, s[12:15], s34 offen offset:1024 sc1
buffer_load_dwordx2 v[48:49], v13, s[12:15], s34 offen offset:2048 sc1
s_waitcnt vmcnt(6)
v_lshlrev_b32 v56, 16, v16
v_and_b32 v57, 0xffff0000, v16
v_pk_add_f32 v[168:169], v[168:169], v[56:57]
v_lshlrev_b32 v56, 16, v17
v_and_b32 v57, 0xffff0000, v17
v_pk_add_f32 v[170:171], v[170:171], v[56:57]
v_lshlrev_b32 v56, 16, v18
v_and_b32 v57, 0xffff0000, v18
v_pk_add_f32 v[172:173], v[172:173], v[56:57]
v_lshlrev_b32 v56, 16, v19
v_and_b32 v57, 0xffff0000, v19
v_pk_add_f32 v[174:175], v[174:175], v[56:57]
v_lshlrev_b32 v56, 16, v20
v_and_b32 v57, 0xffff0000, v20
v_pk_add_f32 v[176:177], v[176:177], v[56:57]
v_lshlrev_b32 v56, 16, v21
v_and_b32 v57, 0xffff0000, v21
v_pk_add_f32 v[178:179], v[178:179], v[56:57]
v_lshlrev_b32 v56, 16, v22
v_and_b32 v57, 0xffff0000, v22
v_pk_add_f32 v[180:181], v[180:181], v[56:57]
v_lshlrev_b32 v56, 16, v23
v_and_b32 v57, 0xffff0000, v23
v_pk_add_f32 v[182:183], v[182:183], v[56:57]
v_lshlrev_b32 v56, 16, v24
v_and_b32 v57, 0xffff0000, v24
v_pk_add_f32 v[184:185], v[184:185], v[56:57]
v_lshlrev_b32 v56, 16, v25
v_and_b32 v57, 0xffff0000, v25
v_pk_add_f32 v[186:187], v[186:187], v[56:57]
s_waitcnt vmcnt(3)
v_lshlrev_b32 v56, 16, v28
v_and_b32 v57, 0xffff0000, v28
v_pk_add_f32 v[168:169], v[168:169], v[56:57]
v_lshlrev_b32 v56, 16, v29
v_and_b32 v57, 0xffff0000, v29
v_pk_add_f32 v[170:171], v[170:171], v[56:57]
v_lshlrev_b32 v56, 16, v30
v_and_b32 v57, 0xffff0000, v30
v_pk_add_f32 v[172:173], v[172:173], v[56:57]
v_lshlrev_b32 v56, 16, v31
v_and_b32 v57, 0xffff0000, v31
v_pk_add_f32 v[174:175], v[174:175], v[56:57]
v_lshlrev_b32 v56, 16, v32
v_and_b32 v57, 0xffff0000, v32
v_pk_add_f32 v[176:177], v[176:177], v[56:57]
v_lshlrev_b32 v56, 16, v33
v_and_b32 v57, 0xffff0000, v33
v_pk_add_f32 v[178:179], v[178:179], v[56:57]
v_lshlrev_b32 v56, 16, v34
v_and_b32 v57, 0xffff0000, v34
v_pk_add_f32 v[180:181], v[180:181], v[56:57]
v_lshlrev_b32 v56, 16, v35
v_and_b32 v57, 0xffff0000, v35
v_pk_add_f32 v[182:183], v[182:183], v[56:57]
v_lshlrev_b32 v56, 16, v36
v_and_b32 v57, 0xffff0000, v36
v_pk_add_f32 v[184:185], v[184:185], v[56:57]
v_lshlrev_b32 v56, 16, v37
v_and_b32 v57, 0xffff0000, v37
v_pk_add_f32 v[186:187], v[186:187], v[56:57]
s_waitcnt vmcnt(0)
v_lshlrev_b32 v56, 16, v40
v_and_b32 v57, 0xffff0000, v40
v_pk_add_f32 v[168:169], v[168:169], v[56:57]
v_lshlrev_b32 v56, 16, v41
v_and_b32 v57, 0xffff0000, v41
v_pk_add_f32 v[170:171], v[170:171], v[56:57]
v_lshlrev_b32 v56, 16, v42
v_and_b32 v57, 0xffff0000, v42
v_pk_add_f32 v[172:173], v[172:173], v[56:57]
v_lshlrev_b32 v56, 16, v43
v_and_b32 v57, 0xffff0000, v43
v_pk_add_f32 v[174:175], v[174:175], v[56:57]
v_lshlrev_b32 v56, 16, v44
v_and_b32 v57, 0xffff0000, v44
v_pk_add_f32 v[176:177], v[176:177], v[56:57]
v_lshlrev_b32 v56, 16, v45
v_and_b32 v57, 0xffff0000, v45
v_pk_add_f32 v[178:179], v[178:179], v[56:57]
v_lshlrev_b32 v56, 16, v46
v_and_b32 v57, 0xffff0000, v46
v_pk_add_f32 v[180:181], v[180:181], v[56:57]
v_lshlrev_b32 v56, 16, v47
v_and_b32 v57, 0xffff0000, v47
v_pk_add_f32 v[182:183], v[182:183], v[56:57]
v_lshlrev_b32 v56, 16, v48
v_and_b32 v57, 0xffff0000, v48
v_pk_add_f32 v[184:185], v[184:185], v[56:57]
v_lshlrev_b32 v56, 16, v49
v_and_b32 v57, 0xffff0000, v49
v_pk_add_f32 v[186:187], v[186:187], v[56:57]
buffer_store_dwordx4 v[168:171], v246, s[16:19], 0 offen offset:0 sc1
buffer_store_dwordx4 v[172:175], v246, s[16:19], 0 offen offset:64 sc1
buffer_store_dwordx4 v[176:179], v246, s[16:19], 0 offen offset:128 sc1
buffer_store_dwordx4 v[180:183], v246, s[16:19], 0 offen offset:192 sc1
buffer_store_dwordx4 v[184:187], v246, s[16:19], 0 offen offset:256 sc1
P2FC_END:
FIN:
DONE:
s_endpgm
CODE_END:
.section .rodata,"a"
.p2align 6
.amdhsa_kernel gated_mix__ssm_conv_s5__dense_activation_squared_relu__prompt_kernel
  .amdhsa_next_free_vgpr 256
  .amdhsa_next_free_sgpr 100
  .amdhsa_accum_offset 256
  .amdhsa_group_segment_fixed_size 0
  .amdhsa_kernarg_size 144
  .amdhsa_user_sgpr_count 2
  .amdhsa_user_sgpr_kernarg_segment_ptr 1
  .amdhsa_system_sgpr_workgroup_id_x 1
  .amdhsa_float_denorm_mode_32 3
.end_amdhsa_kernel
```
